```python
import torch

def _softmax(x, axis=-1):
    return torch.softmax(x, dim=axis)

def _gelu(x):
    return torch.nn.functional.gelu(x, approximate='tanh')

def _silu(x):
    return torch.nn.functional.silu(x)

def _sigmoid(x):
    return torch.sigmoid(x)

def _layernorm(x, axis=-1, eps=1e-05):
    m = x.mean(dim=axis, keepdim=True)
    v = x.var(dim=axis, keepdim=True, unbiased=False)
    return (x - m) / torch.sqrt(v + eps)

def _scatter_add(tgt, idx, src, axis=0):
    return tgt.clone().index_add_(axis, idx, src)

def _segment_sum(src, seg, n):
    out = torch.zeros((n,) + src.shape[1:], dtype=src.dtype)
    return out.index_add_(0, seg, src)

def _pad(x, pw):
    flat = tuple((v for pair in reversed(pw) for v in pair))
    return torch.nn.functional.pad(x, flat)
kernel_name = 'recurrent_scan__linear_kernel_hedgehog__mixer_gmlp__prompt'

def setup_inputs():

    _w = lambda a: (lambda t: t.to(torch.bfloat16) if t.is_floating_point() else t)(torch.as_tensor(a))

    def _A_setup():
        B, S, D, H = (1, 2048, 512, 32)
        Dh = D // H
        return {'x': _w((lambda *s: torch.randn(*s, dtype=torch.bfloat16) * 0.05)(B, S, D)), 'wqkv': _w((lambda *s: torch.randn(*s, dtype=torch.bfloat16) * 0.2)(D, 3 * D)), 'w_phi': _w((lambda *s: torch.randn(*s, dtype=torch.bfloat16) * 0.2)(H, Dh, Dh) * Dh ** (-0.5)), 'wo': _w((lambda *s: torch.randn(*s, dtype=torch.bfloat16) * 0.05)(D, D))}
    _A_in = _A_setup()

    def _B_setup():
        B, S, D, F = (1, 2048, 512, 1376)
        Fh = F // 2
        return {'x': _w((lambda *s: torch.randn(*s, dtype=torch.bfloat16) * 0.05)(B, S, D)), 'w_in': _w((lambda *s: torch.randn(*s, dtype=torch.bfloat16) * 0.4)(D, 2 * Fh)), 'w_sp': _w(0.01 * (lambda *s: torch.randn(*s, dtype=torch.bfloat16) * 0.4)(S, S)), 'b_sp': _w(1.0 + 0.01 * (lambda *s: torch.randn(*s, dtype=torch.bfloat16) * 0.05)(S)), 'w_out': _w((lambda *s: torch.randn(*s, dtype=torch.bfloat16) * 0.05)(Fh, D))}
    _B_in = _B_setup()
    return {'A_x': _A_in['x'], 'A_wqkv': _A_in['wqkv'], 'A_w_phi': _A_in['w_phi'], 'A_wo': _A_in['wo'], 'B_x': _B_in['x'], 'B_w_in': _B_in['w_in'], 'B_w_sp': _B_in['w_sp'], 'B_b_sp': _B_in['b_sp'], 'B_w_out': _B_in['w_out']}

def reference(A_x, A_wqkv, A_w_phi, A_wo, B_x, B_w_in, B_w_sp, B_b_sp, B_w_out):

    def _A_ref(x, wqkv, w_phi, wo):
        B, S, D = x.shape
        H = 32
        Dh = D // H
        qkv = (lambda x, *d: x.permute(*d))((x @ wqkv).reshape(B, S, 3, H, Dh), 2, 0, 3, 1, 4)
        q, k, v = (qkv[0], qkv[1], qkv[2])
        pq = torch.einsum('bhsd,hdf->bhsf', q, w_phi)
        pk = torch.einsum('bhsd,hdf->bhsf', k, w_phi)
        phi_q = torch.concatenate([_softmax(pq, axis=-1), _softmax(-pq, axis=-1)], axis=-1)
        phi_k = torch.concatenate([_softmax(pk, axis=-1), _softmax(-pk, axis=-1)], axis=-1)
        kv = torch.einsum('bhsf,bhsd->bhfd', phi_k, v)
        z = torch.einsum('bhsf->bhf', phi_k)
        num = torch.einsum('bhqf,bhfd->bhqd', phi_q, kv)
        den = torch.einsum('bhqf,bhf->bhq', phi_q, z)[..., None] + 1e-06
        o = num / den
        return (lambda x, *d: x.permute(*d))(o, 0, 2, 1, 3).reshape(B, S, D) @ wo

    def _B_ref(x, w_in, w_sp, b_sp, w_out):
        B, S, D = x.shape
        F = w_in.shape[-1]
        Fh = F // 2
        z = _gelu(torch.einsum('bsd,df->bsf', x, w_in))
        z1 = z[..., :Fh].clone()
        z2 = _layernorm(z[..., Fh:], axis=-1)
        g = torch.einsum('ts,bsf->btf', w_sp, z2) + b_sp[None, :, None]
        return torch.einsum('bsf,fd->bsd', z1 * g, w_out)
    x = A_x
    xn = _layernorm(x, axis=-1)
    s = _A_ref(xn, A_wqkv, A_w_phi, A_wo)
    g = _silu(_B_ref(xn, B_w_in, B_w_sp, B_b_sp, B_w_out))
    return x + s * g
```

```asm
; @launch grid=(256,1,1) block=(256,1,1) lds=163840
.amdgcn_target "amdgcn-amd-amdhsa--gfx950"
.text
.globl recurrent_scan__linear_kernel_hedgehog__mixer_gmlp__prompt_kernel
.p2align 8
.type recurrent_scan__linear_kernel_hedgehog__mixer_gmlp__prompt_kernel,@function
recurrent_scan__linear_kernel_hedgehog__mixer_gmlp__prompt_kernel:
    s_cmp_ge_u32 s2, 256
    s_cbranch_scc1 L_end
    s_load_dwordx16 s[52:67], s[0:1], 0
    s_load_dwordx8 s[68:75], s[0:1], 64
    s_getpc_b64 s[76:77]
    s_and_b32 s76, s76, 0xffffff00
    s_lshr_b32 s78, s2, 3
    s_lshl_b32 s79, s78, 11
    v_and_b32_e64 v2, 31, v0
    v_lshl_add_u32 v2, v2, 6, s79
    v_min_u32 v2, CODE_BYTES-64, v2
    v_lshrrev_b32_e64 v4, 6, v0
    global_load_dword v3, v2, s[76:77]
    v_and_b32 v1, 63, v0
    v_readfirstlane_b32 s3, v4
    s_and_b32 s6, s2, 7
    s_lshl_b32 s6, s6, 2
    s_lshr_b32 s79, s78, 3
    s_add_u32 s6, s6, s79
    s_and_b32 s7, s78, 7
    s_and_b32 s89, s7, 7
    s_mul_i32 s89, s89, 128
    s_lshl_b32 s76, s3, 8
    s_xor_b32 s89, s89, s76
    s_mov_b32 s10, 2097152
    s_mov_b32 s11, 0x20000
    v_lshlrev_b32 v4, 4, v0
    v_and_b32 v4, 48, v4
    v_lshrrev_b32_e64 v5, 2, v0
    v_lshl_add_u32 v4, v5, 10, v4
    s_lshl_b32 s76, s6, 16
    v_add_u32 v45, s76, v4
    s_waitcnt lgkmcnt(0)
    s_mov_b64 s[8:9], s[52:53]
    s_xor_b32 s82, s89, 0
    buffer_load_dwordx4 v[192:195], v45, s[8:11], s82 offen nt
    s_xor_b32 s82, s89, 64
    buffer_load_dwordx4 v[196:199], v45, s[8:11], s82 offen nt
    s_xor_b32 s82, s89, 128
    buffer_load_dwordx4 v[200:203], v45, s[8:11], s82 offen
    s_xor_b32 s82, s89, 192
    buffer_load_dwordx4 v[204:207], v45, s[8:11], s82 offen
    s_xor_b32 s82, s89, 256
    buffer_load_dwordx4 v[208:211], v45, s[8:11], s82 offen
    s_xor_b32 s82, s89, 320
    buffer_load_dwordx4 v[212:215], v45, s[8:11], s82 offen
    s_xor_b32 s82, s89, 384
    buffer_load_dwordx4 v[216:219], v45, s[8:11], s82 offen
    s_xor_b32 s82, s89, 448
    buffer_load_dwordx4 v[220:223], v45, s[8:11], s82 offen
    s_xor_b32 s82, s89, 512
    buffer_load_dwordx4 v[224:227], v45, s[8:11], s82 offen
    s_xor_b32 s82, s89, 576
    buffer_load_dwordx4 v[228:231], v45, s[8:11], s82 offen
    s_mov_b64 s[12:13], s[54:55]
    s_mov_b32 s14, 1572864
    s_mov_b32 s15, 0x20000
    s_mov_b64 s[16:17], s[62:63]
    s_mov_b32 s18, 1409024
    s_mov_b32 s19, 0x20000
    s_mov_b64 s[20:21], s[64:65]
    s_mov_b32 s22, 8388608
    s_mov_b32 s23, 0x20000
    s_mov_b64 s[24:25], s[74:75]
    s_mov_b32 s26, 268435456
    s_mov_b32 s27, 0x20000
    s_mov_b64 s[28:29], s[58:59]
    s_mov_b32 s30, 524288
    s_mov_b32 s31, 0x20000
    s_mov_b64 s[32:33], s[68:69]
    s_mov_b32 s34, 704512
    s_mov_b32 s35, 0x20000
    s_mov_b64 s[36:37], s[70:71]
    s_mov_b32 s38, 2097152
    s_mov_b32 s39, 0x20000
    s_mov_b64 s[40:41], s[56:57]
    s_mov_b32 s42, 16384
    s_mov_b32 s43, 0x20000
    s_mov_b64 s[44:45], s[66:67]
    s_mov_b32 s46, 4096
    s_mov_b32 s47, 0x20000
    s_mov_b64 s[48:49], s[72:73]
    s_mov_b32 s50, 256
    s_mov_b32 s51, 0x20000
    s_xor_b32 s88, s7, 3
    s_lshr_b32 s4, s3, 1
    s_and_b32 s5, s3, 1
    s_mul_i32 s84, s3, 3072
    s_and_b32 s90, s6, 3
    s_mul_i32 s90, s90, 4
    s_and_b32 s91, s7, 7
    s_mul_i32 s91, s91, 1
    s_lshl_b32 s76, s3, 1
    s_xor_b32 s91, s91, s76
    s_mul_i32 s76, s3, 192
    s_mul_i32 s77, s7, 192
    s_sub_u32 s77, s77, 160
    s_cmp_eq_u32 s7, 0
    s_cselect_b32 s78, 10, 0
    v_mov_b32 v9, 2147483648
    v_add_u32 v4, 0, v1
    v_add_u32_e64 v4, s76, v4
    v_mul_u32_u24 v5, 43691, v4
    v_lshrrev_b32 v5, 19, v5
    v_mul_u32_u24 v6, 12, v5
    v_sub_u32 v6, v4, v6
    v_cmp_gt_u32 vcc, s78, v6
    v_mul_u32_u24 v5, 2752, v5
    v_lshlrev_b32_e64 v6, 4, v6
    v_add3_u32 v5, v5, v6, s77
    v_cndmask_b32 v48, v5, v9, vcc
    v_add_u32 v4, 64, v1
    v_add_u32_e64 v4, s76, v4
    v_mul_u32_u24 v5, 43691, v4
    v_lshrrev_b32_e64 v5, 19, v5
    s_xor_b32 s82, s89, 640
    buffer_load_dwordx4 v[232:235], v45, s[8:11], s82 offen
    v_mul_u32_u24 v6, 12, v5
    v_sub_u32 v6, v4, v6
    v_cmp_gt_u32_e64 vcc, s78, v6
    v_mul_u32_u24 v5, 2752, v5
    v_lshlrev_b32_e64 v6, 4, v6
    v_add3_u32 v5, v5, v6, s77
    v_subrev_u32 v5, 1024, v5
    v_cndmask_b32_e64 v49, v5, v9, vcc
    v_add_u32 v4, 128, v1
    v_add_u32_e64 v4, s76, v4
    v_mul_u32_u24 v5, 43691, v4
    v_lshrrev_b32 v5, 19, v5
    v_mul_u32_u24 v6, 12, v5
    v_sub_u32 v6, v4, v6
    v_cmp_gt_u32 vcc, s78, v6
    v_mul_u32_u24 v5, 2752, v5
    s_xor_b32 s82, s89, 704
    buffer_load_dwordx4 v[236:239], v45, s[8:11], s82 offen
    v_lshlrev_b32_e64 v6, 4, v6
    v_add3_u32 v5, v5, v6, s77
    v_subrev_u32 v5, 2048, v5
    v_cndmask_b32 v50, v5, v9, vcc
    s_or_b32 s76, s2, s3
    s_cmp_lg_u32 s76, 0
    s_cbranch_scc1 L_nolead_1
    s_memrealtime s[86:87]
    s_waitcnt lgkmcnt(0)
    s_or_b32 s76, s86, 0x80000000
    v_mov_b32 v8, s76
    v_mov_b32_e64 v9, 0
    buffer_store_dword v8, v9, s[48:51], 0 offen sc1
L_nolead_1:
    s_lshl_b32 s76, s4, 15
    s_add_u32 s76, s76, 98304
    s_lshl_b32 s77, s90, 6
    v_bfe_u32 v4, v1, 5, 1
    v_lshlrev_b32 v4, 0, v4
    v_and_b32 v5, 15, v1
    v_xor_b32_e64 v4, v4, v5
    v_bfe_u32 v51, v1, 0, 5
    v_lshlrev_b32 v51, 10, v51
    v_add_u32 v51, s76, v51
    v_lshl_add_u32 v51, v4, 4, v51
    v_xor_b32 v51, s77, v51
    s_lshl_b32 s76, s3, 14
    s_add_u32 s76, s76, 98304
    v_bfe_u32 v4, v1, 2, 4
    v_lshlrev_b32 v4, 0, v4
    v_and_b32 v5, 3, v1
    s_xor_b32 s82, s89, 768
    buffer_load_dwordx4 v[240:243], v45, s[8:11], s82 offen
    v_xor_b32_e64 v5, v4, v5
    v_lshl_add_u32 v4, v4, 10, s76
    v_lshl_add_u32 v4, v5, 4, v4
    v_xor_b32_e64 v55, s89, v4
    v_bfe_u32 v4, v1, 5, 1
    v_mul_u32_u24 v4, 1536, v4
    v_bfe_u32 v2, v1, 2, 2
    v_mul_u32_u24 v2, 192, v2
    v_add_u32_e64 v4, v4, v2
    v_bfe_u32 v2, v1, 0, 2
    v_lshl_add_u32 v4, v2, 3, v4
    v_bfe_u32 v6, v1, 4, 1
    v_lshlrev_b32 v6, 5, v6
    s_lshl_b32 s76, s5, 7
    v_add3_u32 v56, v4, v6, s76
    s_lshl_b32 s76, s5, 5
    s_add_u32 s76, s76, 64
    v_add_u32_e64 v57, s76, v4
    v_add_u32 v58, 49152, v56
    s_xor_b32 s82, s89, 832
    buffer_load_dwordx4 v[244:247], v45, s[8:11], s82 offen
    v_add_u32 v59, 49152, v57
    s_mul_i32 s76, s3, 192
    s_lshl_b32 s79, s88, 7
    v_add_u32 v4, 0, v1
    v_add_u32_e64 v4, s76, v4
    v_mul_u32_u24 v5, 43691, v4
    v_lshrrev_b32 v5, 20, v5
    v_mul_u32_u24 v6, 24, v5
    v_sub_u32 v6, v4, v6
    v_lshlrev_b32 v7, 1, v5
    v_and_b32 v7, 4, v7
    v_xor_b32 v6, v6, v7
    v_lshrrev_b32 v7, 3, v6
    v_and_b32 v6, 7, v6
    v_lshlrev_b32_e64 v6, 4, v6
    v_lshl_add_u32 v6, v7, 10, v6
    v_mul_u32_u24 v5, 3072, v5
    v_add3_u32 v52, v5, v6, s79
    s_xor_b32 s82, s89, 896
    buffer_load_dwordx4 v[248:251], v45, s[8:11], s82 offen
    v_add_u32 v4, 64, v1
    v_add_u32 v4, s76, v4
    v_mul_u32_u24 v5, 43691, v4
    v_lshrrev_b32 v5, 20, v5
    v_mul_u32_u24 v6, 24, v5
    v_sub_u32 v6, v4, v6
    v_lshlrev_b32 v7, 1, v5
    v_and_b32 v7, 4, v7
    v_xor_b32 v6, v6, v7
    v_lshrrev_b32 v7, 3, v6
    v_and_b32 v6, 7, v6
    v_lshlrev_b32_e64 v6, 4, v6
    v_lshl_add_u32 v6, v7, 10, v6
    v_mul_u32_u24 v5, 3072, v5
    v_add3_u32 v53, v5, v6, s79
    v_subrev_u32 v53, 1024, v53
    s_xor_b32 s82, s89, 960
    buffer_load_dwordx4 v[252:255], v45, s[8:11], s82 offen
    v_add_u32 v4, 128, v1
    v_add_u32_e64 v4, s76, v4
    v_mul_u32_u24 v5, 43691, v4
    v_lshrrev_b32 v5, 20, v5
    v_mul_u32_u24 v6, 24, v5
    v_sub_u32 v6, v4, v6
    v_lshlrev_b32 v7, 1, v5
    v_and_b32 v7, 4, v7
    v_xor_b32 v6, v6, v7
    v_lshrrev_b32 v7, 3, v6
    v_and_b32 v6, 7, v6
    v_lshlrev_b32_e64 v6, 4, v6
    v_lshl_add_u32 v6, v7, 10, v6
    v_mul_u32_u24 v5, 3072, v5
    v_add3_u32 v54, v5, v6, s79
    v_subrev_u32 v54, 2048, v54
    s_xor_b32 s82, s90, 0
    s_mul_i32 s82, s82, 88064
    s_add_u32 s82, s82, 1376
    s_add_u32 m0, s84, 24576
    s_nop 0
    buffer_load_dwordx4 v48, s[16:19], s82 offen offset:0 lds
    v_bfe_u32 v4, v1, 5, 1
    v_mul_u32_u24 v4, 3072, v4
    v_bfe_u32 v2, v1, 2, 2
    v_mul_u32_u24 v2, 384, v2
    v_add_u32_e64 v4, v4, v2
    v_bfe_u32 v2, v1, 0, 2
    v_lshl_add_u32 v4, v2, 3, v4
    v_bfe_u32 v2, v1, 4, 1
    v_lshl_add_u32 v4, v2, 5, v4
    v_bfe_u32 v5, v1, 3, 1
    v_lshlrev_b32 v5, 6, v5
    s_lshl_b32 s76, s5, 6
    v_xor_b32 v5, s76, v5
    v_add_u32 v60, v4, v5
    v_add_u32 v61, 49152, v60
    s_lshl_b32 s76, s88, 11
    s_lshl_b32 s81, s5, 10
    s_add_u32 s76, s76, s81
    v_bfe_u32 v62, v1, 4, 1
    v_lshlrev_b32 v62, 9, v62
    buffer_load_dwordx4 v49, s[16:19], s82 offen offset:1024 lds
    v_bfe_u32 v2, v1, 0, 4
    v_lshl_add_u32 v62, v2, 1, v62
    v_bfe_u32 v2, v1, 5, 1
    v_lshl_add_u32 v62, v2, 7, v62
    v_add_u32 v62, s76, v62
    s_lshl_b32 s76, s6, 7
    s_lshl_b32 s81, s4, 6
    s_add_u32 s76, s76, s81
    v_bfe_u32 v63, v1, 0, 5
    v_lshlrev_b32_e64 v63, 1, v63
    v_add_u32 v63, s76, v63
    s_lshl_b32 s56, s6, 16
    s_lshl_b32 s81, s3, 14
    s_add_u32 s56, s56, s81
    s_lshl_b32 s81, s88, 7
    s_add_u32 s56, s56, s81
    v_bfe_u32 v64, v1, 0, 4
    v_lshlrev_b32_e64 v64, 10, v64
    v_bfe_u32 v2, v1, 4, 2
    v_lshl_add_u32 v64, v2, 3, v64
    v_add_u32 v64, s56, v64
    v_lshlrev_b32 v42, 4, v1
    v_mov_b32 v176, 0
    v_mov_b32 v177, 0
    buffer_load_dwordx4 v50, s[16:19], s82 offen offset:2048 lds
    v_mov_b32 v178, 0
    v_mov_b32 v179, 0
    v_mov_b32 v180, 0
    v_mov_b32 v181, 0
    v_mov_b32 v182, 0
    v_mov_b32 v183, 0
    s_mov_b32 s61, 0x3f803f80
    s_mov_b32 s62, 0xffff0000
    v_mov_b32 v32, 0xbdd2d3e8
    v_mov_b32 v33, 0xc0135761
    v_mov_b32 v36, 0x3fb8aa3b
    s_waitcnt vmcnt(18)
    v_dot2c_f32_bf16 v176, s61, v192
    v_dot2c_f32_bf16 v180, v192, v192
    v_dot2c_f32_bf16 v177, s61, v193
    v_dot2c_f32_bf16 v181, v193, v193
    v_dot2c_f32_bf16 v178, s61, v194
    v_dot2c_f32_bf16 v182, v194, v194
    v_dot2c_f32_bf16 v179, s61, v195
    v_dot2c_f32_bf16 v183, v195, v195
    s_waitcnt vmcnt(17)
    v_dot2c_f32_bf16 v176, s61, v196
    v_dot2c_f32_bf16 v180, v196, v196
    v_dot2c_f32_bf16 v177, s61, v197
    v_dot2c_f32_bf16 v181, v197, v197
    v_dot2c_f32_bf16 v178, s61, v198
    v_dot2c_f32_bf16 v182, v198, v198
    v_dot2c_f32_bf16 v179, s61, v199
    v_dot2c_f32_bf16 v183, v199, v199
    s_waitcnt vmcnt(16)
    v_dot2c_f32_bf16 v176, s61, v200
    v_dot2c_f32_bf16 v180, v200, v200
    v_dot2c_f32_bf16 v177, s61, v201
    v_dot2c_f32_bf16 v181, v201, v201
    v_dot2c_f32_bf16 v178, s61, v202
    v_dot2c_f32_bf16 v182, v202, v202
    v_dot2c_f32_bf16 v179, s61, v203
    v_dot2c_f32_bf16 v183, v203, v203
    s_waitcnt vmcnt(15)
    v_dot2c_f32_bf16 v176, s61, v204
    v_dot2c_f32_bf16 v180, v204, v204
    v_dot2c_f32_bf16 v177, s61, v205
    v_dot2c_f32_bf16 v181, v205, v205
    v_dot2c_f32_bf16 v178, s61, v206
    v_dot2c_f32_bf16 v182, v206, v206
    v_dot2c_f32_bf16 v179, s61, v207
    v_dot2c_f32_bf16 v183, v207, v207
    s_waitcnt vmcnt(14)
    v_dot2c_f32_bf16 v176, s61, v208
    v_dot2c_f32_bf16 v180, v208, v208
    v_dot2c_f32_bf16 v177, s61, v209
    v_dot2c_f32_bf16 v181, v209, v209
    v_dot2c_f32_bf16 v178, s61, v210
    v_dot2c_f32_bf16 v182, v210, v210
    v_dot2c_f32_bf16 v179, s61, v211
    v_dot2c_f32_bf16 v183, v211, v211
    s_xor_b32 s82, s90, 2
    s_mul_i32 s82, s82, 88064
    s_add_u32 s82, s82, 1376
    s_add_u32 m0, s84, 36864
    s_nop 0
    buffer_load_dwordx4 v48, s[16:19], s82 offen offset:0 lds
    s_waitcnt vmcnt(14)
    v_dot2c_f32_bf16 v176, s61, v212
    v_dot2c_f32_bf16 v180, v212, v212
    v_dot2c_f32_bf16 v177, s61, v213
    v_dot2c_f32_bf16 v181, v213, v213
    v_dot2c_f32_bf16 v178, s61, v214
    v_dot2c_f32_bf16 v182, v214, v214
    v_dot2c_f32_bf16 v179, s61, v215
    v_dot2c_f32_bf16 v183, v215, v215
    s_waitcnt vmcnt(13)
    v_dot2c_f32_bf16 v176, s61, v216
    v_dot2c_f32_bf16 v180, v216, v216
    v_dot2c_f32_bf16 v177, s61, v217
    v_dot2c_f32_bf16 v181, v217, v217
    v_dot2c_f32_bf16 v178, s61, v218
    v_dot2c_f32_bf16 v182, v218, v218
    v_dot2c_f32_bf16 v179, s61, v219
    v_dot2c_f32_bf16 v183, v219, v219
    s_waitcnt vmcnt(12)
    v_dot2c_f32_bf16 v176, s61, v220
    v_dot2c_f32_bf16 v180, v220, v220
    v_dot2c_f32_bf16 v177, s61, v221
    v_dot2c_f32_bf16 v181, v221, v221
    v_dot2c_f32_bf16 v178, s61, v222
    v_dot2c_f32_bf16 v182, v222, v222
    v_dot2c_f32_bf16 v179, s61, v223
    v_dot2c_f32_bf16 v183, v223, v223
    s_waitcnt vmcnt(11)
    v_dot2c_f32_bf16 v176, s61, v224
    v_dot2c_f32_bf16 v180, v224, v224
    v_dot2c_f32_bf16 v177, s61, v225
    v_dot2c_f32_bf16 v181, v225, v225
    v_dot2c_f32_bf16 v178, s61, v226
    v_dot2c_f32_bf16 v182, v226, v226
    v_dot2c_f32_bf16 v179, s61, v227
    v_dot2c_f32_bf16 v183, v227, v227
    s_waitcnt vmcnt(10)
    v_dot2c_f32_bf16 v176, s61, v228
    v_dot2c_f32_bf16 v180, v228, v228
    v_dot2c_f32_bf16 v177, s61, v229
    v_dot2c_f32_bf16 v181, v229, v229
    v_dot2c_f32_bf16 v178, s61, v230
    v_dot2c_f32_bf16 v182, v230, v230
    v_dot2c_f32_bf16 v179, s61, v231
    v_dot2c_f32_bf16 v183, v231, v231
    buffer_load_dwordx4 v49, s[16:19], s82 offen offset:1024 lds
    s_waitcnt vmcnt(10)
    v_dot2c_f32_bf16 v176, s61, v232
    v_dot2c_f32_bf16 v180, v232, v232
    v_dot2c_f32_bf16 v177, s61, v233
    v_dot2c_f32_bf16 v181, v233, v233
    v_dot2c_f32_bf16 v178, s61, v234
    v_dot2c_f32_bf16 v182, v234, v234
    v_dot2c_f32_bf16 v179, s61, v235
    v_dot2c_f32_bf16 v183, v235, v235
    s_waitcnt vmcnt(9)
    v_dot2c_f32_bf16 v176, s61, v236
    v_dot2c_f32_bf16 v180, v236, v236
    v_dot2c_f32_bf16 v177, s61, v237
    v_dot2c_f32_bf16 v181, v237, v237
    v_dot2c_f32_bf16 v178, s61, v238
    v_dot2c_f32_bf16 v182, v238, v238
    v_dot2c_f32_bf16 v179, s61, v239
    v_dot2c_f32_bf16 v183, v239, v239
    s_waitcnt vmcnt(8)
    v_dot2c_f32_bf16 v176, s61, v240
    v_dot2c_f32_bf16 v180, v240, v240
    v_dot2c_f32_bf16 v177, s61, v241
    v_dot2c_f32_bf16 v181, v241, v241
    v_dot2c_f32_bf16 v178, s61, v242
    v_dot2c_f32_bf16 v182, v242, v242
    v_dot2c_f32_bf16 v179, s61, v243
    v_dot2c_f32_bf16 v183, v243, v243
    s_waitcnt vmcnt(7)
    v_dot2c_f32_bf16 v176, s61, v244
    v_dot2c_f32_bf16 v180, v244, v244
    v_dot2c_f32_bf16 v177, s61, v245
    v_dot2c_f32_bf16 v181, v245, v245
    v_dot2c_f32_bf16 v178, s61, v246
    v_dot2c_f32_bf16 v182, v246, v246
    v_dot2c_f32_bf16 v179, s61, v247
    v_dot2c_f32_bf16 v183, v247, v247
    s_waitcnt vmcnt(6)
    v_dot2c_f32_bf16 v176, s61, v248
    v_dot2c_f32_bf16 v180, v248, v248
    v_dot2c_f32_bf16 v177, s61, v249
    v_dot2c_f32_bf16 v181, v249, v249
    v_dot2c_f32_bf16 v178, s61, v250
    v_dot2c_f32_bf16 v182, v250, v250
    v_dot2c_f32_bf16 v179, s61, v251
    v_dot2c_f32_bf16_e64 v183, v251, v251
    buffer_load_dwordx4 v50, s[16:19], s82 offen offset:2048 lds
    s_waitcnt vmcnt(6)
    v_dot2c_f32_bf16 v176, s61, v252
    v_dot2c_f32_bf16 v180, v252, v252
    v_dot2c_f32_bf16 v177, s61, v253
    v_dot2c_f32_bf16 v181, v253, v253
    v_dot2c_f32_bf16 v178, s61, v254
    v_dot2c_f32_bf16 v182, v254, v254
    v_dot2c_f32_bf16 v179, s61, v255
    v_dot2c_f32_bf16 v183, v255, v255
    s_nop 1
    v_pk_add_f32 v[176:177], v[176:177], v[178:179]
    v_pk_add_f32 v[180:181], v[180:181], v[182:183]
    v_add_f32 v176, v176, v177
    v_add_f32 v177, v180, v181
    s_nop 0
    v_add_f32_dpp v176, v176, v176 quad_perm:[1,0,3,2] row_mask:0xf bank_mask:0xf bound_ctrl:1
    v_add_f32_dpp v177, v177, v177 quad_perm:[1,0,3,2] row_mask:0xf bank_mask:0xf bound_ctrl:1
    s_nop 0
    v_add_f32_dpp v176, v176, v176 quad_perm:[2,3,0,1] row_mask:0xf bank_mask:0xf bound_ctrl:1
    v_add_f32_dpp v177, v177, v177 quad_perm:[2,3,0,1] row_mask:0xf bank_mask:0xf bound_ctrl:1
    v_mul_f32 v176, 0x3b000000, v176
    v_mul_f32 v177, 0x3b000000, v177
    v_fma_f32 v180, -v176, v176, v177
    v_max_f32_e64 v180, 0, v180
    v_add_f32 v180, 0x3727c5ac, v180
    v_rsq_f32 v178, v180
    s_nop 0
    v_mul_f32 v179, -v176, v178
    v_lshlrev_b32 v168, 16, v192
    v_and_b32 v169, s62, v192
    v_lshlrev_b32 v170, 16, v193
    v_and_b32 v171, s62, v193
    v_lshlrev_b32 v172, 16, v194
    v_and_b32 v173, s62, v194
    v_lshlrev_b32 v174, 16, v195
    v_and_b32 v175, s62, v195
    v_pk_fma_f32 v[168:169], v[168:169], v[178:179], v[178:179] op_sel:[0,0,1] op_sel_hi:[1,0,1]
    v_pk_fma_f32 v[170:171], v[170:171], v[178:179], v[178:179] op_sel:[0,0,1] op_sel_hi:[1,0,1]
    v_pk_fma_f32 v[172:173], v[172:173], v[178:179], v[178:179] op_sel:[0,0,1] op_sel_hi:[1,0,1]
    v_pk_fma_f32 v[174:175], v[174:175], v[178:179], v[178:179] op_sel:[0,0,1] op_sel_hi:[1,0,1]
    v_xor_b32_e64 v5, 0, v55
    v_cvt_pk_bf16_f32 v192, v168, v169
    v_cvt_pk_bf16_f32 v193, v170, v171
    v_cvt_pk_bf16_f32 v194, v172, v173
    v_cvt_pk_bf16_f32 v195, v174, v175
    ds_write_b128 v5, v[192:195]
    v_lshlrev_b32 v168, 16, v196
    v_and_b32 v169, s62, v196
    v_lshlrev_b32 v170, 16, v197
    v_and_b32 v171, s62, v197
    v_lshlrev_b32 v172, 16, v198
    v_and_b32 v173, s62, v198
    v_lshlrev_b32 v174, 16, v199
    v_and_b32 v175, s62, v199
    v_pk_fma_f32 v[168:169], v[168:169], v[178:179], v[178:179] op_sel:[0,0,1] op_sel_hi:[1,0,1]
    v_pk_fma_f32 v[170:171], v[170:171], v[178:179], v[178:179] op_sel:[0,0,1] op_sel_hi:[1,0,1]
    v_pk_fma_f32 v[172:173], v[172:173], v[178:179], v[178:179] op_sel:[0,0,1] op_sel_hi:[1,0,1]
    v_pk_fma_f32 v[174:175], v[174:175], v[178:179], v[178:179] op_sel:[0,0,1] op_sel_hi:[1,0,1]
    v_xor_b32_e64 v6, 64, v55
    s_xor_b32 s82, s90, 4
    s_mul_i32 s82, s82, 88064
    s_add_u32 s82, s82, 1376
    s_add_u32 m0, s84, 49152
    s_nop 0
    buffer_load_dwordx4 v48, s[16:19], s82 offen offset:0 lds
    v_cvt_pk_bf16_f32 v196, v168, v169
    v_cvt_pk_bf16_f32 v197, v170, v171
    v_cvt_pk_bf16_f32 v198, v172, v173
    v_cvt_pk_bf16_f32 v199, v174, v175
    ds_write_b128 v6, v[196:199]
    v_lshlrev_b32 v168, 16, v200
    v_and_b32 v169, s62, v200
    v_lshlrev_b32 v170, 16, v201
    v_and_b32 v171, s62, v201
    v_lshlrev_b32 v172, 16, v202
    v_and_b32 v173, s62, v202
    v_lshlrev_b32 v174, 16, v203
    v_and_b32 v175, s62, v203
    v_pk_fma_f32 v[168:169], v[168:169], v[178:179], v[178:179] op_sel:[0,0,1] op_sel_hi:[1,0,1]
    v_pk_fma_f32 v[170:171], v[170:171], v[178:179], v[178:179] op_sel:[0,0,1] op_sel_hi:[1,0,1]
    v_pk_fma_f32 v[172:173], v[172:173], v[178:179], v[178:179] op_sel:[0,0,1] op_sel_hi:[1,0,1]
    v_pk_fma_f32 v[174:175], v[174:175], v[178:179], v[178:179] op_sel:[0,0,1] op_sel_hi:[1,0,1]
    v_xor_b32 v5, 128, v55
    v_cvt_pk_bf16_f32 v200, v168, v169
    v_cvt_pk_bf16_f32 v201, v170, v171
    v_cvt_pk_bf16_f32 v202, v172, v173
    v_cvt_pk_bf16_f32 v203, v174, v175
    ds_write_b128 v5, v[200:203]
    v_lshlrev_b32 v168, 16, v204
    v_and_b32 v169, s62, v204
    v_lshlrev_b32 v170, 16, v205
    v_and_b32 v171, s62, v205
    v_lshlrev_b32 v172, 16, v206
    v_and_b32 v173, s62, v206
    v_lshlrev_b32 v174, 16, v207
    v_and_b32 v175, s62, v207
    v_pk_fma_f32 v[168:169], v[168:169], v[178:179], v[178:179] op_sel:[0,0,1] op_sel_hi:[1,0,1]
    v_pk_fma_f32 v[170:171], v[170:171], v[178:179], v[178:179] op_sel:[0,0,1] op_sel_hi:[1,0,1]
    v_pk_fma_f32 v[172:173], v[172:173], v[178:179], v[178:179] op_sel:[0,0,1] op_sel_hi:[1,0,1]
    v_pk_fma_f32 v[174:175], v[174:175], v[178:179], v[178:179] op_sel:[0,0,1] op_sel_hi:[1,0,1]
    v_xor_b32 v6, 192, v55
    v_cvt_pk_bf16_f32 v204, v168, v169
    v_cvt_pk_bf16_f32 v205, v170, v171
    v_cvt_pk_bf16_f32 v206, v172, v173
    v_cvt_pk_bf16_f32 v207, v174, v175
    ds_write_b128 v6, v[204:207]
    v_lshlrev_b32 v168, 16, v208
    v_and_b32 v169, s62, v208
    v_lshlrev_b32 v170, 16, v209
    v_and_b32 v171, s62, v209
    v_lshlrev_b32_e64 v172, 16, v210
    buffer_load_dwordx4 v49, s[16:19], s82 offen offset:1024 lds
    v_and_b32 v173, s62, v210
    v_lshlrev_b32 v174, 16, v211
    v_and_b32_e64 v175, s62, v211
    v_pk_fma_f32 v[168:169], v[168:169], v[178:179], v[178:179] op_sel:[0,0,1] op_sel_hi:[1,0,1]
    v_pk_fma_f32 v[170:171], v[170:171], v[178:179], v[178:179] op_sel:[0,0,1] op_sel_hi:[1,0,1]
    v_pk_fma_f32 v[172:173], v[172:173], v[178:179], v[178:179] op_sel:[0,0,1] op_sel_hi:[1,0,1]
    v_pk_fma_f32 v[174:175], v[174:175], v[178:179], v[178:179] op_sel:[0,0,1] op_sel_hi:[1,0,1]
    v_xor_b32 v5, 256, v55
    v_cvt_pk_bf16_f32 v208, v168, v169
    v_cvt_pk_bf16_f32 v209, v170, v171
    v_cvt_pk_bf16_f32 v210, v172, v173
    v_cvt_pk_bf16_f32 v211, v174, v175
    ds_write_b128 v5, v[208:211]
    v_lshlrev_b32 v168, 16, v212
    v_and_b32 v169, s62, v212
    v_lshlrev_b32 v170, 16, v213
    v_and_b32 v171, s62, v213
    v_lshlrev_b32 v172, 16, v214
    v_and_b32 v173, s62, v214
    v_lshlrev_b32 v174, 16, v215
    v_and_b32 v175, s62, v215
    v_pk_fma_f32 v[168:169], v[168:169], v[178:179], v[178:179] op_sel:[0,0,1] op_sel_hi:[1,0,1]
    v_pk_fma_f32 v[170:171], v[170:171], v[178:179], v[178:179] op_sel:[0,0,1] op_sel_hi:[1,0,1]
    v_pk_fma_f32 v[172:173], v[172:173], v[178:179], v[178:179] op_sel:[0,0,1] op_sel_hi:[1,0,1]
    v_pk_fma_f32 v[174:175], v[174:175], v[178:179], v[178:179] op_sel:[0,0,1] op_sel_hi:[1,0,1]
    v_xor_b32 v6, 320, v55
    v_cvt_pk_bf16_f32 v212, v168, v169
    v_cvt_pk_bf16_f32 v213, v170, v171
    v_cvt_pk_bf16_f32 v214, v172, v173
    v_cvt_pk_bf16_f32 v215, v174, v175
    ds_write_b128 v6, v[212:215]
    v_lshlrev_b32 v168, 16, v216
    v_and_b32 v169, s62, v216
    v_lshlrev_b32 v170, 16, v217
    v_and_b32 v171, s62, v217
    v_lshlrev_b32 v172, 16, v218
    v_and_b32 v173, s62, v218
    v_lshlrev_b32 v174, 16, v219
    v_and_b32 v175, s62, v219
    v_pk_fma_f32 v[168:169], v[168:169], v[178:179], v[178:179] op_sel:[0,0,1] op_sel_hi:[1,0,1]
    v_pk_fma_f32 v[170:171], v[170:171], v[178:179], v[178:179] op_sel:[0,0,1] op_sel_hi:[1,0,1]
    v_pk_fma_f32 v[172:173], v[172:173], v[178:179], v[178:179] op_sel:[0,0,1] op_sel_hi:[1,0,1]
    v_pk_fma_f32 v[174:175], v[174:175], v[178:179], v[178:179] op_sel:[0,0,1] op_sel_hi:[1,0,1]
    v_xor_b32 v5, 384, v55
    v_cvt_pk_bf16_f32 v216, v168, v169
    v_cvt_pk_bf16_f32 v217, v170, v171
    buffer_load_dwordx4 v50, s[16:19], s82 offen offset:2048 lds
    v_cvt_pk_bf16_f32 v218, v172, v173
    v_cvt_pk_bf16_f32 v219, v174, v175
    ds_write_b128 v5, v[216:219]
    v_lshlrev_b32 v168, 16, v220
    v_and_b32 v169, s62, v220
    v_lshlrev_b32 v170, 16, v221
    v_and_b32 v171, s62, v221
    v_lshlrev_b32 v172, 16, v222
    v_and_b32 v173, s62, v222
    v_lshlrev_b32 v174, 16, v223
    v_and_b32 v175, s62, v223
    v_pk_fma_f32 v[168:169], v[168:169], v[178:179], v[178:179] op_sel:[0,0,1] op_sel_hi:[1,0,1]
    v_pk_fma_f32 v[170:171], v[170:171], v[178:179], v[178:179] op_sel:[0,0,1] op_sel_hi:[1,0,1]
    v_pk_fma_f32 v[172:173], v[172:173], v[178:179], v[178:179] op_sel:[0,0,1] op_sel_hi:[1,0,1]
    v_pk_fma_f32 v[174:175], v[174:175], v[178:179], v[178:179] op_sel:[0,0,1] op_sel_hi:[1,0,1]
    v_xor_b32 v6, 448, v55
    v_cvt_pk_bf16_f32 v220, v168, v169
    v_cvt_pk_bf16_f32 v221, v170, v171
    v_cvt_pk_bf16_f32 v222, v172, v173
    v_cvt_pk_bf16_f32 v223, v174, v175
    ds_write_b128 v6, v[220:223]
    v_lshlrev_b32 v168, 16, v224
    v_and_b32 v169, s62, v224
    v_lshlrev_b32 v170, 16, v225
    v_and_b32 v171, s62, v225
    v_lshlrev_b32 v172, 16, v226
    v_and_b32 v173, s62, v226
    v_lshlrev_b32 v174, 16, v227
    v_and_b32 v175, s62, v227
    v_pk_fma_f32 v[168:169], v[168:169], v[178:179], v[178:179] op_sel:[0,0,1] op_sel_hi:[1,0,1]
    v_pk_fma_f32 v[170:171], v[170:171], v[178:179], v[178:179] op_sel:[0,0,1] op_sel_hi:[1,0,1]
    v_pk_fma_f32 v[172:173], v[172:173], v[178:179], v[178:179] op_sel:[0,0,1] op_sel_hi:[1,0,1]
    v_pk_fma_f32 v[174:175], v[174:175], v[178:179], v[178:179] op_sel:[0,0,1] op_sel_hi:[1,0,1]
    v_xor_b32 v5, 512, v55
    v_cvt_pk_bf16_f32 v224, v168, v169
    v_cvt_pk_bf16_f32 v225, v170, v171
    v_cvt_pk_bf16_f32 v226, v172, v173
    v_cvt_pk_bf16_f32 v227, v174, v175
    ds_write_b128 v5, v[224:227]
    v_lshlrev_b32 v168, 16, v228
    v_and_b32 v169, s62, v228
    v_lshlrev_b32 v170, 16, v229
    v_and_b32 v171, s62, v229
    v_lshlrev_b32 v172, 16, v230
    v_and_b32 v173, s62, v230
    v_lshlrev_b32 v174, 16, v231
    s_xor_b32 s82, s90, 6
    s_mul_i32 s82, s82, 88064
    s_add_u32 s82, s82, 1376
    s_add_u32 m0, s84, 61440
    s_nop 0
    buffer_load_dwordx4 v48, s[16:19], s82 offen offset:0 lds
    v_and_b32 v175, s62, v231
    v_pk_fma_f32 v[168:169], v[168:169], v[178:179], v[178:179] op_sel:[0,0,1] op_sel_hi:[1,0,1]
    v_pk_fma_f32 v[170:171], v[170:171], v[178:179], v[178:179] op_sel:[0,0,1] op_sel_hi:[1,0,1]
    v_pk_fma_f32 v[172:173], v[172:173], v[178:179], v[178:179] op_sel:[0,0,1] op_sel_hi:[1,0,1]
    v_pk_fma_f32 v[174:175], v[174:175], v[178:179], v[178:179] op_sel:[0,0,1] op_sel_hi:[1,0,1]
    v_xor_b32 v6, 576, v55
    v_cvt_pk_bf16_f32 v228, v168, v169
    v_cvt_pk_bf16_f32 v229, v170, v171
    v_cvt_pk_bf16_f32 v230, v172, v173
    v_cvt_pk_bf16_f32 v231, v174, v175
    ds_write_b128 v6, v[228:231]
    v_lshlrev_b32 v168, 16, v232
    v_and_b32 v169, s62, v232
    v_lshlrev_b32 v170, 16, v233
    v_and_b32 v171, s62, v233
    v_lshlrev_b32 v172, 16, v234
    v_and_b32 v173, s62, v234
    v_lshlrev_b32 v174, 16, v235
    v_and_b32 v175, s62, v235
    v_pk_fma_f32 v[168:169], v[168:169], v[178:179], v[178:179] op_sel:[0,0,1] op_sel_hi:[1,0,1]
    v_pk_fma_f32 v[170:171], v[170:171], v[178:179], v[178:179] op_sel:[0,0,1] op_sel_hi:[1,0,1]
    v_pk_fma_f32 v[172:173], v[172:173], v[178:179], v[178:179] op_sel:[0,0,1] op_sel_hi:[1,0,1]
    v_pk_fma_f32 v[174:175], v[174:175], v[178:179], v[178:179] op_sel:[0,0,1] op_sel_hi:[1,0,1]
    v_xor_b32 v5, 640, v55
    v_cvt_pk_bf16_f32 v232, v168, v169
    v_cvt_pk_bf16_f32 v233, v170, v171
    v_cvt_pk_bf16_f32 v234, v172, v173
    v_cvt_pk_bf16_f32 v235, v174, v175
    ds_write_b128 v5, v[232:235]
    v_lshlrev_b32 v168, 16, v236
    v_and_b32 v169, s62, v236
    v_lshlrev_b32 v170, 16, v237
    v_and_b32 v171, s62, v237
    v_lshlrev_b32 v172, 16, v238
    v_and_b32 v173, s62, v238
    v_lshlrev_b32 v174, 16, v239
    v_and_b32 v175, s62, v239
    v_pk_fma_f32 v[168:169], v[168:169], v[178:179], v[178:179] op_sel:[0,0,1] op_sel_hi:[1,0,1]
    v_pk_fma_f32 v[170:171], v[170:171], v[178:179], v[178:179] op_sel:[0,0,1] op_sel_hi:[1,0,1]
    v_pk_fma_f32 v[172:173], v[172:173], v[178:179], v[178:179] op_sel:[0,0,1] op_sel_hi:[1,0,1]
    v_pk_fma_f32 v[174:175], v[174:175], v[178:179], v[178:179] op_sel:[0,0,1] op_sel_hi:[1,0,1]
    v_xor_b32 v6, 704, v55
    v_cvt_pk_bf16_f32 v236, v168, v169
    v_cvt_pk_bf16_f32 v237, v170, v171
    v_cvt_pk_bf16_f32 v238, v172, v173
    v_cvt_pk_bf16_f32 v239, v174, v175
    buffer_load_dwordx4 v49, s[16:19], s82 offen offset:1024 lds
    ds_write_b128 v6, v[236:239]
    v_lshlrev_b32 v168, 16, v240
    v_and_b32 v169, s62, v240
    v_lshlrev_b32 v170, 16, v241
    v_and_b32 v171, s62, v241
    v_lshlrev_b32 v172, 16, v242
    v_and_b32 v173, s62, v242
    v_lshlrev_b32 v174, 16, v243
    v_and_b32 v175, s62, v243
    v_pk_fma_f32 v[168:169], v[168:169], v[178:179], v[178:179] op_sel:[0,0,1] op_sel_hi:[1,0,1]
    v_pk_fma_f32 v[170:171], v[170:171], v[178:179], v[178:179] op_sel:[0,0,1] op_sel_hi:[1,0,1]
    v_pk_fma_f32 v[172:173], v[172:173], v[178:179], v[178:179] op_sel:[0,0,1] op_sel_hi:[1,0,1]
    v_pk_fma_f32 v[174:175], v[174:175], v[178:179], v[178:179] op_sel:[0,0,1] op_sel_hi:[1,0,1]
    v_xor_b32 v5, 768, v55
    v_cvt_pk_bf16_f32 v240, v168, v169
    v_cvt_pk_bf16_f32 v241, v170, v171
    v_cvt_pk_bf16_f32 v242, v172, v173
    v_cvt_pk_bf16_f32 v243, v174, v175
    ds_write_b128 v5, v[240:243]
    v_lshlrev_b32 v168, 16, v244
    v_and_b32 v169, s62, v244
    v_lshlrev_b32 v170, 16, v245
    v_and_b32 v171, s62, v245
    v_lshlrev_b32 v172, 16, v246
    v_and_b32 v173, s62, v246
    v_lshlrev_b32 v174, 16, v247
    v_and_b32 v175, s62, v247
    v_pk_fma_f32 v[168:169], v[168:169], v[178:179], v[178:179] op_sel:[0,0,1] op_sel_hi:[1,0,1]
    v_pk_fma_f32 v[170:171], v[170:171], v[178:179], v[178:179] op_sel:[0,0,1] op_sel_hi:[1,0,1]
    v_pk_fma_f32 v[172:173], v[172:173], v[178:179], v[178:179] op_sel:[0,0,1] op_sel_hi:[1,0,1]
    v_pk_fma_f32 v[174:175], v[174:175], v[178:179], v[178:179] op_sel:[0,0,1] op_sel_hi:[1,0,1]
    v_xor_b32 v6, 832, v55
    v_cvt_pk_bf16_f32 v244, v168, v169
    v_cvt_pk_bf16_f32 v245, v170, v171
    v_cvt_pk_bf16_f32 v246, v172, v173
    v_cvt_pk_bf16_f32 v247, v174, v175
    ds_write_b128 v6, v[244:247]
    v_lshlrev_b32 v168, 16, v248
    v_and_b32 v169, s62, v248
    v_lshlrev_b32 v170, 16, v249
    v_and_b32 v171, s62, v249
    v_lshlrev_b32 v172, 16, v250
    v_and_b32 v173, s62, v250
    v_lshlrev_b32 v174, 16, v251
    v_and_b32 v175, s62, v251
    v_pk_fma_f32 v[168:169], v[168:169], v[178:179], v[178:179] op_sel:[0,0,1] op_sel_hi:[1,0,1]
    buffer_load_dwordx4 v50, s[16:19], s82 offen offset:2048 lds
    v_pk_fma_f32 v[170:171], v[170:171], v[178:179], v[178:179] op_sel:[0,0,1] op_sel_hi:[1,0,1]
    v_pk_fma_f32 v[172:173], v[172:173], v[178:179], v[178:179] op_sel:[0,0,1] op_sel_hi:[1,0,1]
    v_pk_fma_f32 v[174:175], v[174:175], v[178:179], v[178:179] op_sel:[0,0,1] op_sel_hi:[1,0,1]
    v_xor_b32 v5, 896, v55
    v_cvt_pk_bf16_f32 v248, v168, v169
    v_cvt_pk_bf16_f32 v249, v170, v171
    v_cvt_pk_bf16_f32 v250, v172, v173
    v_cvt_pk_bf16_f32 v251, v174, v175
    ds_write_b128 v5, v[248:251]
    v_lshlrev_b32 v168, 16, v252
    v_and_b32 v169, s62, v252
    v_lshlrev_b32 v170, 16, v253
    v_and_b32 v171, s62, v253
    v_lshlrev_b32 v172, 16, v254
    v_and_b32 v173, s62, v254
    v_lshlrev_b32 v174, 16, v255
    v_and_b32 v175, s62, v255
    v_pk_fma_f32 v[168:169], v[168:169], v[178:179], v[178:179] op_sel:[0,0,1] op_sel_hi:[1,0,1]
    v_pk_fma_f32 v[170:171], v[170:171], v[178:179], v[178:179] op_sel:[0,0,1] op_sel_hi:[1,0,1]
    v_pk_fma_f32 v[172:173], v[172:173], v[178:179], v[178:179] op_sel:[0,0,1] op_sel_hi:[1,0,1]
    v_pk_fma_f32 v[174:175], v[174:175], v[178:179], v[178:179] op_sel:[0,0,1] op_sel_hi:[1,0,1]
    v_xor_b32 v6, 960, v55
    v_cvt_pk_bf16_f32 v252, v168, v169
    v_cvt_pk_bf16_f32 v253, v170, v171
    v_cvt_pk_bf16_f32 v254, v172, v173
    v_cvt_pk_bf16_f32 v255, v174, v175
    ds_write_b128 v6, v[252:255]
    v_mov_b32_e64 v45, 0
    v_mov_b32 v66, v51
    s_waitcnt lgkmcnt(0)
    s_waitcnt vmcnt(9)
    s_barrier
    ds_read_b128 a[0:3], v66
    v_xor_b32_e64 v67, 32, v51
    ds_read_b64_tr_b16 v[212:213], v56 offset:24576
    ds_read_b64_tr_b16 v[214:215], v56 offset:25344
    ds_read_b64_tr_b16 v[216:217], v57 offset:24576
    ds_read_b64_tr_b16 v[218:219], v57 offset:25344
    ds_read_b128 a[4:7], v67
    v_xor_b32_e64 v66, 64, v51
    ds_read_b64_tr_b16 v[220:221], v56 offset:27648
    ds_read_b64_tr_b16 v[222:223], v56 offset:28416
    ds_read_b64_tr_b16 v[224:225], v57 offset:27648
    ds_read_b64_tr_b16 v[226:227], v57 offset:28416
    s_waitcnt lgkmcnt(5)
    v_mfma_f32_32x32x16_bf16 v[152:167], v[212:215], a[0:3], 0
    s_xor_b32 s82, s90, 8
    s_mul_i32 s82, s82, 88064
    s_add_u32 s82, s82, 1376
    s_add_u32 m0, s84, 73728
    ds_read_b128 a[8:11], v66
    buffer_load_dwordx4 v48, s[16:19], s82 offen offset:0 lds
    v_xor_b32 v67, 96, v51
    ds_read_b64_tr_b16 v[228:229], v56 offset:30720
    v_bfe_u32 v5, v1, 4, 2
    v_mfma_f32_32x32x16_bf16 v[168:183], v[216:219], a[0:3], 0
    ds_read_b64_tr_b16 v[230:231], v56 offset:31488
    buffer_load_dwordx4 v49, s[16:19], s82 offen offset:1024 lds
    ds_read_b64_tr_b16 v[232:233], v57 offset:30720
    ds_read_b64_tr_b16 v[234:235], v57 offset:31488
    v_lshlrev_b32 v5, 0, v5
    s_waitcnt lgkmcnt(5)
    v_mfma_f32_32x32x16_bf16 v[152:167], v[220:223], a[4:7], v[152:167]
    ds_read_b128 a[12:15], v67
    buffer_load_dwordx4 v50, s[16:19], s82 offen offset:2048 lds
    v_xor_b32 v66, 128, v51
    ds_read_b64_tr_b16 v[212:213], v56 offset:33792
    v_and_b32 v6, 7, v1
    v_mfma_f32_32x32x16_bf16 v[168:183], v[224:227], a[4:7], v[168:183]
    s_xor_b32 s82, s90, 10
    s_mul_i32 s82, s82, 88064
    s_add_u32 s82, s82, 1376
    s_add_u32 m0, s84, 86016
    ds_read_b64_tr_b16 v[214:215], v56 offset:34560
    buffer_load_dwordx4 v48, s[16:19], s82 offen offset:0 lds
    ds_read_b64_tr_b16 v[216:217], v57 offset:33792
    ds_read_b64_tr_b16 v[218:219], v57 offset:34560
    v_xor_b32 v5, v5, v6
    s_waitcnt vmcnt(10)
    s_barrier
    s_waitcnt lgkmcnt(5)
    v_mfma_f32_32x32x16_bf16 v[152:167], v[228:231], a[8:11], v[152:167]
    ds_read_b128 a[16:19], v66
    buffer_load_dwordx4 v49, s[16:19], s82 offen offset:1024 lds
    v_xor_b32 v67, 160, v51
    ds_read_b64_tr_b16 v[220:221], v56 offset:36864
    v_bfe_u32 v4, v1, 3, 3
    v_mfma_f32_32x32x16_bf16 v[168:183], v[232:235], a[8:11], v[168:183]
    ds_read_b64_tr_b16 v[222:223], v56 offset:37632
    buffer_load_dwordx4 v50, s[16:19], s82 offen offset:2048 lds
    ds_read_b64_tr_b16 v[224:225], v57 offset:36864
    ds_read_b64_tr_b16 v[226:227], v57 offset:37632
    v_lshlrev_b32 v4, 12, v4
    s_waitcnt lgkmcnt(5)
    v_mfma_f32_32x32x16_bf16 v[152:167], v[212:215], a[12:15], v[152:167]
    s_xor_b32 s82, s90, 12
    s_mul_i32 s82, s82, 88064
    s_add_u32 s82, s82, 1376
    s_add_u32 m0, s84, 0
    ds_read_b128 a[20:23], v67
    buffer_load_dwordx4 v48, s[16:19], s82 offen offset:0 lds
    v_xor_b32 v66, 192, v51
    ds_read_b64_tr_b16 v[228:229], v56 offset:39936
    v_lshl_add_u32 v34, v5, 4, v4
    v_mfma_f32_32x32x16_bf16 v[168:183], v[216:219], a[12:15], v[168:183]
    ds_read_b64_tr_b16 v[230:231], v56 offset:40704
    buffer_load_dwordx4 v49, s[16:19], s82 offen offset:1024 lds
    ds_read_b64_tr_b16 v[232:233], v57 offset:39936
    ds_read_b64_tr_b16 v[234:235], v57 offset:40704
    v_xor_b32 v35, 64, v34
    s_waitcnt lgkmcnt(5)
    v_mfma_f32_32x32x16_bf16 v[152:167], v[220:223], a[16:19], v[152:167]
    ds_read_b128 a[24:27], v66
    buffer_load_dwordx4 v50, s[16:19], s82 offen offset:2048 lds
    v_xor_b32 v67, 224, v51
    ds_read_b64_tr_b16 v[212:213], v56 offset:43008
    s_lshl_b32 s59, s4, 18
    v_mfma_f32_32x32x16_bf16 v[168:183], v[224:227], a[16:19], v[168:183]
    s_xor_b32 s82, s90, 14
    s_mul_i32 s82, s82, 88064
    s_add_u32 s82, s82, 1376
    s_add_u32 m0, s84, 12288
    ds_read_b64_tr_b16 v[214:215], v56 offset:43776
    buffer_load_dwordx4 v48, s[16:19], s82 offen offset:0 lds
    ds_read_b64_tr_b16 v[216:217], v57 offset:43008
    ds_read_b64_tr_b16 v[218:219], v57 offset:43776
    s_sub_u32 s59, 35840, s59
    s_waitcnt lgkmcnt(5)
    v_mfma_f32_32x32x16_bf16 v[152:167], v[228:231], a[20:23], v[152:167]
    ds_read_b128 a[28:31], v67
    buffer_load_dwordx4 v49, s[16:19], s82 offen offset:1024 lds
    v_xor_b32 v66, 256, v51
    ds_read_b64_tr_b16 v[220:221], v56 offset:46080
    s_lshl_b32 s57, s6, 18
    v_mfma_f32_32x32x16_bf16 v[168:183], v[232:235], a[20:23], v[168:183]
    ds_read_b64_tr_b16 v[222:223], v56 offset:46848
    buffer_load_dwordx4 v50, s[16:19], s82 offen offset:2048 lds
    ds_read_b64_tr_b16 v[224:225], v57 offset:46080
    ds_read_b64_tr_b16 v[226:227], v57 offset:46848
    s_lshl_b32 s81, s3, 10
    s_waitcnt vmcnt(15)
    s_barrier
    s_waitcnt lgkmcnt(5)
    v_mfma_f32_32x32x16_bf16 v[152:167], v[212:215], a[24:27], v[152:167]
    ds_read_b128 a[32:35], v66
    buffer_load_dwordx2 v[10:11], v64, s[8:11], 0 offen offset:0
    v_xor_b32 v67, 288, v51
    ds_read_b64_tr_b16 v[228:229], v56 offset:49152
    s_add_u32 s57, s57, s81
    v_mfma_f32_32x32x16_bf16 v[168:183], v[216:219], a[24:27], v[168:183]
    ds_read_b64_tr_b16 v[230:231], v56 offset:49920
    buffer_load_dwordx2 v[12:13], v64, s[8:11], 0 offen offset:32
    ds_read_b64_tr_b16 v[232:233], v57 offset:49152
    ds_read_b64_tr_b16 v[234:235], v57 offset:49920
    s_lshl_b32 s81, s4, 17
    s_waitcnt lgkmcnt(5)
    v_mfma_f32_32x32x16_bf16 v[152:167], v[220:223], a[28:31], v[152:167]
    ds_read_b128 a[36:39], v67
    buffer_load_dwordx2 v[14:15], v64, s[8:11], 0 offen offset:64
    v_xor_b32 v66, 320, v51
    ds_read_b64_tr_b16 v[212:213], v56 offset:52224
    s_add_u32 s57, s57, s81
    v_mfma_f32_32x32x16_bf16 v[168:183], v[224:227], a[28:31], v[168:183]
    ds_read_b64_tr_b16 v[214:215], v56 offset:52992
    buffer_load_dwordx2 v[16:17], v64, s[8:11], 0 offen offset:96
    ds_read_b64_tr_b16 v[216:217], v57 offset:52224
    ds_read_b64_tr_b16 v[218:219], v57 offset:52992
    s_lshl_b32 s58, s3, 13
    s_waitcnt lgkmcnt(5)
    v_mfma_f32_32x32x16_bf16 v[152:167], v[228:231], a[32:35], v[152:167]
    ds_read_b128 a[40:43], v66
    buffer_load_dword v55, v45, s[48:51], 0 offen sc1
    v_xor_b32 v67, 352, v51
    ds_read_b64_tr_b16 v[220:221], v56 offset:55296
    s_mul_i32 s60, s3, 6144
    v_mfma_f32_32x32x16_bf16 v[168:183], v[232:235], a[32:35], v[168:183]
    ds_read_b64_tr_b16 v[222:223], v56 offset:56064
    buffer_load_ushort v248, v62, s[40:43], 0 offen offset:0
    ds_read_b64_tr_b16 v[224:225], v57 offset:55296
    ds_read_b64_tr_b16 v[226:227], v57 offset:56064
    v_bfe_u32 v5, v1, 1, 3
    s_waitcnt lgkmcnt(5)
    v_mfma_f32_32x32x16_bf16 v[152:167], v[212:215], a[36:39], v[152:167]
    ds_read_b128 a[44:47], v67
    buffer_load_short_d16_hi v249, v62, s[40:43], 0 offen offset:32
    v_xor_b32 v66, 384, v51
    ds_read_b64_tr_b16 v[228:229], v58 offset:9216
    v_lshlrev_b32 v5, 0, v5
    v_mfma_f32_32x32x16_bf16 v[168:183], v[216:219], a[36:39], v[168:183]
    ds_read_b64_tr_b16 v[230:231], v58 offset:9984
    buffer_load_ushort v250, v62, s[40:43], 0 offen offset:64
    ds_read_b64_tr_b16 v[232:233], v59 offset:9216
    ds_read_b64_tr_b16 v[234:235], v59 offset:9984
    v_bfe_u32 v6, v1, 5, 1
    s_waitcnt vmcnt(20)
    s_barrier
    s_waitcnt lgkmcnt(5)
    v_mfma_f32_32x32x16_bf16 v[152:167], v[220:223], a[40:43], v[152:167]
    ds_read_b128 a[48:51], v66
    buffer_load_short_d16_hi v251, v62, s[40:43], 0 offen offset:96
    v_xor_b32 v67, 416, v51
    ds_read_b64_tr_b16 v[212:213], v58 offset:12288
    v_lshlrev_b32 v6, 0, v6
    v_mfma_f32_32x32x16_bf16 v[168:183], v[224:227], a[40:43], v[168:183]
    ds_read_b64_tr_b16 v[214:215], v58 offset:13056
    buffer_load_ushort v252, v62, s[40:43], 0 offen offset:256
    ds_read_b64_tr_b16 v[216:217], v59 offset:12288
    ds_read_b64_tr_b16 v[218:219], v59 offset:13056
    v_xor_b32 v5, v5, v6
    s_waitcnt lgkmcnt(5)
    v_mfma_f32_32x32x16_bf16 v[152:167], v[228:231], a[44:47], v[152:167]
    ds_read_b128 a[52:55], v67
    buffer_load_short_d16_hi v253, v62, s[40:43], 0 offen offset:288
    v_xor_b32 v66, 448, v51
    ds_read_b64_tr_b16 v[220:221], v58 offset:15360
    v_bfe_u32 v41, v1, 0, 5
    v_mfma_f32_32x32x16_bf16 v[168:183], v[232:235], a[44:47], v[168:183]
    ds_read_b64_tr_b16 v[222:223], v58 offset:16128
    buffer_load_ushort v254, v62, s[40:43], 0 offen offset:320
    ds_read_b64_tr_b16 v[224:225], v59 offset:15360
    ds_read_b64_tr_b16 v[226:227], v59 offset:16128
    v_lshlrev_b32 v41, 7, v41
    s_waitcnt lgkmcnt(5)
    v_mfma_f32_32x32x16_bf16 v[152:167], v[212:215], a[48:51], v[152:167]
    ds_read_b128 a[56:59], v66
    buffer_load_short_d16_hi v255, v62, s[40:43], 0 offen offset:352
    v_xor_b32 v67, 480, v51
    ds_read_b64_tr_b16 v[228:229], v58 offset:18432
    v_add_u32_e64 v41, s58, v41
    v_mfma_f32_32x32x16_bf16 v[168:183], v[216:219], a[48:51], v[168:183]
    ds_read_b64_tr_b16 v[230:231], v58 offset:19200
    buffer_load_short_d16_hi v30, v63, s[44:47], 0 offen
    ds_read_b64_tr_b16 v[232:233], v59 offset:18432
    ds_read_b64_tr_b16 v[234:235], v59 offset:19200
    v_lshl_add_u32 v41, v5, 4, v41
    s_waitcnt lgkmcnt(5)
    v_mfma_f32_32x32x16_bf16 v[152:167], v[220:223], a[52:55], v[152:167]
    s_xor_b32 s82, s90, 0
    s_mul_i32 s82, s82, 98304
    s_add_u32 m0, s84, 24576
    ds_read_b128 a[60:63], v67
    buffer_load_dwordx4 v52, s[12:15], s82 offen offset:0 lds
    v_xor_b32 v66, 512, v51
    ds_read_b64_tr_b16 v[212:213], v58 offset:21504
    v_bfe_u32 v187, v1, 0, 5
    v_mfma_f32_32x32x16_bf16 v[168:183], v[224:227], a[52:55], v[168:183]
    ds_read_b64_tr_b16 v[214:215], v58 offset:22272
    buffer_load_dwordx4 v53, s[12:15], s82 offen offset:1024 lds
    ds_read_b64_tr_b16 v[216:217], v59 offset:21504
    ds_read_b64_tr_b16 v[218:219], v59 offset:22272
    v_lshlrev_b32 v187, 6, v187
    s_waitcnt vmcnt(25)
    s_barrier
    s_waitcnt lgkmcnt(5)
    v_mfma_f32_32x32x16_bf16 v[152:167], v[228:231], a[56:59], v[152:167]
    ds_read_b128 a[64:67], v66
    buffer_load_dwordx4 v54, s[12:15], s82 offen offset:2048 lds
    v_xor_b32 v67, 544, v51
    ds_read_b64_tr_b16 v[220:221], v58 offset:24576
    v_add_u32_e64 v187, s60, v187
    v_mfma_f32_32x32x16_bf16 v[168:183], v[232:235], a[56:59], v[168:183]
    s_xor_b32 s82, s90, 1
    s_mul_i32 s82, s82, 98304
    s_add_u32 m0, s84, 36864
    ds_read_b64_tr_b16 v[222:223], v58 offset:25344
    buffer_load_dwordx4 v52, s[12:15], s82 offen offset:0 lds
    ds_read_b64_tr_b16 v[224:225], v59 offset:24576
    ds_read_b64_tr_b16 v[226:227], v59 offset:25344
    v_lshl_add_u32 v187, v5, 3, v187
    s_waitcnt lgkmcnt(5)
    v_mfma_f32_32x32x16_bf16 v[152:167], v[212:215], a[60:63], v[152:167]
    ds_read_b128 a[68:71], v67
    buffer_load_dwordx4 v53, s[12:15], s82 offen offset:1024 lds
    v_xor_b32 v66, 576, v51
    ds_read_b64_tr_b16 v[228:229], v58 offset:27648
    v_bfe_u32 v184, v1, 0, 5
    v_mfma_f32_32x32x16_bf16 v[168:183], v[216:219], a[60:63], v[168:183]
    ds_read_b64_tr_b16 v[230:231], v58 offset:28416
    buffer_load_dwordx4 v54, s[12:15], s82 offen offset:2048 lds
    ds_read_b64_tr_b16 v[232:233], v59 offset:27648
    ds_read_b64_tr_b16 v[234:235], v59 offset:28416
    v_mul_u32_u24 v184, 104, v184
    s_waitcnt lgkmcnt(5)
    v_mfma_f32_32x32x16_bf16 v[152:167], v[220:223], a[64:67], v[152:167]
    s_xor_b32 s82, s90, 2
    s_mul_i32 s82, s82, 98304
    s_add_u32 m0, s84, 49152
    ds_read_b128 a[72:75], v66
    buffer_load_dwordx4 v52, s[12:15], s82 offen offset:0 lds
    v_xor_b32 v67, 608, v51
    ds_read_b64_tr_b16 v[212:213], v58 offset:30720
    v_bfe_u32 v2, v1, 5, 1
    v_mfma_f32_32x32x16_bf16 v[168:183], v[224:227], a[64:67], v[168:183]
    ds_read_b64_tr_b16 v[214:215], v58 offset:31488
    buffer_load_dwordx4 v53, s[12:15], s82 offen offset:1024 lds
    ds_read_b64_tr_b16 v[216:217], v59 offset:30720
    ds_read_b64_tr_b16 v[218:219], v59 offset:31488
    v_lshl_add_u32 v184, v2, 3, v184
    s_waitcnt lgkmcnt(5)
    v_mfma_f32_32x32x16_bf16 v[152:167], v[228:231], a[68:71], v[152:167]
    ds_read_b128 a[76:79], v67
    buffer_load_dwordx4 v54, s[12:15], s82 offen offset:2048 lds
    v_xor_b32 v66, 640, v51
    ds_read_b64_tr_b16 v[220:221], v58 offset:33792
    v_add_u32 v184, s60, v184
    v_mfma_f32_32x32x16_bf16 v[168:183], v[232:235], a[68:71], v[168:183]
    ds_read_b64_tr_b16 v[222:223], v58 offset:34560
    ds_read_b64_tr_b16 v[224:225], v59 offset:33792
    ds_read_b64_tr_b16 v[226:227], v59 offset:34560
    v_bfe_u32 v185, v1, 4, 2
    v_mul_u32_u24 v185, 832, v185
    s_waitcnt vmcnt(29)
    s_barrier
    s_waitcnt lgkmcnt(5)
    v_mfma_f32_32x32x16_bf16 v[152:167], v[212:215], a[72:75], v[152:167]
    s_xor_b32 s82, s90, 3
    s_mul_i32 s82, s82, 98304
    s_add_u32 m0, s84, 61440
    ds_read_b128 a[80:83], v66
    buffer_load_dwordx4 v52, s[12:15], s82 offen offset:0 lds
    v_xor_b32 v67, 672, v51
    ds_read_b64_tr_b16 v[228:229], v58 offset:36864
    v_bfe_u32 v2, v1, 2, 2
    v_mfma_f32_32x32x16_bf16 v[168:183], v[216:219], a[72:75], v[168:183]
    ds_read_b64_tr_b16 v[230:231], v58 offset:37632
    buffer_load_dwordx4 v53, s[12:15], s82 offen offset:1024 lds
    ds_read_b64_tr_b16 v[232:233], v59 offset:36864
    ds_read_b64_tr_b16 v[234:235], v59 offset:37632
    v_mul_u32_u24 v2, 104, v2
    s_waitcnt lgkmcnt(5)
    v_mfma_f32_32x32x16_bf16 v[152:167], v[220:223], a[76:79], v[152:167]
    ds_read_b128 a[84:87], v67
    buffer_load_dwordx4 v54, s[12:15], s82 offen offset:2048 lds
    v_xor_b32 v66, 704, v51
    ds_read_b64_tr_b16 v[212:213], v58 offset:39936
    v_add_u32 v185, v185, v2
    v_mfma_f32_32x32x16_bf16 v[168:183], v[224:227], a[76:79], v[168:183]
    ds_read_b64_tr_b16 v[214:215], v58 offset:40704
    ds_read_b64_tr_b16 v[216:217], v59 offset:39936
    ds_read_b64_tr_b16 v[218:219], v59 offset:40704
    v_bfe_u32 v2, v1, 0, 2
    v_lshl_add_u32 v185, v2, 3, v185
    s_waitcnt lgkmcnt(5)
    v_mfma_f32_32x32x16_bf16 v[152:167], v[228:231], a[80:83], v[152:167]
    ds_read_b128 a[88:91], v66
    v_xor_b32 v67, 736, v51
    ds_read_b64_tr_b16 v[220:221], v58 offset:43008
    v_add_u32 v185, s60, v185
    s_mul_i32 s76, s7, 393216
    v_mfma_f32_32x32x16_bf16 v[168:183], v[232:235], a[80:83], v[168:183]
    ds_read_b64_tr_b16 v[222:223], v58 offset:43776
    ds_read_b64_tr_b16 v[224:225], v59 offset:43008
    ds_read_b64_tr_b16 v[226:227], v59 offset:43776
    s_mul_i32 s81, s6, 12288
    s_add_u32 s76, s76, s81
    s_waitcnt lgkmcnt(5)
    v_mfma_f32_32x32x16_bf16 v[152:167], v[212:215], a[84:87], v[152:167]
    ds_read_b128 a[92:95], v67
    v_xor_b32 v66, 768, v51
    ds_read_b64_tr_b16 v[228:229], v58 offset:46080
    s_mul_i32 s81, s4, 6144
    s_add_u32 s76, s76, s81
    v_mfma_f32_32x32x16_bf16 v[168:183], v[216:219], a[84:87], v[168:183]
    ds_read_b64_tr_b16 v[230:231], v58 offset:46848
    ds_read_b64_tr_b16 v[232:233], v59 offset:46080
    ds_read_b64_tr_b16 v[234:235], v59 offset:46848
    v_bfe_u32 v186, v1, 5, 1
    v_mul_u32_u24 v186, 3072, v186
    s_waitcnt vmcnt(29)
    s_barrier
    s_waitcnt lgkmcnt(5)
    v_mfma_f32_32x32x16_bf16 v[152:167], v[220:223], a[88:91], v[152:167]
    s_xor_b32 s82, s90, 4
    s_mul_i32 s82, s82, 98304
    s_add_u32 m0, s84, 73728
    ds_read_b128 a[96:99], v66
    buffer_load_dwordx4 v52, s[12:15], s82 offen offset:0 lds
    v_xor_b32 v67, 800, v51
    ds_read_b64_tr_b16 v[212:213], v56 offset:0
    v_bfe_u32 v2, v1, 4, 1
    v_mfma_f32_32x32x16_bf16 v[168:183], v[224:227], a[88:91], v[168:183]
    ds_read_b64_tr_b16 v[214:215], v56 offset:768
    buffer_load_dwordx4 v53, s[12:15], s82 offen offset:1024 lds
    ds_read_b64_tr_b16 v[216:217], v57 offset:0
    ds_read_b64_tr_b16 v[218:219], v57 offset:768
    v_lshl_add_u32 v186, v2, 9, v186
    s_waitcnt lgkmcnt(5)
    v_mfma_f32_32x32x16_bf16 v[152:167], v[228:231], a[92:95], v[152:167]
    ds_read_b128 a[100:103], v67
    buffer_load_dwordx4 v54, s[12:15], s82 offen offset:2048 lds
    v_xor_b32 v66, 832, v51
    ds_read_b64_tr_b16 v[220:221], v56 offset:3072
    v_bfe_u32 v2, v1, 0, 4
    v_mfma_f32_32x32x16_bf16 v[168:183], v[232:235], a[92:95], v[168:183]
    ds_read_b64_tr_b16 v[222:223], v56 offset:3840
    ds_read_b64_tr_b16 v[224:225], v57 offset:3072
    ds_read_b64_tr_b16 v[226:227], v57 offset:3840
    v_lshl_add_u32 v186, v2, 4, v186
    v_add_u32_e64 v186, s76, v186
    s_waitcnt lgkmcnt(5)
    v_mfma_f32_32x32x16_bf16 v[152:167], v[212:215], a[96:99], v[152:167]
    ds_read_b128 a[104:107], v66
    v_xor_b32 v67, 864, v51
    ds_read_b64_tr_b16 v[228:229], v56 offset:6144
    s_mul_i32 s76, s5, 6144
    s_lshl_b32 s81, s4, 11
    v_mfma_f32_32x32x16_bf16 v[168:183], v[216:219], a[96:99], v[168:183]
    ds_read_b64_tr_b16 v[230:231], v56 offset:6912
    ds_read_b64_tr_b16 v[232:233], v57 offset:6144
    ds_read_b64_tr_b16 v[234:235], v57 offset:6912
    s_add_u32 s76, s76, s81
    v_bfe_u32 v4, v1, 5, 1
    s_waitcnt lgkmcnt(5)
    v_mfma_f32_32x32x16_bf16 v[152:167], v[220:223], a[100:103], v[152:167]
    ds_read_b128 a[108:111], v67
    v_xor_b32 v66, 896, v51
    ds_read_b64_tr_b16 v[212:213], v56 offset:9216
    v_lshlrev_b32_e64 v4, 1, v4
    v_bfe_u32 v2, v1, 3, 1
    v_mfma_f32_32x32x16_bf16 v[168:183], v[224:227], a[100:103], v[168:183]
    ds_read_b64_tr_b16 v[214:215], v56 offset:9984
    ds_read_b64_tr_b16 v[216:217], v57 offset:9216
    ds_read_b64_tr_b16 v[218:219], v57 offset:9984
    v_lshl_add_u32 v4, v2, 0, v4
    v_bfe_u32 v5, v1, 4, 1
    s_waitcnt vmcnt(29)
    s_barrier
    s_waitcnt lgkmcnt(5)
    v_mfma_f32_32x32x16_bf16 v[152:167], v[228:231], a[104:107], v[152:167]
    s_xor_b32 s82, s90, 5
    s_mul_i32 s82, s82, 98304
    s_add_u32 m0, s84, 86016
    ds_read_b128 a[112:115], v66
    buffer_load_dwordx4 v52, s[12:15], s82 offen offset:0 lds
    v_xor_b32 v67, 928, v51
    ds_read_b64_tr_b16 v[220:221], v56 offset:12288
    v_lshlrev_b32 v5, 2, v5
    v_mfma_f32_32x32x16_bf16 v[168:183], v[232:235], a[104:107], v[168:183]
    ds_read_b64_tr_b16 v[222:223], v56 offset:13056
    buffer_load_dwordx4 v53, s[12:15], s82 offen offset:1024 lds
    ds_read_b64_tr_b16 v[224:225], v57 offset:12288
    ds_read_b64_tr_b16 v[226:227], v57 offset:13056
    v_bfe_u32 v2, v1, 0, 2
    s_waitcnt lgkmcnt(5)
    v_mfma_f32_32x32x16_bf16 v[152:167], v[212:215], a[108:111], v[152:167]
    ds_read_b128 a[116:119], v67
    buffer_load_dwordx4 v54, s[12:15], s82 offen offset:2048 lds
    v_xor_b32 v66, 960, v51
    ds_read_b64_tr_b16 v[228:229], v56 offset:15360
    v_lshl_add_u32 v5, v2, 0, v5
    v_mfma_f32_32x32x16_bf16 v[168:183], v[216:219], a[108:111], v[168:183]
    ds_read_b64_tr_b16 v[230:231], v56 offset:16128
    ds_read_b64_tr_b16 v[232:233], v57 offset:15360
    ds_read_b64_tr_b16 v[234:235], v57 offset:16128
    v_xor_b32 v5, v5, v4
    v_bfe_u32 v188, v1, 5, 1
    s_waitcnt lgkmcnt(5)
    v_mfma_f32_32x32x16_bf16 v[152:167], v[220:223], a[112:115], v[152:167]
    ds_read_b128 a[120:123], v66
    v_xor_b32 v67, 992, v51
    ds_read_b64_tr_b16 v[212:213], v56 offset:18432
    v_lshlrev_b32_e64 v188, 8, v188
    v_bfe_u32 v2, v1, 2, 2
    v_mfma_f32_32x32x16_bf16 v[168:183], v[224:227], a[112:115], v[168:183]
    ds_read_b64_tr_b16 v[214:215], v56 offset:19200
    ds_read_b64_tr_b16 v[216:217], v57 offset:18432
    ds_read_b64_tr_b16 v[218:219], v57 offset:19200
    v_lshl_add_u32 v188, v2, 6, v188
    v_add_u32 v188, s76, v188
    s_waitcnt lgkmcnt(5)
    v_mfma_f32_32x32x16_bf16 v[152:167], v[228:231], a[116:119], v[152:167]
    ds_read_b128 a[124:127], v67
    ds_read_b64_tr_b16 v[220:221], v56 offset:21504
    ds_read_b64_tr_b16 v[222:223], v56 offset:22272
    v_lshl_add_u32 v188, v5, 3, v188
    v_xor_b32 v189, 32, v188
    v_mfma_f32_32x32x16_bf16 v[168:183], v[232:235], a[116:119], v[168:183]
    ds_read_b64_tr_b16 v[224:225], v57 offset:21504
    ds_read_b64_tr_b16 v[226:227], v57 offset:22272
    s_lshl_b32 s76, s7, 19
    s_lshl_b32 s81, s5, 18
    s_waitcnt lgkmcnt(5)
    v_mfma_f32_32x32x16_bf16 v[152:167], v[212:215], a[120:123], v[152:167]
    s_add_u32 s76, s76, s81
    s_lshl_b32 s81, s4, 17
    v_mfma_f32_32x32x16_bf16 v[168:183], v[216:219], a[120:123], v[168:183]
    s_add_u32 s76, s76, s81
    s_lshl_b32 s81, s6, 9
    s_waitcnt lgkmcnt(0)
    v_mfma_f32_32x32x16_bf16 v[152:167], v[220:223], a[124:127], v[152:167]
    s_add_u32 s76, s76, s81
    s_add_u32 s76, s76, 8388608
    v_mfma_f32_32x32x16_bf16 v[168:183], v[224:227], a[124:127], v[168:183]
    v_bfe_u32 v190, v1, 5, 1
    v_lshlrev_b32_e64 v190, 14, v190
    v_bfe_u32 v2, v1, 0, 5
    v_lshl_add_u32 v190, v2, 4, v190
    v_add_u32 v190, s76, v190
    s_lshl_b32 s76, s6, 13
    s_lshl_b32 s81, s4, 9
    s_add_u32 s76, s76, s81
    s_add_u32 s76, s76, 12713984
    v_lshlrev_b32_e64 v191, 3, v1
    v_add_u32 v191, s76, v191
    s_barrier
    v_pk_mul_f32 v[204:205], v[152:153], v[152:153]
    v_pk_mul_f32 v[206:207], v[154:155], v[154:155]
    v_pk_mul_f32 v[208:209], v[156:157], v[156:157]
    v_pk_mul_f32 v[210:211], v[158:159], v[158:159]
    v_pk_fma_f32 v[204:205], v[204:205], v[32:33], v[32:33] op_sel:[0,0,1] op_sel_hi:[1,0,1]
    v_pk_fma_f32 v[206:207], v[206:207], v[32:33], v[32:33] op_sel:[0,0,1] op_sel_hi:[1,0,1]
    v_pk_fma_f32 v[208:209], v[208:209], v[32:33], v[32:33] op_sel:[0,0,1] op_sel_hi:[1,0,1]
    v_pk_fma_f32 v[210:211], v[210:211], v[32:33], v[32:33] op_sel:[0,0,1] op_sel_hi:[1,0,1]
    v_pk_mul_f32 v[204:205], v[204:205], v[152:153]
    v_pk_mul_f32 v[206:207], v[206:207], v[154:155]
    v_pk_mul_f32 v[208:209], v[208:209], v[156:157]
    v_pk_mul_f32 v[210:211], v[210:211], v[158:159]
    v_exp_f32 v204, v204
    v_exp_f32 v205, v205
    v_exp_f32 v206, v206
    v_exp_f32 v207, v207
    v_exp_f32 v208, v208
    v_exp_f32 v209, v209
    v_exp_f32 v210, v210
    v_exp_f32 v211, v211
    v_pk_add_f32 v[204:205], v[204:205], 1.0 op_sel_hi:[1,0]
    v_pk_add_f32 v[206:207], v[206:207], 1.0 op_sel_hi:[1,0]
    v_pk_add_f32 v[208:209], v[208:209], 1.0 op_sel_hi:[1,0]
    v_pk_add_f32 v[210:211], v[210:211], 1.0 op_sel_hi:[1,0]
    s_xor_b32 s82, s91, 0
    s_lshl_b32 s82, s82, 7
    s_add_u32 s82, s82, s57
    s_add_u32 m0, s58, 98304
    s_nop 0
    buffer_load_dwordx4 v34, s[20:23], s82 offen offset:0 lds
    v_rcp_f32 v204, v204
    v_rcp_f32 v205, v205
    v_rcp_f32 v206, v206
    v_rcp_f32 v207, v207
    v_rcp_f32 v208, v208
    v_rcp_f32 v209, v209
    v_rcp_f32 v210, v210
    v_rcp_f32 v211, v211
    v_pk_mul_f32 v[152:153], v[152:153], v[204:205]
    v_pk_mul_f32 v[154:155], v[154:155], v[206:207]
    v_pk_mul_f32 v[156:157], v[156:157], v[208:209]
    v_pk_mul_f32 v[158:159], v[158:159], v[210:211]
    v_pk_mul_f32 v[204:205], v[160:161], v[160:161]
    v_pk_mul_f32 v[206:207], v[162:163], v[162:163]
    v_pk_mul_f32 v[208:209], v[164:165], v[164:165]
    v_pk_mul_f32 v[210:211], v[166:167], v[166:167]
    v_pk_fma_f32 v[204:205], v[204:205], v[32:33], v[32:33] op_sel:[0,0,1] op_sel_hi:[1,0,1]
    v_pk_fma_f32 v[206:207], v[206:207], v[32:33], v[32:33] op_sel:[0,0,1] op_sel_hi:[1,0,1]
    v_pk_fma_f32 v[208:209], v[208:209], v[32:33], v[32:33] op_sel:[0,0,1] op_sel_hi:[1,0,1]
    v_pk_fma_f32 v[210:211], v[210:211], v[32:33], v[32:33] op_sel:[0,0,1] op_sel_hi:[1,0,1]
    v_pk_mul_f32 v[204:205], v[204:205], v[160:161]
    v_pk_mul_f32 v[206:207], v[206:207], v[162:163]
    v_pk_mul_f32 v[208:209], v[208:209], v[164:165]
    v_pk_mul_f32 v[210:211], v[210:211], v[166:167]
    s_add_u32 s82, s82, 31744
    buffer_load_dwordx4 v35, s[20:23], s82 offen offset:1024 lds
    v_exp_f32 v204, v204
    v_exp_f32 v205, v205
    v_exp_f32 v206, v206
    v_exp_f32 v207, v207
    v_exp_f32 v208, v208
    v_exp_f32 v209, v209
    v_exp_f32 v210, v210
    v_exp_f32 v211, v211
    v_pk_add_f32 v[204:205], v[204:205], 1.0 op_sel_hi:[1,0]
    v_pk_add_f32 v[206:207], v[206:207], 1.0 op_sel_hi:[1,0]
    v_pk_add_f32 v[208:209], v[208:209], 1.0 op_sel_hi:[1,0]
    v_pk_add_f32 v[210:211], v[210:211], 1.0 op_sel_hi:[1,0]
    v_rcp_f32 v204, v204
    v_rcp_f32 v205, v205
    v_rcp_f32 v206, v206
    v_rcp_f32 v207, v207
    v_rcp_f32 v208, v208
    v_rcp_f32 v209, v209
    v_rcp_f32 v210, v210
    v_rcp_f32 v211, v211
    v_pk_mul_f32 v[160:161], v[160:161], v[204:205]
    v_pk_mul_f32 v[162:163], v[162:163], v[206:207]
    v_pk_mul_f32 v[164:165], v[164:165], v[208:209]
    v_pk_mul_f32 v[166:167], v[166:167], v[210:211]
    s_add_u32 s82, s82, 31744
    buffer_load_dwordx4 v34, s[20:23], s82 offen offset:2048 lds
    v_pk_mul_f32 v[204:205], v[168:169], v[168:169]
    v_pk_mul_f32 v[206:207], v[170:171], v[170:171]
    v_pk_mul_f32 v[208:209], v[172:173], v[172:173]
    v_pk_mul_f32 v[210:211], v[174:175], v[174:175]
    v_pk_fma_f32 v[204:205], v[204:205], v[32:33], v[32:33] op_sel:[0,0,1] op_sel_hi:[1,0,1]
    v_pk_fma_f32 v[206:207], v[206:207], v[32:33], v[32:33] op_sel:[0,0,1] op_sel_hi:[1,0,1]
    v_pk_fma_f32 v[208:209], v[208:209], v[32:33], v[32:33] op_sel:[0,0,1] op_sel_hi:[1,0,1]
    v_pk_fma_f32 v[210:211], v[210:211], v[32:33], v[32:33] op_sel:[0,0,1] op_sel_hi:[1,0,1]
    v_pk_mul_f32 v[204:205], v[204:205], v[168:169]
    v_pk_mul_f32 v[206:207], v[206:207], v[170:171]
    v_pk_mul_f32 v[208:209], v[208:209], v[172:173]
    v_pk_mul_f32 v[210:211], v[210:211], v[174:175]
    v_exp_f32 v204, v204
    v_exp_f32 v205, v205
    v_exp_f32 v206, v206
    v_exp_f32 v207, v207
    v_exp_f32 v208, v208
    v_exp_f32 v209, v209
    v_exp_f32 v210, v210
    v_exp_f32 v211, v211
    v_pk_add_f32 v[204:205], v[204:205], 1.0 op_sel_hi:[1,0]
    v_pk_add_f32 v[206:207], v[206:207], 1.0 op_sel_hi:[1,0]
    v_pk_add_f32 v[208:209], v[208:209], 1.0 op_sel_hi:[1,0]
    v_pk_add_f32 v[210:211], v[210:211], 1.0 op_sel_hi:[1,0]
    s_add_u32 s82, s82, 31744
    buffer_load_dwordx4 v35, s[20:23], s82 offen offset:3072 lds
    v_rcp_f32 v204, v204
    v_rcp_f32 v205, v205
    v_rcp_f32 v206, v206
    v_rcp_f32 v207, v207
    v_rcp_f32 v208, v208
    v_rcp_f32 v209, v209
    v_rcp_f32 v210, v210
    v_rcp_f32 v211, v211
    v_pk_mul_f32 v[168:169], v[168:169], v[204:205]
    v_pk_mul_f32 v[170:171], v[170:171], v[206:207]
    v_pk_mul_f32 v[172:173], v[172:173], v[208:209]
    v_pk_mul_f32 v[174:175], v[174:175], v[210:211]
    v_pk_add_f32 v[64:65], v[152:153], v[154:155]
    v_pk_mul_f32 v[66:67], v[152:153], v[152:153]
    v_pk_fma_f32 v[66:67], v[154:155], v[154:155], v[66:67]
    v_pk_add_f32 v[64:65], v[64:65], v[156:157]
    v_pk_fma_f32 v[66:67], v[156:157], v[156:157], v[66:67]
    v_pk_add_f32 v[64:65], v[64:65], v[158:159]
    v_pk_fma_f32 v[66:67], v[158:159], v[158:159], v[66:67]
    v_pk_add_f32 v[64:65], v[64:65], v[160:161]
    v_pk_fma_f32 v[66:67], v[160:161], v[160:161], v[66:67]
    v_pk_add_f32 v[64:65], v[64:65], v[162:163]
    v_pk_fma_f32 v[66:67], v[162:163], v[162:163], v[66:67]
    v_pk_add_f32 v[64:65], v[64:65], v[164:165]
    s_add_u32 s82, s82, s59
    s_add_u32 m0, s58, 102400
    s_nop 0
    buffer_load_dwordx4 v34, s[20:23], s82 offen offset:0 lds
    v_pk_fma_f32 v[66:67], v[164:165], v[164:165], v[66:67]
    v_pk_add_f32 v[64:65], v[64:65], v[166:167]
    v_pk_fma_f32 v[66:67], v[166:167], v[166:167], v[66:67]
    v_pk_add_f32 v[64:65], v[64:65], v[168:169]
    v_pk_fma_f32 v[66:67], v[168:169], v[168:169], v[66:67]
    v_pk_add_f32 v[64:65], v[64:65], v[170:171]
    v_pk_fma_f32 v[66:67], v[170:171], v[170:171], v[66:67]
    v_pk_add_f32 v[64:65], v[64:65], v[172:173]
    v_pk_fma_f32 v[66:67], v[172:173], v[172:173], v[66:67]
    v_pk_add_f32 v[64:65], v[64:65], v[174:175]
    v_pk_fma_f32 v[66:67], v[174:175], v[174:175], v[66:67]
    v_add_f32_e64 v64, v64, v65
    v_add_f32 v65, v66, v67
    s_lshl_b32 s76, s3, 8
    v_lshl_add_u32 v4, v1, 2, s76
    v_permlane32_swap_b32 v64, v65
    v_add_f32 v64, v64, v65
    ds_write_b32 v4, v64 offset:0
    v_xor_b32 v4, 256, v4
    s_waitcnt vmcnt(32)
    v_cmp_eq_u32 vcc, 0, v55
    s_nop 0
    s_cbranch_vccnz L_slow_n_2
L_back_n_3:
    v_readfirstlane_b32 s83, v55
    s_lshl_b32 s77, s7, 10
    s_cmp_eq_u32 s5, 0
    s_cselect_b32 s77, s77, 2147483648
    v_add_u32 v5, s77, v191
    v_mov_b32 v67, v55
    s_waitcnt lgkmcnt(0)
    s_waitcnt vmcnt(20)
    s_barrier
    ds_read_b32 v65, v4 offset:0
    v_or_b32 v248, v248, v249
    v_or_b32 v249, v250, v251
    v_or_b32 v250, v252, v253
    v_or_b32 v251, v254, v255
    s_mov_b32 s64, 0xffff0000
    s_mov_b32 s65, 0xffff0000
    v_cndmask_b32 v18, v248, 0, s[64:65]
    v_cndmask_b32 v22, 0, v248, s[64:65]
    v_cndmask_b32 v19, v249, 0, s[64:65]
    v_cndmask_b32 v23, 0, v249, s[64:65]
    v_cndmask_b32 v20, v250, 0, s[64:65]
    v_cndmask_b32 v24, 0, v250, s[64:65]
    v_cndmask_b32 v21, v251, 0, s[64:65]
    v_cndmask_b32 v25, 0, v251, s[64:65]
    s_waitcnt lgkmcnt(0)
    v_add_f32_e64 v66, v64, v65
    buffer_store_dwordx2 v[66:67], v5, s[24:27], 0 offen sc1
    ds_read_b64_tr_b16 v[212:213], v60 offset:24576
    ds_read_b64_tr_b16 v[214:215], v60 offset:26112
    ds_read_b64_tr_b16 v[216:217], v60 offset:24704
    ds_read_b64_tr_b16 v[218:219], v60 offset:26240
    ds_read_b64_tr_b16 v[220:221], v60 offset:24832
    ds_read_b64_tr_b16 v[222:223], v60 offset:26368
    ds_read_b64_tr_b16 v[224:225], v60 offset:30720
    ds_read_b64_tr_b16 v[226:227], v60 offset:32256
    ds_read_b64_tr_b16 v[228:229], v60 offset:30848
    ds_read_b64_tr_b16 v[230:231], v60 offset:32384
    ds_read_b64_tr_b16 v[232:233], v60 offset:30976
    ds_read_b64_tr_b16 v[234:235], v60 offset:32512
    s_waitcnt vmcnt(18)
    s_barrier
    s_waitcnt lgkmcnt(6)
    v_mfma_f32_32x32x16_bf16 v[136:151], v[212:215], a[0:3], 0
    s_add_u32 s82, s82, 31744
    ds_read_b64_tr_b16 v[236:237], v60 offset:36864
    buffer_load_dwordx4 v35, s[20:23], s82 offen offset:1024 lds
    ds_read_b64_tr_b16 v[238:239], v60 offset:38400
    v_mfma_f32_32x32x16_bf16 v[120:135], v[216:219], a[0:3], 0
    s_add_u32 s82, s82, 31744
    ds_read_b64_tr_b16 v[240:241], v60 offset:36992
    buffer_load_dwordx4 v34, s[20:23], s82 offen offset:2048 lds
    ds_read_b64_tr_b16 v[242:243], v60 offset:38528
    v_mfma_f32_32x32x16_bf16 v[104:119], a[0:3], v[220:223], 0
    s_add_u32 s82, s82, 31744
    ds_read_b64_tr_b16 v[244:245], v60 offset:37120
    buffer_load_dwordx4 v35, s[20:23], s82 offen offset:3072 lds
    ds_read_b64_tr_b16 v[246:247], v60 offset:38656
    s_waitcnt lgkmcnt(6)
    v_mfma_f32_32x32x16_bf16 v[136:151], v[224:227], a[4:7], v[136:151]
    s_xor_b32 s82, s91, 1
    s_lshl_b32 s82, s82, 7
    s_add_u32 s82, s82, s57
    s_add_u32 m0, s58, 131072
    ds_read_b64_tr_b16 v[212:213], v60 offset:43008
    buffer_load_dwordx4 v34, s[20:23], s82 offen offset:0 lds
    ds_read_b64_tr_b16 v[214:215], v60 offset:44544
    v_mfma_f32_32x32x16_bf16 v[120:135], v[228:231], a[4:7], v[120:135]
    s_add_u32 s82, s82, 31744
    ds_read_b64_tr_b16 v[216:217], v60 offset:43136
    buffer_load_dwordx4 v35, s[20:23], s82 offen offset:1024 lds
    ds_read_b64_tr_b16 v[218:219], v60 offset:44672
    v_mfma_f32_32x32x16_bf16 v[104:119], a[4:7], v[232:235], v[104:119]
    s_add_u32 s82, s82, 31744
    ds_read_b64_tr_b16 v[220:221], v60 offset:43264
    buffer_load_dwordx4 v34, s[20:23], s82 offen offset:2048 lds
    ds_read_b64_tr_b16 v[222:223], v60 offset:44800
    s_waitcnt vmcnt(21)
    s_barrier
    s_waitcnt lgkmcnt(6)
    v_mfma_f32_32x32x16_bf16 v[136:151], v[236:239], a[8:11], v[136:151]
    s_add_u32 s82, s82, 31744
    ds_read_b64_tr_b16 v[224:225], v60 offset:49152
    buffer_load_dwordx4 v35, s[20:23], s82 offen offset:3072 lds
    ds_read_b64_tr_b16 v[226:227], v60 offset:50688
    v_mfma_f32_32x32x16_bf16 v[120:135], v[240:243], a[8:11], v[120:135]
    s_add_u32 s82, s82, s59
    s_add_u32 m0, s58, 135168
    ds_read_b64_tr_b16 v[228:229], v60 offset:49280
    buffer_load_dwordx4 v34, s[20:23], s82 offen offset:0 lds
    ds_read_b64_tr_b16 v[230:231], v60 offset:50816
    v_mfma_f32_32x32x16_bf16 v[104:119], a[8:11], v[244:247], v[104:119]
    s_add_u32 s82, s82, 31744
    ds_read_b64_tr_b16 v[232:233], v60 offset:49408
    buffer_load_dwordx4 v35, s[20:23], s82 offen offset:1024 lds
    ds_read_b64_tr_b16 v[234:235], v60 offset:50944
    s_waitcnt lgkmcnt(6)
    v_mfma_f32_32x32x16_bf16 v[136:151], v[212:215], a[12:15], v[136:151]
    s_add_u32 s82, s82, 31744
    ds_read_b64_tr_b16 v[236:237], v60 offset:55296
    buffer_load_dwordx4 v34, s[20:23], s82 offen offset:2048 lds
    ds_read_b64_tr_b16 v[238:239], v60 offset:56832
    v_mfma_f32_32x32x16_bf16 v[120:135], v[216:219], a[12:15], v[120:135]
    s_add_u32 s82, s82, 31744
    ds_read_b64_tr_b16 v[240:241], v60 offset:55424
    buffer_load_dwordx4 v35, s[20:23], s82 offen offset:3072 lds
    ds_read_b64_tr_b16 v[242:243], v60 offset:56960
    v_mfma_f32_32x32x16_bf16 v[104:119], a[12:15], v[220:223], v[104:119]
    s_xor_b32 s82, s90, 6
    s_mul_i32 s82, s82, 98304
    s_add_u32 m0, s84, 24576
    ds_read_b64_tr_b16 v[244:245], v60 offset:55552
    buffer_load_dwordx4 v52, s[12:15], s82 offen offset:0 lds
    ds_read_b64_tr_b16 v[246:247], v60 offset:57088
    s_waitcnt vmcnt(24)
    s_barrier
    s_waitcnt lgkmcnt(6)
    v_mfma_f32_32x32x16_bf16 v[136:151], v[224:227], a[16:19], v[136:151]
    ds_read_b64_tr_b16 v[212:213], v61 offset:12288
    buffer_load_dwordx4 v53, s[12:15], s82 offen offset:1024 lds
    ds_read_b64_tr_b16 v[214:215], v61 offset:13824
    v_mfma_f32_32x32x16_bf16 v[120:135], v[228:231], a[16:19], v[120:135]
    ds_read_b64_tr_b16 v[216:217], v61 offset:12416
    buffer_load_dwordx4 v54, s[12:15], s82 offen offset:2048 lds
    ds_read_b64_tr_b16 v[218:219], v61 offset:13952
    v_mfma_f32_32x32x16_bf16 v[104:119], a[16:19], v[232:235], v[104:119]
    s_xor_b32 s82, s90, 7
    s_mul_i32 s82, s82, 98304
    s_add_u32 m0, s84, 36864
    ds_read_b64_tr_b16 v[220:221], v61 offset:12544
    buffer_load_dwordx4 v52, s[12:15], s82 offen offset:0 lds
    ds_read_b64_tr_b16 v[222:223], v61 offset:14080
    s_waitcnt lgkmcnt(6)
    v_mfma_f32_32x32x16_bf16 v[136:151], v[236:239], a[20:23], v[136:151]
    ds_read_b64_tr_b16 v[224:225], v61 offset:18432
    buffer_load_dwordx4 v53, s[12:15], s82 offen offset:1024 lds
    ds_read_b64_tr_b16 v[226:227], v61 offset:19968
    v_mfma_f32_32x32x16_bf16 v[120:135], v[240:243], a[20:23], v[120:135]
    ds_read_b64_tr_b16 v[228:229], v61 offset:18560
    buffer_load_dwordx4 v54, s[12:15], s82 offen offset:2048 lds
    ds_read_b64_tr_b16 v[230:231], v61 offset:20096
    v_mfma_f32_32x32x16_bf16 v[104:119], a[20:23], v[244:247], v[104:119]
    ds_read_b64_tr_b16 v[232:233], v61 offset:18688
    ds_read_b64_tr_b16 v[234:235], v61 offset:20224
    s_waitcnt vmcnt(26)
    s_barrier
    s_waitcnt lgkmcnt(6)
    v_mfma_f32_32x32x16_bf16 v[136:151], v[212:215], a[24:27], v[136:151]
    s_xor_b32 s82, s90, 8
    s_mul_i32 s82, s82, 98304
    s_add_u32 m0, s84, 49152
    ds_read_b64_tr_b16 v[236:237], v61 offset:24576
    buffer_load_dwordx4 v52, s[12:15], s82 offen offset:0 lds
    ds_read_b64_tr_b16 v[238:239], v61 offset:26112
    v_mfma_f32_32x32x16_bf16 v[120:135], v[216:219], a[24:27], v[120:135]
    ds_read_b64_tr_b16 v[240:241], v61 offset:24704
    buffer_load_dwordx4 v53, s[12:15], s82 offen offset:1024 lds
    ds_read_b64_tr_b16 v[242:243], v61 offset:26240
    v_mfma_f32_32x32x16_bf16 v[104:119], a[24:27], v[220:223], v[104:119]
    ds_read_b64_tr_b16 v[244:245], v61 offset:24832
    buffer_load_dwordx4 v54, s[12:15], s82 offen offset:2048 lds
    ds_read_b64_tr_b16 v[246:247], v61 offset:26368
    s_waitcnt lgkmcnt(6)
    v_mfma_f32_32x32x16_bf16 v[136:151], v[224:227], a[28:31], v[136:151]
    ds_read_b64_tr_b16 v[212:213], v61 offset:30720
    ds_read_b64_tr_b16 v[214:215], v61 offset:32256
    v_mfma_f32_32x32x16_bf16 v[120:135], v[228:231], a[28:31], v[120:135]
    ds_read_b64_tr_b16 v[216:217], v61 offset:30848
    ds_read_b64_tr_b16 v[218:219], v61 offset:32384
    v_mfma_f32_32x32x16_bf16 v[104:119], a[28:31], v[232:235], v[104:119]
    ds_read_b64_tr_b16 v[220:221], v61 offset:30976
    ds_read_b64_tr_b16 v[222:223], v61 offset:32512
    s_waitcnt vmcnt(26)
    s_barrier
    s_waitcnt lgkmcnt(6)
    v_mfma_f32_32x32x16_bf16 v[136:151], v[236:239], a[32:35], v[136:151]
    s_xor_b32 s82, s90, 9
    s_mul_i32 s82, s82, 98304
    s_add_u32 m0, s84, 61440
    ds_read_b64_tr_b16 v[224:225], v61 offset:36864
    buffer_load_dwordx4 v52, s[12:15], s82 offen offset:0 lds
    ds_read_b64_tr_b16 v[226:227], v61 offset:38400
    v_mfma_f32_32x32x16_bf16 v[120:135], v[240:243], a[32:35], v[120:135]
    ds_read_b64_tr_b16 v[228:229], v61 offset:36992
    buffer_load_dwordx4 v53, s[12:15], s82 offen offset:1024 lds
    ds_read_b64_tr_b16 v[230:231], v61 offset:38528
    v_mfma_f32_32x32x16_bf16 v[104:119], a[32:35], v[244:247], v[104:119]
    ds_read_b64_tr_b16 v[232:233], v61 offset:37120
    buffer_load_dwordx4 v54, s[12:15], s82 offen offset:2048 lds
    ds_read_b64_tr_b16 v[234:235], v61 offset:38656
    s_waitcnt lgkmcnt(6)
    v_mfma_f32_32x32x16_bf16 v[136:151], v[212:215], a[36:39], v[136:151]
    ds_read_b64_tr_b16 v[236:237], v61 offset:43008
    ds_read_b64_tr_b16 v[238:239], v61 offset:44544
    v_mfma_f32_32x32x16_bf16 v[120:135], v[216:219], a[36:39], v[120:135]
    ds_read_b64_tr_b16 v[240:241], v61 offset:43136
    ds_read_b64_tr_b16 v[242:243], v61 offset:44672
    v_mfma_f32_32x32x16_bf16 v[104:119], a[36:39], v[220:223], v[104:119]
    ds_read_b64_tr_b16 v[244:245], v61 offset:43264
    ds_read_b64_tr_b16 v[246:247], v61 offset:44800
    s_waitcnt vmcnt(9)
    s_barrier
    s_waitcnt lgkmcnt(6)
    v_mfma_f32_32x32x16_bf16 v[136:151], v[224:227], a[40:43], v[136:151]
    s_xor_b32 s82, s90, 10
    s_mul_i32 s82, s82, 98304
    s_add_u32 m0, s84, 73728
    ds_read_b64_tr_b16 v[212:213], v60 offset:24576
    buffer_load_dwordx4 v52, s[12:15], s82 offen offset:0 lds
    ds_read_b64_tr_b16 v[214:215], v60 offset:26112
    v_mfma_f32_32x32x16_bf16 v[120:135], v[228:231], a[40:43], v[120:135]
    ds_read_b64_tr_b16 v[216:217], v60 offset:24704
    buffer_load_dwordx4 v53, s[12:15], s82 offen offset:1024 lds
    ds_read_b64_tr_b16 v[218:219], v60 offset:26240
    v_mfma_f32_32x32x16_bf16 v[104:119], a[40:43], v[232:235], v[104:119]
    ds_read_b64_tr_b16 v[220:221], v60 offset:24832
    buffer_load_dwordx4 v54, s[12:15], s82 offen offset:2048 lds
    ds_read_b64_tr_b16 v[222:223], v60 offset:26368
    s_waitcnt lgkmcnt(6)
    v_mfma_f32_32x32x16_bf16 v[136:151], v[236:239], a[44:47], v[136:151]
    ds_read_b64_tr_b16 v[224:225], v60 offset:30720
    ds_read_b64_tr_b16 v[226:227], v60 offset:32256
    v_mfma_f32_32x32x16_bf16 v[120:135], v[240:243], a[44:47], v[120:135]
    ds_read_b64_tr_b16 v[228:229], v60 offset:30848
    ds_read_b64_tr_b16 v[230:231], v60 offset:32384
    v_mfma_f32_32x32x16_bf16 v[104:119], a[44:47], v[244:247], v[104:119]
    ds_read_b64_tr_b16 v[232:233], v60 offset:30976
    ds_read_b64_tr_b16 v[234:235], v60 offset:32512
    s_waitcnt vmcnt(9)
    s_barrier
    s_waitcnt lgkmcnt(6)
    v_mfma_f32_32x32x16_bf16 v[136:151], v[212:215], a[48:51], v[136:151]
    s_xor_b32 s82, s90, 11
    s_mul_i32 s82, s82, 98304
    s_add_u32 m0, s84, 86016
    ds_read_b64_tr_b16 v[236:237], v60 offset:36864
    buffer_load_dwordx4 v52, s[12:15], s82 offen offset:0 lds
    ds_read_b64_tr_b16 v[238:239], v60 offset:38400
    v_mfma_f32_32x32x16_bf16 v[120:135], v[216:219], a[48:51], v[120:135]
    ds_read_b64_tr_b16 v[240:241], v60 offset:36992
    buffer_load_dwordx4 v53, s[12:15], s82 offen offset:1024 lds
    ds_read_b64_tr_b16 v[242:243], v60 offset:38528
    v_mfma_f32_32x32x16_bf16 v[104:119], a[48:51], v[220:223], v[104:119]
    ds_read_b64_tr_b16 v[244:245], v60 offset:37120
    buffer_load_dwordx4 v54, s[12:15], s82 offen offset:2048 lds
    ds_read_b64_tr_b16 v[246:247], v60 offset:38656
    s_waitcnt lgkmcnt(6)
    v_mfma_f32_32x32x16_bf16 v[136:151], v[224:227], a[52:55], v[136:151]
    ds_read_b64_tr_b16 v[212:213], v60 offset:43008
    ds_read_b64_tr_b16 v[214:215], v60 offset:44544
    v_mfma_f32_32x32x16_bf16 v[120:135], v[228:231], a[52:55], v[120:135]
    ds_read_b64_tr_b16 v[216:217], v60 offset:43136
    ds_read_b64_tr_b16 v[218:219], v60 offset:44672
    v_mfma_f32_32x32x16_bf16 v[104:119], a[52:55], v[232:235], v[104:119]
    ds_read_b64_tr_b16 v[220:221], v60 offset:43264
    ds_read_b64_tr_b16 v[222:223], v60 offset:44800
    s_waitcnt vmcnt(9)
    s_barrier
    s_waitcnt lgkmcnt(6)
    v_mfma_f32_32x32x16_bf16 v[136:151], v[236:239], a[56:59], v[136:151]
    s_xor_b32 s82, s90, 12
    s_mul_i32 s82, s82, 98304
    s_add_u32 m0, s84, 24576
    ds_read_b64_tr_b16 v[224:225], v60 offset:49152
    buffer_load_dwordx4 v52, s[12:15], s82 offen offset:0 lds
    ds_read_b64_tr_b16 v[226:227], v60 offset:50688
    v_mfma_f32_32x32x16_bf16 v[120:135], v[240:243], a[56:59], v[120:135]
    ds_read_b64_tr_b16 v[228:229], v60 offset:49280
    buffer_load_dwordx4 v53, s[12:15], s82 offen offset:1024 lds
    ds_read_b64_tr_b16 v[230:231], v60 offset:50816
    v_mfma_f32_32x32x16_bf16 v[104:119], a[56:59], v[244:247], v[104:119]
    ds_read_b64_tr_b16 v[232:233], v60 offset:49408
    buffer_load_dwordx4 v54, s[12:15], s82 offen offset:2048 lds
    ds_read_b64_tr_b16 v[234:235], v60 offset:50944
    s_waitcnt lgkmcnt(6)
    v_mfma_f32_32x32x16_bf16 v[136:151], v[212:215], a[60:63], v[136:151]
    ds_read_b64_tr_b16 v[236:237], v60 offset:55296
    ds_read_b64_tr_b16 v[238:239], v60 offset:56832
    v_mfma_f32_32x32x16_bf16 v[120:135], v[216:219], a[60:63], v[120:135]
    ds_read_b64_tr_b16 v[240:241], v60 offset:55424
    ds_read_b64_tr_b16 v[242:243], v60 offset:56960
    v_mfma_f32_32x32x16_bf16 v[104:119], a[60:63], v[220:223], v[104:119]
    ds_read_b64_tr_b16 v[244:245], v60 offset:55552
    ds_read_b64_tr_b16 v[246:247], v60 offset:57088
    s_waitcnt vmcnt(9)
    s_barrier
    s_waitcnt lgkmcnt(6)
    v_mfma_f32_32x32x16_bf16 v[136:151], v[224:227], a[64:67], v[136:151]
    s_xor_b32 s82, s90, 13
    s_mul_i32 s82, s82, 98304
    s_add_u32 m0, s84, 36864
    ds_read_b64_tr_b16 v[212:213], v61 offset:12288
    buffer_load_dwordx4 v52, s[12:15], s82 offen offset:0 lds
    ds_read_b64_tr_b16 v[214:215], v61 offset:13824
    v_mfma_f32_32x32x16_bf16 v[120:135], v[228:231], a[64:67], v[120:135]
    ds_read_b64_tr_b16 v[216:217], v61 offset:12416
    buffer_load_dwordx4 v53, s[12:15], s82 offen offset:1024 lds
    ds_read_b64_tr_b16 v[218:219], v61 offset:13952
    v_mfma_f32_32x32x16_bf16 v[104:119], a[64:67], v[232:235], v[104:119]
    ds_read_b64_tr_b16 v[220:221], v61 offset:12544
    buffer_load_dwordx4 v54, s[12:15], s82 offen offset:2048 lds
    ds_read_b64_tr_b16 v[222:223], v61 offset:14080
    s_waitcnt lgkmcnt(6)
    v_mfma_f32_32x32x16_bf16 v[136:151], v[236:239], a[68:71], v[136:151]
    ds_read_b64_tr_b16 v[224:225], v61 offset:18432
    ds_read_b64_tr_b16 v[226:227], v61 offset:19968
    v_add_u32 v26, 98304, v41
    v_xor_b32 v27, 32, v26
    v_xor_b32_e64 v28, 64, v26
    v_xor_b32 v29, 96, v26
    v_mfma_f32_32x32x16_bf16 v[120:135], v[240:243], a[68:71], v[120:135]
    ds_read_b64_tr_b16 v[228:229], v61 offset:18560
    ds_read_b64_tr_b16 v[230:231], v61 offset:20096
    ds_read_b128 a[128:131], v26 offset:0
    v_mfma_f32_32x32x16_bf16 v[104:119], a[68:71], v[244:247], v[104:119]
    ds_read_b64_tr_b16 v[232:233], v61 offset:18688
    ds_read_b64_tr_b16 v[234:235], v61 offset:20224
    ds_read_b128 a[132:135], v26 offset:4096
    s_waitcnt vmcnt(9)
    s_barrier
    s_waitcnt lgkmcnt(8)
    v_mfma_f32_32x32x16_bf16 v[136:151], v[212:215], a[72:75], v[136:151]
    s_xor_b32 s82, s90, 14
    s_mul_i32 s82, s82, 98304
    s_add_u32 m0, s84, 49152
    ds_read_b64_tr_b16 v[236:237], v61 offset:24576
    buffer_load_dwordx4 v52, s[12:15], s82 offen offset:0 lds
    ds_read_b64_tr_b16 v[238:239], v61 offset:26112
    v_mfma_f32_32x32x16_bf16 v[120:135], v[216:219], a[72:75], v[120:135]
    ds_read_b64_tr_b16 v[240:241], v61 offset:24704
    buffer_load_dwordx4 v53, s[12:15], s82 offen offset:1024 lds
    ds_read_b64_tr_b16 v[242:243], v61 offset:26240
    v_mfma_f32_32x32x16_bf16 v[104:119], a[72:75], v[220:223], v[104:119]
    ds_read_b64_tr_b16 v[244:245], v61 offset:24832
    buffer_load_dwordx4 v54, s[12:15], s82 offen offset:2048 lds
    ds_read_b64_tr_b16 v[246:247], v61 offset:26368
    s_waitcnt lgkmcnt(7)
    v_mfma_f32_32x32x16_bf16 v[136:151], v[224:227], a[76:79], v[136:151]
    ds_read_b64_tr_b16 v[212:213], v61 offset:30720
    ds_read_b64_tr_b16 v[214:215], v61 offset:32256
    ds_read_b128 a[136:139], v27 offset:0
    v_mfma_f32_32x32x16_bf16 v[120:135], v[228:231], a[76:79], v[120:135]
    ds_read_b64_tr_b16 v[216:217], v61 offset:30848
    ds_read_b64_tr_b16 v[218:219], v61 offset:32384
    ds_read_b128 a[140:143], v27 offset:4096
    v_mfma_f32_32x32x16_bf16 v[104:119], a[76:79], v[232:235], v[104:119]
    ds_read_b64_tr_b16 v[220:221], v61 offset:30976
    ds_read_b64_tr_b16 v[222:223], v61 offset:32512
    ds_read_b128 a[144:147], v28 offset:0
    s_waitcnt vmcnt(9)
    s_barrier
    s_waitcnt lgkmcnt(9)
    v_mfma_f32_32x32x16_bf16 v[136:151], v[236:239], a[80:83], v[136:151]
    s_xor_b32 s82, s90, 15
    s_mul_i32 s82, s82, 98304
    s_add_u32 m0, s84, 61440
    ds_read_b64_tr_b16 v[224:225], v61 offset:36864
    buffer_load_dwordx4 v52, s[12:15], s82 offen offset:0 lds
    ds_read_b64_tr_b16 v[226:227], v61 offset:38400
    v_mfma_f32_32x32x16_bf16 v[120:135], v[240:243], a[80:83], v[120:135]
    ds_read_b64_tr_b16 v[228:229], v61 offset:36992
    buffer_load_dwordx4 v53, s[12:15], s82 offen offset:1024 lds
    ds_read_b64_tr_b16 v[230:231], v61 offset:38528
    v_mfma_f32_32x32x16_bf16 v[104:119], a[80:83], v[244:247], v[104:119]
    ds_read_b64_tr_b16 v[232:233], v61 offset:37120
    buffer_load_dwordx4 v54, s[12:15], s82 offen offset:2048 lds
    ds_read_b64_tr_b16 v[234:235], v61 offset:38656
    s_waitcnt lgkmcnt(7)
    v_mfma_f32_32x32x16_bf16 v[136:151], v[212:215], a[84:87], v[136:151]
    ds_read_b64_tr_b16 v[236:237], v61 offset:43008
    ds_read_b64_tr_b16 v[238:239], v61 offset:44544
    ds_read_b128 a[148:151], v28 offset:4096
    v_mfma_f32_32x32x16_bf16 v[120:135], v[216:219], a[84:87], v[120:135]
    ds_read_b64_tr_b16 v[240:241], v61 offset:43136
    ds_read_b64_tr_b16 v[242:243], v61 offset:44672
    ds_read_b128 a[152:155], v29 offset:0
    v_mfma_f32_32x32x16_bf16 v[104:119], a[84:87], v[220:223], v[104:119]
    ds_read_b64_tr_b16 v[244:245], v61 offset:43264
    ds_read_b64_tr_b16 v[246:247], v61 offset:44800
    ds_read_b128 a[156:159], v29 offset:4096
    s_waitcnt vmcnt(9)
    s_barrier
    s_waitcnt lgkmcnt(9)
    v_mfma_f32_32x32x16_bf16 v[136:151], v[224:227], a[88:91], v[136:151]
    s_xor_b32 s82, s90, 0
    s_mul_i32 s82, s82, 88064
    s_add_u32 m0, s84, 73728
    ds_read_b64_tr_b16 v[212:213], v60 offset:24576
    buffer_load_dwordx4 v48, s[16:19], s82 offen offset:0 lds
    ds_read_b64_tr_b16 v[214:215], v60 offset:26112
    v_mfma_f32_32x32x16_bf16 v[120:135], v[228:231], a[88:91], v[120:135]
    ds_read_b64_tr_b16 v[216:217], v60 offset:24704
    buffer_load_dwordx4 v49, s[16:19], s82 offen offset:1024 lds
    ds_read_b64_tr_b16 v[218:219], v60 offset:26240
    v_mfma_f32_32x32x16_bf16 v[104:119], a[88:91], v[232:235], v[104:119]
    ds_read_b64_tr_b16 v[220:221], v60 offset:24832
    buffer_load_dwordx4 v50, s[16:19], s82 offen offset:2048 lds
    ds_read_b64_tr_b16 v[222:223], v60 offset:26368
    s_waitcnt lgkmcnt(7)
    v_mfma_f32_32x32x16_bf16 v[136:151], v[236:239], a[92:95], v[136:151]
    ds_read_b64_tr_b16 v[224:225], v60 offset:30720
    ds_read_b64_tr_b16 v[226:227], v60 offset:32256
    v_add_u32 v26, 131072, v41
    v_xor_b32 v27, 32, v26
    v_xor_b32_e64 v28, 64, v26
    v_xor_b32 v29, 96, v26
    v_mfma_f32_32x32x16_bf16 v[120:135], v[240:243], a[92:95], v[120:135]
    ds_read_b64_tr_b16 v[228:229], v60 offset:30848
    ds_read_b64_tr_b16 v[230:231], v60 offset:32384
    ds_read_b128 a[160:163], v26 offset:0
    v_mfma_f32_32x32x16_bf16 v[104:119], a[92:95], v[244:247], v[104:119]
    ds_read_b64_tr_b16 v[232:233], v60 offset:30976
    ds_read_b64_tr_b16 v[234:235], v60 offset:32512
    ds_read_b128 a[164:167], v26 offset:4096
    s_waitcnt vmcnt(9)
    s_barrier
    v_add_u32 v9, 4096, v191
    s_waitcnt lgkmcnt(8)
    v_mfma_f32_32x32x16_bf16 v[136:151], v[212:215], a[96:99], v[136:151]
    s_xor_b32 s82, s90, 2
    s_mul_i32 s82, s82, 88064
    s_add_u32 m0, s84, 86016
    ds_read_b64_tr_b16 v[236:237], v60 offset:36864
    buffer_load_dwordx4 v48, s[16:19], s82 offen offset:0 lds
    ds_read_b64_tr_b16 v[238:239], v60 offset:38400
    v_mfma_f32_32x32x16_bf16 v[120:135], v[216:219], a[96:99], v[120:135]
    ds_read_b64_tr_b16 v[240:241], v60 offset:36992
    buffer_load_dwordx4 v49, s[16:19], s82 offen offset:1024 lds
    ds_read_b64_tr_b16 v[242:243], v60 offset:38528
    v_mfma_f32_32x32x16_bf16 v[104:119], a[96:99], v[220:223], v[104:119]
    ds_read_b64_tr_b16 v[244:245], v60 offset:37120
    buffer_load_dwordx4 v50, s[16:19], s82 offen offset:2048 lds
    ds_read_b64_tr_b16 v[246:247], v60 offset:38656
    s_waitcnt lgkmcnt(7)
    v_mfma_f32_32x32x16_bf16 v[136:151], v[224:227], a[100:103], v[136:151]
    ds_read_b64_tr_b16 v[212:213], v60 offset:43008
    buffer_load_dwordx2 v[196:197], v191, s[24:27], 0 offen offset:0 sc1
    ds_read_b64_tr_b16 v[214:215], v60 offset:44544
    v_mfma_f32_32x32x16_bf16 v[120:135], v[228:231], a[100:103], v[120:135]
    ds_read_b64_tr_b16 v[216:217], v60 offset:43136
    buffer_load_dwordx2 v[198:199], v191, s[24:27], 0 offen offset:1024 sc1
    ds_read_b64_tr_b16 v[218:219], v60 offset:44672
    v_mfma_f32_32x32x16_bf16 v[104:119], a[100:103], v[232:235], v[104:119]
    ds_read_b64_tr_b16 v[220:221], v60 offset:43264
    buffer_load_dwordx2 v[200:201], v191, s[24:27], 0 offen offset:2048 sc1
    ds_read_b64_tr_b16 v[222:223], v60 offset:44800
    s_waitcnt vmcnt(12)
    s_barrier
    s_waitcnt lgkmcnt(6)
    v_mfma_f32_32x32x16_bf16 v[136:151], v[236:239], a[104:107], v[136:151]
    ds_read_b64_tr_b16 v[224:225], v60 offset:49152
    buffer_load_dwordx2 v[202:203], v191, s[24:27], 0 offen offset:3072 sc1
    ds_read_b64_tr_b16 v[226:227], v60 offset:50688
    v_mfma_f32_32x32x16_bf16 v[120:135], v[240:243], a[104:107], v[120:135]
    ds_read_b64_tr_b16 v[228:229], v60 offset:49280
    buffer_load_dwordx2 v[204:205], v9, s[24:27], 0 offen offset:0 sc1
    ds_read_b64_tr_b16 v[230:231], v60 offset:50816
    v_mfma_f32_32x32x16_bf16 v[104:119], a[104:107], v[244:247], v[104:119]
    ds_read_b64_tr_b16 v[232:233], v60 offset:49408
    buffer_load_dwordx2 v[206:207], v9, s[24:27], 0 offen offset:1024 sc1
    ds_read_b64_tr_b16 v[234:235], v60 offset:50944
    s_waitcnt lgkmcnt(6)
    v_mfma_f32_32x32x16_bf16 v[136:151], v[212:215], a[108:111], v[136:151]
    ds_read_b64_tr_b16 v[236:237], v60 offset:55296
    buffer_load_dwordx2 v[208:209], v9, s[24:27], 0 offen offset:2048 sc1
    ds_read_b64_tr_b16 v[238:239], v60 offset:56832
    v_mfma_f32_32x32x16_bf16 v[120:135], v[216:219], a[108:111], v[120:135]
    ds_read_b64_tr_b16 v[240:241], v60 offset:55424
    buffer_load_dwordx2 v[210:211], v9, s[24:27], 0 offen offset:3072 sc1
    ds_read_b64_tr_b16 v[242:243], v60 offset:56960
    v_mfma_f32_32x32x16_bf16 v[104:119], a[108:111], v[220:223], v[104:119]
    s_xor_b32 s82, s90, 4
    s_mul_i32 s82, s82, 88064
    s_add_u32 m0, s84, 24576
    ds_read_b64_tr_b16 v[244:245], v60 offset:55552
    buffer_load_dwordx4 v48, s[16:19], s82 offen offset:0 lds
    ds_read_b64_tr_b16 v[246:247], v60 offset:57088
    s_waitcnt vmcnt(15)
    s_barrier
    s_waitcnt lgkmcnt(6)
    v_mfma_f32_32x32x16_bf16 v[136:151], v[224:227], a[112:115], v[136:151]
    ds_read_b64_tr_b16 v[212:213], v61 offset:12288
    buffer_load_dwordx4 v49, s[16:19], s82 offen offset:1024 lds
    ds_read_b64_tr_b16 v[214:215], v61 offset:13824
    v_mfma_f32_32x32x16_bf16 v[120:135], v[228:231], a[112:115], v[120:135]
    ds_read_b64_tr_b16 v[216:217], v61 offset:12416
    buffer_load_dwordx4 v50, s[16:19], s82 offen offset:2048 lds
    ds_read_b64_tr_b16 v[218:219], v61 offset:13952
    v_mfma_f32_32x32x16_bf16 v[104:119], a[112:115], v[232:235], v[104:119]
    s_xor_b32 s82, s90, 6
    s_mul_i32 s82, s82, 88064
    s_add_u32 m0, s84, 36864
    ds_read_b64_tr_b16 v[220:221], v61 offset:12544
    buffer_load_dwordx4 v48, s[16:19], s82 offen offset:0 lds
    ds_read_b64_tr_b16 v[222:223], v61 offset:14080
    s_waitcnt lgkmcnt(6)
    v_mfma_f32_32x32x16_bf16 v[136:151], v[236:239], a[116:119], v[136:151]
    ds_read_b64_tr_b16 v[224:225], v61 offset:18432
    buffer_load_dwordx4 v49, s[16:19], s82 offen offset:1024 lds
    ds_read_b64_tr_b16 v[226:227], v61 offset:19968
    v_mfma_f32_32x32x16_bf16 v[120:135], v[240:243], a[116:119], v[120:135]
    ds_read_b64_tr_b16 v[228:229], v61 offset:18560
    buffer_load_dwordx4 v50, s[16:19], s82 offen offset:2048 lds
    ds_read_b64_tr_b16 v[230:231], v61 offset:20096
    v_mfma_f32_32x32x16_bf16 v[104:119], a[116:119], v[244:247], v[104:119]
    ds_read_b64_tr_b16 v[232:233], v61 offset:18688
    ds_read_b64_tr_b16 v[234:235], v61 offset:20224
    ds_read_b128 a[168:171], v27 offset:0
    s_waitcnt lgkmcnt(7)
    v_mfma_f32_32x32x16_bf16 v[136:151], v[212:215], a[120:123], v[136:151]
    ds_read_b128 a[172:175], v27 offset:4096
    v_mfma_f32_32x32x16_bf16 v[120:135], v[216:219], a[120:123], v[120:135]
    ds_read_b128 a[176:179], v28 offset:0
    v_mfma_f32_32x32x16_bf16 v[104:119], a[120:123], v[220:223], v[104:119]
    ds_read_b128 a[180:183], v28 offset:4096
    s_waitcnt lgkmcnt(4)
    v_mfma_f32_32x32x16_bf16 v[136:151], v[224:227], a[124:127], v[136:151]
    ds_read_b128 a[184:187], v29 offset:0
    v_mfma_f32_32x32x16_bf16 v[120:135], v[228:231], a[124:127], v[120:135]
    ds_read_b128 a[188:191], v29 offset:4096
    v_mfma_f32_32x32x16_bf16 v[104:119], a[124:127], v[232:235], v[104:119]
    s_barrier
    s_waitcnt lgkmcnt(0)
    s_waitcnt vmcnt(11)
    v_min3_u32 v5, v197, v199, v201
    v_max3_u32 v6, v197, v199, v201
    s_waitcnt vmcnt(9)
    v_min3_u32 v5, v5, v203, v205
    v_max3_u32 v6, v6, v203, v205
    s_waitcnt vmcnt(7)
    v_min3_u32 v5, v5, v207, v209
    v_max3_u32 v6, v6, v207, v209
    s_waitcnt vmcnt(6)
    v_min_u32 v5, v5, v211
    v_max_u32 v6, v6, v211
    v_xor_b32 v5, s83, v5
    v_xor_b32 v6, s83, v6
    v_or_b32 v5, v5, v6
    v_cmp_ne_u32 vcc, 0, v5
    s_nop 0
    s_cbranch_vccnz L_slow_st_5
L_back_st_6:
    v_add_f32 v196, v196, v198
    v_add_f32 v196, v196, v200
    v_add_f32 v196, v196, v202
    v_add_f32 v196, v196, v204
    v_add_f32 v196, v196, v206
    v_add_f32 v196, v196, v208
    v_add_f32 v196, v196, v210
    v_mov_b32_e64 v198, v196
    s_cmp_eq_u32 s5, 0
    s_mov_b32 s76, 2048
    s_cmov_b32 s76, 0
    s_mov_b32 s77, 2304
    s_cmov_b32 s77, 256
    s_mov_b32 s78, 1280
    s_cmov_b32 s78, 1024
    v_permlane32_swap_b32_e64 v196, v198
    v_mul_f32 v196, 0x3abe82fa, v196
    v_mul_f32 v198, 0x3abe82fa, v198
    v_fma_f32 v202, -v196, v196, v198
    v_max_f32_e64 v202, 0, v202
    v_add_f32 v202, 0x3727c5ac, v202
    v_rsq_f32 v200, v202
    s_nop 0
    v_mul_f32 v201, -v196, v200
    v_pk_fma_f32 v[152:153], v[152:153], v[200:201], v[200:201] op_sel:[0,0,1] op_sel_hi:[1,0,1]
    v_pk_fma_f32 v[154:155], v[154:155], v[200:201], v[200:201] op_sel:[0,0,1] op_sel_hi:[1,0,1]
    v_pk_fma_f32 v[156:157], v[156:157], v[200:201], v[200:201] op_sel:[0,0,1] op_sel_hi:[1,0,1]
    v_pk_fma_f32 v[158:159], v[158:159], v[200:201], v[200:201] op_sel:[0,0,1] op_sel_hi:[1,0,1]
    v_pk_fma_f32 v[160:161], v[160:161], v[200:201], v[200:201] op_sel:[0,0,1] op_sel_hi:[1,0,1]
    v_pk_fma_f32 v[162:163], v[162:163], v[200:201], v[200:201] op_sel:[0,0,1] op_sel_hi:[1,0,1]
    v_pk_fma_f32 v[164:165], v[164:165], v[200:201], v[200:201] op_sel:[0,0,1] op_sel_hi:[1,0,1]
    v_pk_fma_f32 v[166:167], v[166:167], v[200:201], v[200:201] op_sel:[0,0,1] op_sel_hi:[1,0,1]
    v_pk_fma_f32 v[168:169], v[168:169], v[200:201], v[200:201] op_sel:[0,0,1] op_sel_hi:[1,0,1]
    v_pk_fma_f32 v[170:171], v[170:171], v[200:201], v[200:201] op_sel:[0,0,1] op_sel_hi:[1,0,1]
    v_pk_fma_f32 v[172:173], v[172:173], v[200:201], v[200:201] op_sel:[0,0,1] op_sel_hi:[1,0,1]
    v_pk_fma_f32 v[174:175], v[174:175], v[200:201], v[200:201] op_sel:[0,0,1] op_sel_hi:[1,0,1]
    v_cvt_pk_bf16_f32 v152, v152, v153
    v_cvt_pk_bf16_f32 v153, v154, v155
    ds_write_b64 v184, v[152:153] offset:0
    v_cvt_pk_bf16_f32 v154, v156, v157
    v_cvt_pk_bf16_f32 v155, v158, v159
    ds_write_b64 v184, v[154:155] offset:16
    v_cvt_pk_bf16_f32 v156, v160, v161
    v_cvt_pk_bf16_f32 v157, v162, v163
    ds_write_b64 v184, v[156:157] offset:32
    v_cvt_pk_bf16_f32 v158, v164, v165
    v_cvt_pk_bf16_f32 v159, v166, v167
    ds_write_b64 v184, v[158:159] offset:48
    s_xor_b32 s82, s90, 8
    s_mul_i32 s82, s82, 88064
    s_add_u32 m0, s84, 49152
    s_nop 0
    buffer_load_dwordx4 v48, s[16:19], s82 offen offset:0 lds
    v_cvt_pk_bf16_f32 v160, v168, v169
    v_cvt_pk_bf16_f32 v161, v170, v171
    ds_write_b64 v184, v[160:161] offset:64
    v_cvt_pk_bf16_f32 v162, v172, v173
    v_cvt_pk_bf16_f32 v163, v174, v175
    ds_write_b64 v184, v[162:163] offset:80
    ds_read_b64_tr_b16 v[164:165], v185 offset:0
    ds_read_b64_tr_b16 v[166:167], v185 offset:416
    ds_read_b64_tr_b16 v[168:169], v185 offset:32
    ds_read_b64_tr_b16 v[170:171], v185 offset:448
    ds_read_b64_tr_b16 v[172:173], v185 offset:64
    ds_read_b64_tr_b16 v[174:175], v185 offset:480
    s_waitcnt lgkmcnt(4)
    buffer_store_dwordx4 v[164:167], v186, s[24:27], s76 offen sc1
    s_waitcnt lgkmcnt(2)
    buffer_store_dwordx4 v[168:171], v186, s[24:27], s77 offen sc1
    s_waitcnt lgkmcnt(0)
    buffer_store_dwordx4 v[172:175], v186, s[24:27], s78 offen sc1
    v_cvt_pk_bf16_f32 v120, v120, v121
    v_cvt_pk_bf16_f32 v121, v122, v123
    v_cvt_pk_bf16_f32 v122, v124, v125
    v_cvt_pk_bf16_f32 v123, v126, v127
    v_cvt_pk_bf16_f32 v124, v128, v129
    v_cvt_pk_bf16_f32 v125, v130, v131
    v_cvt_pk_bf16_f32 v126, v132, v133
    v_cvt_pk_bf16_f32 v127, v134, v135
    v_mfma_f32_32x32x16_bf16 v[196:211], v[18:21], v[120:123], 0
    s_nop 0
    v_mfma_f32_32x32x16_bf16 v[196:211], v[22:25], v[124:127], v[196:211]
    v_cvt_pk_bf16_f32 v104, v104, v105
    v_cvt_pk_bf16_f32 v105, v106, v107
    v_cvt_pk_bf16_f32 v106, v108, v109
    v_cvt_pk_bf16_f32 v107, v110, v111
    v_cvt_pk_bf16_f32 v108, v112, v113
    v_cvt_pk_bf16_f32 v109, v114, v115
    buffer_load_dwordx4 v49, s[16:19], s82 offen offset:1024 lds
    v_cvt_pk_bf16_f32 v110, v116, v117
    v_cvt_pk_bf16_f32 v111, v118, v119
    v_add_u32_e64 v4, s60, v42
    ds_write_b128 v4, v[104:107] offset:4096
    ds_write_b128 v4, v[108:111] offset:5120
    v_xor_b32 v5, 16, v187
    v_xor_b32 v6, 32, v187
    v_xor_b32_e64 v7, 48, v187
    v_max3_f32 v176, v196, v197, v198
    v_max3_f32 v176, v176, v199, v200
    v_max3_f32 v176, v176, v201, v202
    v_max_f32_e64 v176, v176, v203
    v_min3_f32 v178, v196, v197, v198
    v_min3_f32 v178, v178, v199, v200
    v_min3_f32 v178, v178, v201, v202
    v_min_f32_e64 v178, v178, v203
    buffer_load_dwordx4 v50, s[16:19], s82 offen offset:2048 lds
    v_max3_f32 v180, v204, v205, v206
    v_max3_f32 v180, v180, v207, v208
    v_max3_f32 v180, v180, v209, v210
    v_max_f32_e64 v180, v180, v211
    v_min3_f32 v182, v204, v205, v206
    v_min3_f32 v182, v182, v207, v208
    v_min3_f32 v182, v182, v209, v210
    v_min_f32 v182, v182, v211
    v_mov_b32 v177, v176
    v_mov_b32 v179, v178
    v_mov_b32 v181, v180
    v_mov_b32 v183, v182
    v_permlane32_swap_b32 v176, v177
    v_permlane32_swap_b32 v178, v179
    v_permlane32_swap_b32 v180, v181
    v_permlane32_swap_b32 v182, v183
    s_xor_b32 s82, s90, 10
    s_mul_i32 s82, s82, 88064
    s_add_u32 m0, s84, 61440
    s_nop 0
    buffer_load_dwordx4 v48, s[16:19], s82 offen offset:0 lds
    v_max_f32 v176, v176, v177
    v_min_f32 v177, v178, v179
    v_max_f32 v180, v180, v181
    v_min_f32 v181, v182, v183
    v_mul_f32 v176, v36, v176
    v_mul_f32 v177, v36, v177
    v_mul_f32 v180, v36, v180
    v_mul_f32_e64 v181, v36, v181
    v_pk_fma_f32 v[88:89], v[196:197], v[36:37], v[176:177] op_sel:[0,0,0] op_sel_hi:[1,0,0] neg_lo:[0,0,1] neg_hi:[0,0,1]
    v_pk_fma_f32 v[96:97], v[196:197], v[36:37], v[176:177] op_sel:[0,0,1] op_sel_hi:[1,0,1] neg_lo:[1,0,0] neg_hi:[1,0,0]
    v_pk_fma_f32 v[90:91], v[198:199], v[36:37], v[176:177] op_sel:[0,0,0] op_sel_hi:[1,0,0] neg_lo:[0,0,1] neg_hi:[0,0,1]
    v_pk_fma_f32 v[98:99], v[198:199], v[36:37], v[176:177] op_sel:[0,0,1] op_sel_hi:[1,0,1] neg_lo:[1,0,0] neg_hi:[1,0,0]
    v_pk_fma_f32 v[92:93], v[200:201], v[36:37], v[176:177] op_sel:[0,0,0] op_sel_hi:[1,0,0] neg_lo:[0,0,1] neg_hi:[0,0,1]
    v_pk_fma_f32 v[100:101], v[200:201], v[36:37], v[176:177] op_sel:[0,0,1] op_sel_hi:[1,0,1] neg_lo:[1,0,0] neg_hi:[1,0,0]
    v_pk_fma_f32 v[94:95], v[202:203], v[36:37], v[176:177] op_sel:[0,0,0] op_sel_hi:[1,0,0] neg_lo:[0,0,1] neg_hi:[0,0,1]
    v_pk_fma_f32 v[102:103], v[202:203], v[36:37], v[176:177] op_sel:[0,0,1] op_sel_hi:[1,0,1] neg_lo:[1,0,0] neg_hi:[1,0,0]
    buffer_load_dwordx4 v49, s[16:19], s82 offen offset:1024 lds
    v_exp_f32 v88, v88
    v_exp_f32 v89, v89
    v_exp_f32 v90, v90
    v_exp_f32 v91, v91
    v_exp_f32 v92, v92
    v_exp_f32 v93, v93
    v_exp_f32 v94, v94
    v_exp_f32 v95, v95
    v_exp_f32 v96, v96
    v_exp_f32 v97, v97
    v_exp_f32 v98, v98
    v_exp_f32 v99, v99
    v_exp_f32 v100, v100
    v_exp_f32 v101, v101
    v_exp_f32 v102, v102
    v_exp_f32 v103, v103
    buffer_load_dwordx4 v50, s[16:19], s82 offen offset:2048 lds
    v_pk_add_f32 v[196:197], v[88:89], v[90:91]
    v_pk_add_f32 v[198:199], v[96:97], v[98:99]
    v_pk_add_f32 v[196:197], v[196:197], v[92:93]
    v_pk_add_f32 v[198:199], v[198:199], v[100:101]
    v_pk_add_f32 v[196:197], v[196:197], v[94:95]
    v_pk_add_f32 v[198:199], v[198:199], v[102:103]
    v_add_f32 v196, v196, v197
    v_add_f32 v198, v198, v199
    v_mov_b32 v197, v196
    v_mov_b32 v199, v198
    s_nop 0
    v_permlane32_swap_b32 v196, v197
    v_permlane32_swap_b32 v198, v199
    v_add_f32 v196, v196, v197
    v_add_f32 v197, v198, v199
    v_rcp_f32 v196, v196
    v_rcp_f32_e64 v197, v197
    s_xor_b32 s82, s91, 2
    s_lshl_b32 s82, s82, 7
    s_add_u32 s82, s82, s57
    s_add_u32 m0, s58, 98304
    s_nop 0
    buffer_load_dwordx4 v34, s[20:23], s82 offen offset:0 lds
    v_pk_mul_f32 v[88:89], v[88:89], v[196:197] op_sel:[0,0] op_sel_hi:[1,0]
    v_pk_mul_f32 v[96:97], v[96:97], v[196:197] op_sel:[0,1] op_sel_hi:[1,1]
    v_pk_mul_f32 v[90:91], v[90:91], v[196:197] op_sel:[0,0] op_sel_hi:[1,0]
    v_pk_mul_f32 v[98:99], v[98:99], v[196:197] op_sel:[0,1] op_sel_hi:[1,1]
    v_pk_mul_f32 v[92:93], v[92:93], v[196:197] op_sel:[0,0] op_sel_hi:[1,0]
    v_pk_mul_f32 v[100:101], v[100:101], v[196:197] op_sel:[0,1] op_sel_hi:[1,1]
    v_pk_mul_f32 v[94:95], v[94:95], v[196:197] op_sel:[0,0] op_sel_hi:[1,0]
    v_pk_mul_f32 v[102:103], v[102:103], v[196:197] op_sel:[0,1] op_sel_hi:[1,1]
    v_cvt_pk_bf16_f32 v120, v88, v89
    v_cvt_pk_bf16_f32 v121, v90, v91
    v_cvt_pk_bf16_f32 v122, v92, v93
    v_cvt_pk_bf16_f32 v123, v94, v95
    v_cvt_pk_bf16_f32 v124, v96, v97
    v_cvt_pk_bf16_f32 v125, v98, v99
    v_cvt_pk_bf16_f32 v126, v100, v101
    v_cvt_pk_bf16_f32 v127, v102, v103
    s_add_u32 s82, s82, 31744
    buffer_load_dwordx4 v35, s[20:23], s82 offen offset:1024 lds
    v_pk_fma_f32 v[88:89], v[204:205], v[36:37], v[180:181] op_sel:[0,0,0] op_sel_hi:[1,0,0] neg_lo:[0,0,1] neg_hi:[0,0,1]
    v_pk_fma_f32 v[96:97], v[204:205], v[36:37], v[180:181] op_sel:[0,0,1] op_sel_hi:[1,0,1] neg_lo:[1,0,0] neg_hi:[1,0,0]
    v_pk_fma_f32 v[90:91], v[206:207], v[36:37], v[180:181] op_sel:[0,0,0] op_sel_hi:[1,0,0] neg_lo:[0,0,1] neg_hi:[0,0,1]
    v_pk_fma_f32 v[98:99], v[206:207], v[36:37], v[180:181] op_sel:[0,0,1] op_sel_hi:[1,0,1] neg_lo:[1,0,0] neg_hi:[1,0,0]
    v_pk_fma_f32 v[92:93], v[208:209], v[36:37], v[180:181] op_sel:[0,0,0] op_sel_hi:[1,0,0] neg_lo:[0,0,1] neg_hi:[0,0,1]
    v_pk_fma_f32 v[100:101], v[208:209], v[36:37], v[180:181] op_sel:[0,0,1] op_sel_hi:[1,0,1] neg_lo:[1,0,0] neg_hi:[1,0,0]
    v_pk_fma_f32 v[94:95], v[210:211], v[36:37], v[180:181] op_sel:[0,0,0] op_sel_hi:[1,0,0] neg_lo:[0,0,1] neg_hi:[0,0,1]
    v_pk_fma_f32 v[102:103], v[210:211], v[36:37], v[180:181] op_sel:[0,0,1] op_sel_hi:[1,0,1] neg_lo:[1,0,0] neg_hi:[1,0,0]
    v_exp_f32 v88, v88
    v_exp_f32 v89, v89
    v_exp_f32 v90, v90
    v_exp_f32 v91, v91
    v_exp_f32 v92, v92
    v_exp_f32 v93, v93
    v_exp_f32 v94, v94
    v_exp_f32 v95, v95
    s_add_u32 s82, s82, 31744
    buffer_load_dwordx4 v34, s[20:23], s82 offen offset:2048 lds
    v_exp_f32 v96, v96
    v_exp_f32 v97, v97
    v_exp_f32 v98, v98
    v_exp_f32 v99, v99
    v_exp_f32 v100, v100
    v_exp_f32 v101, v101
    v_exp_f32 v102, v102
    v_exp_f32 v103, v103
    v_pk_add_f32 v[204:205], v[88:89], v[90:91]
    v_pk_add_f32 v[206:207], v[96:97], v[98:99]
    v_pk_add_f32 v[204:205], v[204:205], v[92:93]
    v_pk_add_f32 v[206:207], v[206:207], v[100:101]
    v_pk_add_f32 v[204:205], v[204:205], v[94:95]
    v_pk_add_f32 v[206:207], v[206:207], v[102:103]
    v_add_f32 v204, v204, v205
    v_add_f32 v206, v206, v207
    s_add_u32 s82, s82, 31744
    buffer_load_dwordx4 v35, s[20:23], s82 offen offset:3072 lds
    v_mov_b32 v205, v204
    v_mov_b32 v207, v206
    s_nop 0
    v_permlane32_swap_b32 v204, v205
    v_permlane32_swap_b32 v206, v207
    v_add_f32 v204, v204, v205
    v_add_f32 v205, v206, v207
    v_rcp_f32 v204, v204
    v_rcp_f32 v205, v205
    s_nop 0
    v_pk_mul_f32 v[88:89], v[88:89], v[204:205] op_sel:[0,0] op_sel_hi:[1,0]
    v_pk_mul_f32 v[96:97], v[96:97], v[204:205] op_sel:[0,1] op_sel_hi:[1,1]
    v_pk_mul_f32 v[90:91], v[90:91], v[204:205] op_sel:[0,0] op_sel_hi:[1,0]
    v_pk_mul_f32 v[98:99], v[98:99], v[204:205] op_sel:[0,1] op_sel_hi:[1,1]
    v_pk_mul_f32 v[92:93], v[92:93], v[204:205] op_sel:[0,0] op_sel_hi:[1,0]
    v_pk_mul_f32 v[100:101], v[100:101], v[204:205] op_sel:[0,1] op_sel_hi:[1,1]
    v_pk_mul_f32 v[94:95], v[94:95], v[204:205] op_sel:[0,0] op_sel_hi:[1,0]
    v_pk_mul_f32 v[102:103], v[102:103], v[204:205] op_sel:[0,1] op_sel_hi:[1,1]
    s_add_u32 s82, s82, s59
    s_add_u32 m0, s58, 102400
    s_nop 0
    buffer_load_dwordx4 v34, s[20:23], s82 offen offset:0 lds
    v_cvt_pk_bf16_f32 v128, v88, v89
    v_cvt_pk_bf16_f32 v129, v90, v91
    v_cvt_pk_bf16_f32 v130, v92, v93
    v_cvt_pk_bf16_f32 v131, v94, v95
    v_cvt_pk_bf16_f32 v132, v96, v97
    v_cvt_pk_bf16_f32 v133, v98, v99
    v_cvt_pk_bf16_f32 v134, v100, v101
    v_cvt_pk_bf16_f32 v135, v102, v103
    ds_write_b64 v187, v[120:121] offset:0
    ds_write_b64 v187, v[128:129] offset:2048
    ds_write_b64 v5, v[122:123] offset:0
    ds_write_b64 v5, v[130:131] offset:2048
    ds_write_b64 v6, v[124:125] offset:0
    ds_write_b64 v6, v[132:133] offset:2048
    ds_write_b64 v7, v[126:127] offset:0
    ds_write_b64 v7, v[134:135] offset:2048
    s_add_u32 s82, s82, 31744
    buffer_load_dwordx4 v35, s[20:23], s82 offen offset:1024 lds
    s_waitcnt vmcnt(11)
    s_waitcnt lgkmcnt(0)
    s_barrier
    s_cmp_lg_u32 s3, 0
    s_cbranch_scc1 L_w0_8
    s_lshl_b32 s76, s7, 12
    s_lshl_b32 s81, s6, 7
    s_add_u32 s76, s76, s81
    s_add_u32 s76, s76, 13107200
    v_mov_b32 v8, s76
    v_mov_b32 v9, s83
    s_mov_b64 exec, 1
    buffer_store_dword v9, v8, s[24:27], 0 offen sc1
    s_mov_b64 exec, -1
L_w0_8:
    s_mul_i32 s76, s5, 6144
    v_add_u32_e64 v7, s76, v42
    ds_read_b128 v[104:107], v7 offset:4096
    ds_read_b128 v[108:111], v7 offset:5120
    ds_read_b128 v[112:115], v7 offset:16384
    ds_read_b128 v[116:119], v7 offset:17408
    ds_read_b64_tr_b16 v[120:121], v188 offset:0
    ds_read_b64_tr_b16 v[122:123], v189 offset:512
    ds_read_b64_tr_b16 v[124:125], v188 offset:1024
    ds_read_b64_tr_b16 v[126:127], v189 offset:1536
    ds_read_b64_tr_b16 v[128:129], v188 offset:12288
    ds_read_b64_tr_b16 v[130:131], v189 offset:12800
    ds_read_b64_tr_b16 v[132:133], v188 offset:13312
    ds_read_b64_tr_b16 v[134:135], v189 offset:13824
    s_cmp_eq_u32 s4, 0
    s_mov_b32 s78, 0x0000ffff
    s_cmov_b32 s78, 0xffff0000
    s_mov_b32 s79, s78
    v_mov_b32_e64 v7, s61
    s_waitcnt lgkmcnt(11)
    v_cndmask_b32 v104, v104, v7, s[78:79]
    v_cndmask_b32 v105, v105, v7, s[78:79]
    s_add_u32 s82, s82, 31744
    buffer_load_dwordx4 v34, s[20:23], s82 offen offset:2048 lds
    v_cndmask_b32 v106, v106, v7, s[78:79]
    v_cndmask_b32 v107, v107, v7, s[78:79]
    s_waitcnt lgkmcnt(10)
    v_cndmask_b32 v108, v108, v7, s[78:79]
    v_cndmask_b32 v109, v109, v7, s[78:79]
    v_cndmask_b32 v110, v110, v7, s[78:79]
    v_cndmask_b32 v111, v111, v7, s[78:79]
    s_waitcnt lgkmcnt(9)
    v_cndmask_b32 v112, v112, v7, s[78:79]
    v_cndmask_b32 v113, v113, v7, s[78:79]
    v_cndmask_b32 v114, v114, v7, s[78:79]
    v_cndmask_b32 v115, v115, v7, s[78:79]
    s_waitcnt lgkmcnt(8)
    v_cndmask_b32 v116, v116, v7, s[78:79]
    v_cndmask_b32 v117, v117, v7, s[78:79]
    v_cndmask_b32 v118, v118, v7, s[78:79]
    v_cndmask_b32 v119, v119, v7, s[78:79]
    s_waitcnt lgkmcnt(6)
    v_mfma_f32_32x32x16_bf16 v[196:211], v[120:123], v[104:107], 0
    s_waitcnt lgkmcnt(4)
    v_mfma_f32_32x32x16_bf16 v[196:211], v[124:127], v[108:111], v[196:211]
    s_add_u32 s82, s82, 31744
    buffer_load_dwordx4 v35, s[20:23], s82 offen offset:3072 lds
    s_waitcnt lgkmcnt(2)
    v_mfma_f32_32x32x16_bf16 v[196:211], v[128:131], v[112:115], v[196:211]
    s_waitcnt lgkmcnt(0)
    v_mfma_f32_32x32x16_bf16 v[196:211], v[132:135], v[116:119], v[196:211]
    s_mov_b32 s76, 0
    s_nop 10
    buffer_store_dwordx4 v[196:199], v190, s[24:27], s76 offen sc1
    s_mov_b32 s76, 32768
    buffer_store_dwordx4 v[200:203], v190, s[24:27], s76 offen sc1
    s_mov_b32 s76, 65536
    buffer_store_dwordx4 v[204:207], v190, s[24:27], s76 offen sc1
    s_mov_b32 s76, 98304
    buffer_store_dwordx4 v[208:211], v190, s[24:27], s76 offen sc1
    ds_read_b64_tr_b16 v[212:213], v58 offset:24576
    ds_read_b64_tr_b16 v[214:215], v58 offset:25344
    ds_read_b64_tr_b16 v[216:217], v59 offset:24576
    ds_read_b64_tr_b16 v[218:219], v59 offset:25344
    ds_read_b64_tr_b16 v[220:221], v58 offset:27648
    ds_read_b64_tr_b16 v[222:223], v58 offset:28416
    ds_read_b64_tr_b16 v[224:225], v59 offset:27648
    ds_read_b64_tr_b16 v[226:227], v59 offset:28416
    s_waitcnt lgkmcnt(4)
    v_mfma_f32_32x32x16_bf16 v[152:167], v[212:215], a[0:3], 0
    s_xor_b32 s82, s91, 3
    s_lshl_b32 s82, s82, 7
    s_add_u32 s82, s82, s57
    s_add_u32 m0, s58, 131072
    ds_read_b64_tr_b16 v[228:229], v58 offset:30720
    buffer_load_dwordx4 v34, s[20:23], s82 offen offset:0 lds
    ds_read_b64_tr_b16 v[230:231], v58 offset:31488
    v_mfma_f32_32x32x16_bf16 v[168:183], v[216:219], a[0:3], 0
    s_add_u32 s82, s82, 31744
    ds_read_b64_tr_b16 v[232:233], v59 offset:30720
    buffer_load_dwordx4 v35, s[20:23], s82 offen offset:1024 lds
    ds_read_b64_tr_b16 v[234:235], v59 offset:31488
    s_waitcnt lgkmcnt(4)
    v_mfma_f32_32x32x16_bf16 v[152:167], v[220:223], a[4:7], v[152:167]
    s_add_u32 s82, s82, 31744
    ds_read_b64_tr_b16 v[212:213], v58 offset:33792
    buffer_load_dwordx4 v34, s[20:23], s82 offen offset:2048 lds
    ds_read_b64_tr_b16 v[214:215], v58 offset:34560
    v_mfma_f32_32x32x16_bf16 v[168:183], v[224:227], a[4:7], v[168:183]
    s_add_u32 s82, s82, 31744
    ds_read_b64_tr_b16 v[216:217], v59 offset:33792
    buffer_load_dwordx4 v35, s[20:23], s82 offen offset:3072 lds
    ds_read_b64_tr_b16 v[218:219], v59 offset:34560
    s_barrier
    s_waitcnt lgkmcnt(4)
    v_mfma_f32_32x32x16_bf16 v[152:167], v[228:231], a[8:11], v[152:167]
    s_add_u32 s82, s82, s59
    s_add_u32 m0, s58, 135168
    ds_read_b64_tr_b16 v[220:221], v58 offset:36864
    buffer_load_dwordx4 v34, s[20:23], s82 offen offset:0 lds
    ds_read_b64_tr_b16 v[222:223], v58 offset:37632
    v_mfma_f32_32x32x16_bf16 v[168:183], v[232:235], a[8:11], v[168:183]
    s_add_u32 s82, s82, 31744
    ds_read_b64_tr_b16 v[224:225], v59 offset:36864
    buffer_load_dwordx4 v35, s[20:23], s82 offen offset:1024 lds
    ds_read_b64_tr_b16 v[226:227], v59 offset:37632
    s_waitcnt lgkmcnt(4)
    v_mfma_f32_32x32x16_bf16 v[152:167], v[212:215], a[12:15], v[152:167]
    s_add_u32 s82, s82, 31744
    ds_read_b64_tr_b16 v[228:229], v58 offset:39936
    buffer_load_dwordx4 v34, s[20:23], s82 offen offset:2048 lds
    ds_read_b64_tr_b16 v[230:231], v58 offset:40704
    v_mfma_f32_32x32x16_bf16 v[168:183], v[216:219], a[12:15], v[168:183]
    s_add_u32 s82, s82, 31744
    ds_read_b64_tr_b16 v[232:233], v59 offset:39936
    buffer_load_dwordx4 v35, s[20:23], s82 offen offset:3072 lds
    ds_read_b64_tr_b16 v[234:235], v59 offset:40704
    s_waitcnt lgkmcnt(4)
    v_mfma_f32_32x32x16_bf16 v[152:167], v[220:223], a[16:19], v[152:167]
    ds_read_b64_tr_b16 v[212:213], v58 offset:43008
    ds_read_b64_tr_b16 v[214:215], v58 offset:43776
    v_mfma_f32_32x32x16_bf16 v[168:183], v[224:227], a[16:19], v[168:183]
    ds_read_b64_tr_b16 v[216:217], v59 offset:43008
    ds_read_b64_tr_b16 v[218:219], v59 offset:43776
    s_waitcnt lgkmcnt(4)
    v_mfma_f32_32x32x16_bf16 v[152:167], v[228:231], a[20:23], v[152:167]
    ds_read_b64_tr_b16 v[220:221], v58 offset:46080
    ds_read_b64_tr_b16 v[222:223], v58 offset:46848
    v_mfma_f32_32x32x16_bf16 v[168:183], v[232:235], a[20:23], v[168:183]
    ds_read_b64_tr_b16 v[224:225], v59 offset:46080
    ds_read_b64_tr_b16 v[226:227], v59 offset:46848
    s_barrier
    s_waitcnt vmcnt(8)
    s_lshl_b32 s76, s7, 14
    s_lshl_b32 s81, s5, 13
    s_add_u32 s76, s76, s81
    s_lshl_b32 s81, s4, 12
    s_add_u32 s76, s76, s81
    s_lshl_b32 s81, s6, 7
    s_add_u32 s76, s76, s81
    s_add_u32 s76, s76, 13303808
    v_mov_b32 v8, s76
    v_mov_b32 v9, s83
    s_mov_b64 exec, 1
    buffer_store_dword v9, v8, s[24:27], 0 offen sc1
    s_mov_b64 exec, -1
    s_waitcnt lgkmcnt(4)
    v_mfma_f32_32x32x16_bf16 v[152:167], v[212:215], a[24:27], v[152:167]
    s_xor_b32 s82, s90, 12
    s_mul_i32 s82, s82, 88064
    s_add_u32 m0, s84, 73728
    ds_read_b64_tr_b16 v[228:229], v56 offset:24576
    buffer_load_dwordx4 v48, s[16:19], s82 offen offset:0 lds
    ds_read_b64_tr_b16 v[230:231], v56 offset:25344
    v_mfma_f32_32x32x16_bf16 v[168:183], v[216:219], a[24:27], v[168:183]
    ds_read_b64_tr_b16 v[232:233], v57 offset:24576
    buffer_load_dwordx4 v49, s[16:19], s82 offen offset:1024 lds
    ds_read_b64_tr_b16 v[234:235], v57 offset:25344
    s_waitcnt lgkmcnt(4)
    v_mfma_f32_32x32x16_bf16 v[152:167], v[220:223], a[28:31], v[152:167]
    ds_read_b64_tr_b16 v[212:213], v56 offset:27648
    buffer_load_dwordx4 v50, s[16:19], s82 offen offset:2048 lds
    ds_read_b64_tr_b16 v[214:215], v56 offset:28416
    v_mfma_f32_32x32x16_bf16 v[168:183], v[224:227], a[28:31], v[168:183]
    ds_read_b64_tr_b16 v[216:217], v57 offset:27648
    ds_read_b64_tr_b16 v[218:219], v57 offset:28416
    s_waitcnt lgkmcnt(4)
    v_mfma_f32_32x32x16_bf16 v[152:167], v[228:231], a[32:35], v[152:167]
    ds_read_b64_tr_b16 v[220:221], v56 offset:30720
    ds_read_b64_tr_b16 v[222:223], v56 offset:31488
    v_mfma_f32_32x32x16_bf16 v[168:183], v[232:235], a[32:35], v[168:183]
    ds_read_b64_tr_b16 v[224:225], v57 offset:30720
    ds_read_b64_tr_b16 v[226:227], v57 offset:31488
    s_waitcnt lgkmcnt(4)
    v_mfma_f32_32x32x16_bf16 v[152:167], v[212:215], a[36:39], v[152:167]
    ds_read_b64_tr_b16 v[228:229], v56 offset:33792
    ds_read_b64_tr_b16 v[230:231], v56 offset:34560
    v_mfma_f32_32x32x16_bf16 v[168:183], v[216:219], a[36:39], v[168:183]
    ds_read_b64_tr_b16 v[232:233], v57 offset:33792
    ds_read_b64_tr_b16 v[234:235], v57 offset:34560
    s_barrier
    s_waitcnt lgkmcnt(4)
    v_mfma_f32_32x32x16_bf16 v[152:167], v[220:223], a[40:43], v[152:167]
    s_xor_b32 s82, s90, 14
    s_mul_i32 s82, s82, 88064
    s_add_u32 m0, s84, 86016
    ds_read_b64_tr_b16 v[212:213], v56 offset:36864
    buffer_load_dwordx4 v48, s[16:19], s82 offen offset:0 lds
    ds_read_b64_tr_b16 v[214:215], v56 offset:37632
    v_mfma_f32_32x32x16_bf16 v[168:183], v[224:227], a[40:43], v[168:183]
    ds_read_b64_tr_b16 v[216:217], v57 offset:36864
    buffer_load_dwordx4 v49, s[16:19], s82 offen offset:1024 lds
    ds_read_b64_tr_b16 v[218:219], v57 offset:37632
    s_waitcnt lgkmcnt(4)
    v_mfma_f32_32x32x16_bf16 v[152:167], v[228:231], a[44:47], v[152:167]
    ds_read_b64_tr_b16 v[220:221], v56 offset:39936
    buffer_load_dwordx4 v50, s[16:19], s82 offen offset:2048 lds
    ds_read_b64_tr_b16 v[222:223], v56 offset:40704
    v_mfma_f32_32x32x16_bf16 v[168:183], v[232:235], a[44:47], v[168:183]
    ds_read_b64_tr_b16 v[224:225], v57 offset:39936
    ds_read_b64_tr_b16 v[226:227], v57 offset:40704
    v_add_u32 v26, 98304, v41
    v_xor_b32 v27, 32, v26
    v_xor_b32_e64 v28, 64, v26
    v_xor_b32 v29, 96, v26
    s_waitcnt lgkmcnt(4)
    v_mfma_f32_32x32x16_bf16 v[152:167], v[212:215], a[48:51], v[152:167]
    ds_read_b64_tr_b16 v[228:229], v56 offset:43008
    ds_read_b64_tr_b16 v[230:231], v56 offset:43776
    ds_read_b128 a[192:195], v26 offset:0
    v_mfma_f32_32x32x16_bf16 v[168:183], v[216:219], a[48:51], v[168:183]
    ds_read_b64_tr_b16 v[232:233], v57 offset:43008
    ds_read_b64_tr_b16 v[234:235], v57 offset:43776
    ds_read_b128 a[196:199], v26 offset:4096
    s_waitcnt lgkmcnt(6)
    v_mfma_f32_32x32x16_bf16 v[152:167], v[220:223], a[52:55], v[152:167]
    ds_read_b64_tr_b16 v[212:213], v56 offset:46080
    ds_read_b64_tr_b16 v[214:215], v56 offset:46848
    ds_read_b128 a[200:203], v27 offset:0
    v_mfma_f32_32x32x16_bf16 v[168:183], v[224:227], a[52:55], v[168:183]
    ds_read_b64_tr_b16 v[216:217], v57 offset:46080
    ds_read_b64_tr_b16 v[218:219], v57 offset:46848
    ds_read_b128 a[204:207], v27 offset:4096
    s_barrier
    s_waitcnt lgkmcnt(7)
    v_mfma_f32_32x32x16_bf16 v[152:167], v[228:231], a[56:59], v[152:167]
    ds_read_b64_tr_b16 v[220:221], v56 offset:49152
    ds_read_b64_tr_b16 v[222:223], v56 offset:49920
    ds_read_b128 a[208:211], v28 offset:0
    v_mfma_f32_32x32x16_bf16 v[168:183], v[232:235], a[56:59], v[168:183]
    ds_read_b64_tr_b16 v[224:225], v57 offset:49152
    ds_read_b64_tr_b16 v[226:227], v57 offset:49920
    ds_read_b128 a[212:215], v28 offset:4096
    s_waitcnt lgkmcnt(7)
    v_mfma_f32_32x32x16_bf16 v[152:167], v[212:215], a[60:63], v[152:167]
    ds_read_b64_tr_b16 v[228:229], v56 offset:52224
    ds_read_b64_tr_b16 v[230:231], v56 offset:52992
    ds_read_b128 a[216:219], v29 offset:0
    v_mfma_f32_32x32x16_bf16 v[168:183], v[216:219], a[60:63], v[168:183]
    ds_read_b64_tr_b16 v[232:233], v57 offset:52224
    ds_read_b64_tr_b16 v[234:235], v57 offset:52992
    ds_read_b128 a[220:223], v29 offset:4096
    s_waitcnt lgkmcnt(7)
    v_mfma_f32_32x32x16_bf16 v[152:167], v[220:223], a[64:67], v[152:167]
    ds_read_b64_tr_b16 v[212:213], v56 offset:55296
    ds_read_b64_tr_b16 v[214:215], v56 offset:56064
    s_waitcnt vmcnt(7)
    v_add_u32 v26, 131072, v41
    v_xor_b32 v27, 32, v26
    v_xor_b32 v28, 64, v26
    v_xor_b32 v29, 96, v26
    v_mfma_f32_32x32x16_bf16 v[168:183], v[224:227], a[64:67], v[168:183]
    ds_read_b64_tr_b16 v[216:217], v57 offset:55296
    ds_read_b64_tr_b16 v[218:219], v57 offset:56064
    ds_read_b128 a[224:227], v26 offset:0
    s_waitcnt lgkmcnt(6)
    v_mfma_f32_32x32x16_bf16 v[152:167], v[228:231], a[68:71], v[152:167]
    ds_read_b64_tr_b16 v[220:221], v58 offset:9216
    ds_read_b64_tr_b16 v[222:223], v58 offset:9984
    ds_read_b128 a[228:231], v26 offset:4096
    v_mfma_f32_32x32x16_bf16 v[168:183], v[232:235], a[68:71], v[168:183]
    ds_read_b64_tr_b16 v[224:225], v59 offset:9216
    ds_read_b64_tr_b16 v[226:227], v59 offset:9984
    ds_read_b128 a[232:235], v27 offset:0
    s_barrier
    s_waitcnt lgkmcnt(11)
    s_waitcnt lgkmcnt(7)
    v_mfma_f32_32x32x16_bf16 v[152:167], v[212:215], a[72:75], v[152:167]
    s_xor_b32 s82, s91, 4
    s_lshl_b32 s82, s82, 7
    s_add_u32 s82, s82, s57
    s_add_u32 m0, s58, 98304
    ds_read_b64_tr_b16 v[228:229], v58 offset:12288
    buffer_load_dwordx4 v34, s[20:23], s82 offen offset:0 lds
    ds_read_b64_tr_b16 v[230:231], v58 offset:13056
    v_mfma_f32_32x32x16_bf16 v[168:183], v[216:219], a[72:75], v[168:183]
    s_add_u32 s82, s82, 31744
    ds_read_b64_tr_b16 v[232:233], v59 offset:12288
    buffer_load_dwordx4 v35, s[20:23], s82 offen offset:1024 lds
    ds_read_b64_tr_b16 v[234:235], v59 offset:13056
    s_waitcnt lgkmcnt(5)
    v_mfma_f32_32x32x16_bf16 v[152:167], v[220:223], a[76:79], v[152:167]
    s_add_u32 s82, s82, 31744
    ds_read_b64_tr_b16 v[212:213], v58 offset:15360
    buffer_load_dwordx4 v34, s[20:23], s82 offen offset:2048 lds
    ds_read_b64_tr_b16 v[214:215], v58 offset:16128
    v_mfma_f32_32x32x16_bf16 v[168:183], v[224:227], a[76:79], v[168:183]
    s_add_u32 s82, s82, 31744
    ds_read_b64_tr_b16 v[216:217], v59 offset:15360
    buffer_load_dwordx4 v35, s[20:23], s82 offen offset:3072 lds
    ds_read_b64_tr_b16 v[218:219], v59 offset:16128
    s_waitcnt lgkmcnt(4)
    v_mfma_f32_32x32x16_bf16 v[152:167], v[228:231], a[80:83], v[152:167]
    s_add_u32 s82, s82, s59
    s_add_u32 m0, s58, 102400
    ds_read_b64_tr_b16 v[220:221], v58 offset:18432
    buffer_load_dwordx4 v34, s[20:23], s82 offen offset:0 lds
    ds_read_b64_tr_b16 v[222:223], v58 offset:19200
    v_mfma_f32_32x32x16_bf16 v[168:183], v[232:235], a[80:83], v[168:183]
    s_add_u32 s82, s82, 31744
    ds_read_b64_tr_b16 v[224:225], v59 offset:18432
    buffer_load_dwordx4 v35, s[20:23], s82 offen offset:1024 lds
    ds_read_b64_tr_b16 v[226:227], v59 offset:19200
    s_waitcnt lgkmcnt(4)
    v_mfma_f32_32x32x16_bf16 v[152:167], v[212:215], a[84:87], v[152:167]
    s_add_u32 s82, s82, 31744
    ds_read_b64_tr_b16 v[228:229], v58 offset:21504
    buffer_load_dwordx4 v34, s[20:23], s82 offen offset:2048 lds
    ds_read_b64_tr_b16 v[230:231], v58 offset:22272
    v_mfma_f32_32x32x16_bf16 v[168:183], v[216:219], a[84:87], v[168:183]
    s_add_u32 s82, s82, 31744
    ds_read_b64_tr_b16 v[232:233], v59 offset:21504
    buffer_load_dwordx4 v35, s[20:23], s82 offen offset:3072 lds
    ds_read_b64_tr_b16 v[234:235], v59 offset:22272
    s_waitcnt vmcnt(11)
    s_barrier
    ds_read_b128 a[236:239], v27 offset:4096
    ds_read_b128 a[240:243], v28 offset:0
    ds_read_b128 a[244:247], v28 offset:4096
    ds_read_b128 a[248:251], v29 offset:0
    ds_read_b128 a[252:255], v29 offset:4096
    s_waitcnt lgkmcnt(0)
    v_mfma_f32_32x32x16_bf16 v[152:167], v[220:223], a[88:91], v[152:167]
    s_xor_b32 s82, s91, 5
    s_lshl_b32 s82, s82, 7
    s_add_u32 s82, s82, s57
    s_add_u32 m0, s58, 131072
    ds_read_b64_tr_b16 v[212:213], v58 offset:24576
    buffer_load_dwordx4 v34, s[20:23], s82 offen offset:0 lds
    ds_read_b64_tr_b16 v[214:215], v58 offset:25344
    v_mfma_f32_32x32x16_bf16 v[168:183], v[224:227], a[88:91], v[168:183]
    s_add_u32 s82, s82, 31744
    ds_read_b64_tr_b16 v[216:217], v59 offset:24576
    buffer_load_dwordx4 v35, s[20:23], s82 offen offset:1024 lds
    ds_read_b64_tr_b16 v[218:219], v59 offset:25344
    v_mfma_f32_32x32x16_bf16 v[152:167], v[228:231], a[92:95], v[152:167]
    s_add_u32 s82, s82, 31744
    ds_read_b64_tr_b16 v[220:221], v58 offset:27648
    buffer_load_dwordx4 v34, s[20:23], s82 offen offset:2048 lds
    ds_read_b64_tr_b16 v[222:223], v58 offset:28416
    v_mfma_f32_32x32x16_bf16 v[168:183], v[232:235], a[92:95], v[168:183]
    s_add_u32 s82, s82, 31744
    ds_read_b64_tr_b16 v[224:225], v59 offset:27648
    buffer_load_dwordx4 v35, s[20:23], s82 offen offset:3072 lds
    ds_read_b64_tr_b16 v[226:227], v59 offset:28416
    s_waitcnt lgkmcnt(4)
    v_mfma_f32_32x32x16_bf16 v[152:167], v[212:215], a[96:99], v[152:167]
    s_add_u32 s82, s82, s59
    s_add_u32 m0, s58, 135168
    ds_read_b64_tr_b16 v[228:229], v58 offset:30720
    buffer_load_dwordx4 v34, s[20:23], s82 offen offset:0 lds
    ds_read_b64_tr_b16 v[230:231], v58 offset:31488
    v_mfma_f32_32x32x16_bf16 v[168:183], v[216:219], a[96:99], v[168:183]
    s_add_u32 s82, s82, 31744
    ds_read_b64_tr_b16 v[232:233], v59 offset:30720
    buffer_load_dwordx4 v35, s[20:23], s82 offen offset:1024 lds
    ds_read_b64_tr_b16 v[234:235], v59 offset:31488
    s_waitcnt lgkmcnt(4)
    v_mfma_f32_32x32x16_bf16 v[152:167], v[220:223], a[100:103], v[152:167]
    s_add_u32 s82, s82, 31744
    ds_read_b64_tr_b16 v[212:213], v58 offset:33792
    buffer_load_dwordx4 v34, s[20:23], s82 offen offset:2048 lds
    ds_read_b64_tr_b16 v[214:215], v58 offset:34560
    v_mfma_f32_32x32x16_bf16 v[168:183], v[224:227], a[100:103], v[168:183]
    s_add_u32 s82, s82, 31744
    ds_read_b64_tr_b16 v[216:217], v59 offset:33792
    buffer_load_dwordx4 v35, s[20:23], s82 offen offset:3072 lds
    ds_read_b64_tr_b16 v[218:219], v59 offset:34560
    s_waitcnt vmcnt(16)
    s_barrier
    s_lshl_b32 s76, s7, 12
    s_lshl_b32 s81, s3, 10
    s_add_u32 s76, s76, s81
    s_add_u32 s76, s76, 13107200
    s_lshr_b32 s78, s6, 3
    s_mul_i32 s77, s7, 12288
    s_lshl_b32 s81, s78, 12
    s_add_u32 s77, s77, s81
    s_add_u32 s77, s77, 196608
    v_bfe_u32 v43, v1, 0, 3
    v_lshlrev_b32 v43, 7, v43
    v_add_u32_e64 v43, s76, v43
    v_bfe_u32 v4, v1, 3, 1
    v_mul_lo_u32 v4, v4, s77
    v_add_u32 v43, v43, v4
    buffer_load_dword v44, v43, s[24:27], 0 offen sc1
    s_waitcnt lgkmcnt(4)
    v_mfma_f32_32x32x16_bf16 v[152:167], v[228:231], a[104:107], v[152:167]
    s_xor_b32 s82, s91, 6
    s_lshl_b32 s82, s82, 7
    s_add_u32 s82, s82, s57
    s_add_u32 m0, s58, 0
    ds_read_b64_tr_b16 v[220:221], v58 offset:36864
    buffer_load_dwordx4 v34, s[20:23], s82 offen offset:0 lds
    ds_read_b64_tr_b16 v[222:223], v58 offset:37632
    v_mfma_f32_32x32x16_bf16 v[168:183], v[232:235], a[104:107], v[168:183]
    s_add_u32 s82, s82, 31744
    ds_read_b64_tr_b16 v[224:225], v59 offset:36864
    buffer_load_dwordx4 v35, s[20:23], s82 offen offset:1024 lds
    ds_read_b64_tr_b16 v[226:227], v59 offset:37632
    s_waitcnt lgkmcnt(4)
    v_mfma_f32_32x32x16_bf16 v[152:167], v[212:215], a[108:111], v[152:167]
    s_add_u32 s82, s82, 31744
    ds_read_b64_tr_b16 v[228:229], v58 offset:39936
    buffer_load_dwordx4 v34, s[20:23], s82 offen offset:2048 lds
    ds_read_b64_tr_b16 v[230:231], v58 offset:40704
    v_mfma_f32_32x32x16_bf16 v[168:183], v[216:219], a[108:111], v[168:183]
    s_add_u32 s82, s82, 31744
    ds_read_b64_tr_b16 v[232:233], v59 offset:39936
    buffer_load_dwordx4 v35, s[20:23], s82 offen offset:3072 lds
    ds_read_b64_tr_b16 v[234:235], v59 offset:40704
    s_waitcnt lgkmcnt(4)
    v_mfma_f32_32x32x16_bf16 v[152:167], v[220:223], a[112:115], v[152:167]
    s_add_u32 s82, s82, s59
    s_add_u32 m0, s58, 4096
    ds_read_b64_tr_b16 v[212:213], v58 offset:43008
    buffer_load_dwordx4 v34, s[20:23], s82 offen offset:0 lds
    ds_read_b64_tr_b16 v[214:215], v58 offset:43776
    v_mfma_f32_32x32x16_bf16 v[168:183], v[224:227], a[112:115], v[168:183]
    s_add_u32 s82, s82, 31744
    ds_read_b64_tr_b16 v[216:217], v59 offset:43008
    buffer_load_dwordx4 v35, s[20:23], s82 offen offset:1024 lds
    ds_read_b64_tr_b16 v[218:219], v59 offset:43776
    s_waitcnt lgkmcnt(4)
    v_mfma_f32_32x32x16_bf16 v[152:167], v[228:231], a[116:119], v[152:167]
    s_add_u32 s82, s82, 31744
    ds_read_b64_tr_b16 v[220:221], v58 offset:46080
    buffer_load_dwordx4 v34, s[20:23], s82 offen offset:2048 lds
    ds_read_b64_tr_b16 v[222:223], v58 offset:46848
    v_mfma_f32_32x32x16_bf16 v[168:183], v[232:235], a[116:119], v[168:183]
    s_add_u32 s82, s82, 31744
    ds_read_b64_tr_b16 v[224:225], v59 offset:46080
    buffer_load_dwordx4 v35, s[20:23], s82 offen offset:3072 lds
    ds_read_b64_tr_b16 v[226:227], v59 offset:46848
    s_waitcnt lgkmcnt(4)
    v_mfma_f32_32x32x16_bf16 v[152:167], v[212:215], a[120:123], v[152:167]
    v_mfma_f32_32x32x16_bf16 v[168:183], v[216:219], a[120:123], v[168:183]
    s_waitcnt lgkmcnt(0)
    v_mfma_f32_32x32x16_bf16 v[152:167], v[220:223], a[124:127], v[152:167]
    v_mfma_f32_32x32x16_bf16 v[168:183], v[224:227], a[124:127], v[168:183]
    s_barrier
    s_lshl_b32 s76, s5, 11
    s_lshl_b32 s77, s5, 8
    v_add_u32 v38, s76, v42
    v_xor_b32 v40, 2048, v38
    v_xor_b32 v39, s77, v42
    v_add_u32 v39, 1024, v39
    s_cmp_eq_u32 s7, 0
    s_cselect_b32 s76, 0x900, 0
    v_mov_b32 v5, 2147483648
    v_and_b32 v4, s76, v38
    v_cmp_eq_u32 vcc, s76, v4
    s_nop 1
    v_cndmask_b32 v38, v5, v38, vcc
    v_and_b32 v4, s76, v39
    v_cmp_eq_u32 vcc, s76, v4
    s_nop 1
    v_cndmask_b32 v39, v5, v39, vcc
    v_and_b32_e64 v4, s76, v40
    v_cmp_eq_u32 vcc, s76, v4
    s_nop 1
    v_cndmask_b32 v40, v5, v40, vcc
    s_mul_i32 s63, s7, 393216
    s_mul_i32 s81, s3, 98304
    s_add_u32 s63, s63, s81
    v_cvt_pk_bf16_f32 v136, v136, v137
    v_cvt_pk_bf16_f32 v137, v138, v139
    v_cvt_pk_bf16_f32 v138, v140, v141
    v_cvt_pk_bf16_f32 v139, v142, v143
    v_cvt_pk_bf16_f32 v140, v144, v145
    v_cvt_pk_bf16_f32 v141, v146, v147
    v_cvt_pk_bf16_f32 v142, v148, v149
    v_cvt_pk_bf16_f32 v143, v150, v151
    v_mfma_f32_32x32x16_bf16 v[196:211], v[18:21], v[136:139], 0
    s_nop 0
    v_mfma_f32_32x32x16_bf16 v[196:211], v[22:25], v[140:143], v[196:211]
    s_nop 11
    v_max3_f32 v176, v196, v197, v198
    v_max3_f32 v176, v176, v199, v200
    v_max3_f32 v176, v176, v201, v202
    v_max_f32_e64 v176, v176, v203
    v_min3_f32 v178, v196, v197, v198
    v_min3_f32 v178, v178, v199, v200
    s_xor_b32 s82, s91, 7
    s_lshl_b32 s82, s82, 7
    s_add_u32 s82, s82, s57
    s_add_u32 m0, s58, 32768
    s_nop 0
    buffer_load_dwordx4 v34, s[20:23], s82 offen offset:0 lds
    v_min3_f32 v178, v178, v201, v202
    v_min_f32_e64 v178, v178, v203
    v_max3_f32 v180, v204, v205, v206
    v_max3_f32 v180, v180, v207, v208
    v_max3_f32 v180, v180, v209, v210
    v_max_f32_e64 v180, v180, v211
    v_min3_f32 v182, v204, v205, v206
    v_min3_f32 v182, v182, v207, v208
    v_min3_f32 v182, v182, v209, v210
    v_min_f32 v182, v182, v211
    v_mov_b32 v177, v176
    v_mov_b32 v179, v178
    v_mov_b32 v181, v180
    v_mov_b32 v183, v182
    v_permlane32_swap_b32 v176, v177
    v_permlane32_swap_b32_e64 v178, v179
    s_add_u32 s82, s82, 31744
    buffer_load_dwordx4 v35, s[20:23], s82 offen offset:1024 lds
    v_permlane32_swap_b32 v180, v181
    v_permlane32_swap_b32 v182, v183
    v_max_f32 v176, v176, v177
    v_min_f32 v177, v178, v179
    v_max_f32 v180, v180, v181
    v_min_f32 v181, v182, v183
    v_mul_f32 v176, v36, v176
    v_mul_f32 v177, v36, v177
    v_mul_f32 v180, v36, v180
    v_mul_f32 v181, v36, v181
    v_fma_f32 v88, v196, v36, -v176
    v_fma_f32 v96, -v196, v36, v177
    v_fma_f32 v89, v197, v36, -v176
    v_fma_f32 v97, -v197, v36, v177
    v_fma_f32 v90, v198, v36, -v176
    v_fma_f32 v98, -v198, v36, v177
    s_add_u32 s82, s82, 31744
    buffer_load_dwordx4 v34, s[20:23], s82 offen offset:2048 lds
    v_fma_f32 v91, v199, v36, -v176
    v_fma_f32 v99, -v199, v36, v177
    v_fma_f32 v92, v200, v36, -v176
    v_fma_f32 v100, -v200, v36, v177
    v_fma_f32 v93, v201, v36, -v176
    v_fma_f32 v101, -v201, v36, v177
    v_fma_f32 v94, v202, v36, -v176
    v_fma_f32 v102, -v202, v36, v177
    s_waitcnt vmcnt(11)
    v_cmp_ne_u32_e64 vcc, s83, v44
    s_nop 0
    s_cbranch_vccnz L_slow_f1_9
L_back_f1_10:
    s_lshl_b32 s67, s7, 19
    s_lshl_b32 s81, s6, 14
    s_add_u32 s67, s67, s81
    s_lshl_b32 s81, s3, 12
    s_add_u32 s67, s67, s81
    s_add_u32 s67, s67, 8388608
    buffer_load_dwordx4 v[56:59], v42, s[24:27], s67 offen offset:0 sc1
    buffer_load_dwordx4 v[60:63], v42, s[24:27], s67 offen offset:1024 sc1
    buffer_load_dwordx4 v[64:67], v42, s[24:27], s67 offen offset:2048 sc1
    buffer_load_dwordx4 v[68:71], v42, s[24:27], s67 offen offset:3072 sc1
    s_cmp_eq_u32 s7, 0
    s_cbranch_scc1 L_light_12
    s_xor_b32 s66, s91, 0
    s_mul_i32 s66, s66, 12288
    s_add_u32 s66, s66, s63
    buffer_load_dwordx4 v[212:215], v38, s[24:27], s66 offen sc1
    buffer_load_dwordx4 v[216:219], v39, s[24:27], s66 offen sc1
    buffer_load_dwordx4 v[220:223], v40, s[24:27], s66 offen sc1
    s_add_u32 s66, s66, 3072
    buffer_load_dwordx4 v[184:187], v38, s[24:27], s66 offen sc1
    buffer_load_dwordx4 v[188:191], v39, s[24:27], s66 offen sc1
    buffer_load_dwordx4 v[192:195], v40, s[24:27], s66 offen sc1
    s_add_u32 s66, s66, 3072
    buffer_load_dwordx4 v[124:127], v38, s[24:27], s66 offen sc1
    buffer_load_dwordx4 v[128:131], v39, s[24:27], s66 offen sc1
    buffer_load_dwordx4 v[132:135], v40, s[24:27], s66 offen sc1
    s_waitcnt vmcnt(8)
    v_mfma_f32_32x32x16_bf16 v[224:239], v[212:215], a[128:131], 0
    s_add_u32 s66, s66, 3072
    buffer_load_dwordx4 v[112:115], v38, s[24:27], s66 offen sc1
    v_fma_f32 v95, v203, v36, -v176
    v_fma_f32 v103, -v203, v36, v177
    v_exp_f32 v88, v88
    v_mfma_f32_32x32x16_bf16 a[16:31], v[212:215], a[132:135], 0
    buffer_load_dwordx4 v[116:119], v39, s[24:27], s66 offen sc1
    v_exp_f32 v89, v89
    v_exp_f32 v90, v90
    v_exp_f32 v91, v91
    s_waitcnt vmcnt(9)
    v_mfma_f32_32x32x16_bf16 v[240:255], v[216:219], a[128:131], 0
    buffer_load_dwordx4 v[120:123], v40, s[24:27], s66 offen sc1
    v_exp_f32 v92, v92
    v_exp_f32 v93, v93
    v_exp_f32_e64 v94, v94
    v_mfma_f32_32x32x16_bf16 a[32:47], v[216:219], a[132:135], 0
    s_add_u32 s82, s82, 31744
    buffer_load_dwordx4 v35, s[20:23], s82 offen offset:3072 lds
    v_exp_f32 v95, v95
    v_exp_f32 v96, v96
    v_exp_f32 v97, v97
    s_waitcnt vmcnt(10)
    v_mfma_f32_32x32x16_bf16 a[0:15], v[220:223], a[128:131], 0
    s_add_u32 s82, s82, s59
    s_add_u32 m0, s58, 36864
    s_nop 0
    buffer_load_dwordx4 v34, s[20:23], s82 offen offset:0 lds
    v_exp_f32 v98, v98
    v_exp_f32 v99, v99
    v_exp_f32_e64 v100, v100
    v_mfma_f32_32x32x16_bf16 a[48:63], v[220:223], a[132:135], 0
    s_add_u32 s82, s82, 31744
    buffer_load_dwordx4 v35, s[20:23], s82 offen offset:1024 lds
    v_exp_f32 v101, v101
    v_exp_f32 v102, v102
    v_exp_f32 v103, v103
    v_add_f32 v56, v56, v60
    v_add_f32 v57, v57, v61
    v_add_f32 v58, v58, v62
    v_add_f32 v59, v59, v63
    v_add_f32 v56, v56, v64
    v_add_f32 v57, v57, v65
    v_add_f32 v58, v58, v66
    v_add_f32 v59, v59, v67
    v_add_f32 v56, v56, v68
    v_add_f32 v57, v57, v69
    v_add_f32 v58, v58, v70
    v_add_f32 v59, v59, v71
    s_lshl_b32 s76, s3, 10
    s_add_u32 s76, s76, 65536
    v_add_u32 v4, s76, v42
    ds_write_b128 v4, v[56:59]
    s_waitcnt vmcnt(11)
    v_mfma_f32_32x32x16_bf16 v[224:239], v[184:187], a[136:139], v[224:239]
    s_xor_b32 s66, s91, 1
    s_mul_i32 s66, s66, 12288
    s_add_u32 s66, s66, s63
    buffer_load_dwordx4 v[212:215], v38, s[24:27], s66 offen sc1
    v_add_f32 v196, v88, v90
    v_add_f32 v197, v89, v91
    v_add_f32_e64 v198, v96, v98
    v_mfma_f32_32x32x16_bf16 a[16:31], v[184:187], a[140:143], a[16:31]
    buffer_load_dwordx4 v[216:219], v39, s[24:27], s66 offen sc1
    v_add_f32 v199, v97, v99
    v_add_f32 v196, v196, v92
    v_add_f32 v197, v197, v93
    s_waitcnt vmcnt(12)
    v_mfma_f32_32x32x16_bf16 v[240:255], v[188:191], a[136:139], v[240:255]
    buffer_load_dwordx4 v[220:223], v40, s[24:27], s66 offen sc1
    v_add_f32 v198, v198, v100
    v_add_f32 v199, v199, v101
    v_add_f32_e64 v196, v196, v94
    v_mfma_f32_32x32x16_bf16 a[32:47], v[188:191], a[140:143], a[32:47]
    s_add_u32 s82, s82, 31744
    buffer_load_dwordx4 v34, s[20:23], s82 offen offset:2048 lds
    v_add_f32 v197, v197, v95
    v_add_f32 v198, v198, v102
    v_add_f32 v199, v199, v103
    s_waitcnt vmcnt(13)
    v_mfma_f32_32x32x16_bf16 a[0:15], v[192:195], a[136:139], a[0:15]
    s_add_u32 s82, s82, 31744
    buffer_load_dwordx4 v35, s[20:23], s82 offen offset:3072 lds
    v_add_f32 v196, v196, v197
    v_add_f32 v198, v198, v199
    v_mov_b32_e64 v197, v196
    v_mfma_f32_32x32x16_bf16 a[48:63], v[192:195], a[140:143], a[48:63]
    v_mov_b32 v199, v198
    v_permlane32_swap_b32 v196, v197
    s_nop 0
    v_permlane32_swap_b32 v198, v199
    v_add_f32 v196, v196, v197
    v_add_f32 v197, v198, v199
    v_rcp_f32_e64 v196, v196
    s_waitcnt lgkmcnt(0)
    s_barrier
    s_cmp_lg_u32 s3, 0
    s_cbranch_scc1 L_w0_24
    v_add_u32 v4, 65536, v42
    ds_read_b128 v[56:59], v4 offset:0
    ds_read_b128 v[60:63], v4 offset:1024
    ds_read_b128 v[64:67], v4 offset:2048
    ds_read_b128 v[68:71], v4 offset:3072
L_w0_24:
    s_waitcnt vmcnt(13)
    v_mfma_f32_32x32x16_bf16 v[224:239], v[124:127], a[144:147], v[224:239]
    s_add_u32 s66, s66, 3072
    buffer_load_dwordx4 v[184:187], v38, s[24:27], s66 offen sc1
    v_rcp_f32 v197, v197
    v_mul_f32 v88, v196, v88
    v_mul_f32 v89, v196, v89
    v_mfma_f32_32x32x16_bf16 a[16:31], v[124:127], a[148:151], a[16:31]
    buffer_load_dwordx4 v[188:191], v39, s[24:27], s66 offen sc1
    v_mul_f32 v90, v196, v90
    v_mul_f32 v91, v196, v91
    v_mul_f32 v92, v196, v92
    s_waitcnt vmcnt(14)
    v_mfma_f32_32x32x16_bf16 v[240:255], v[128:131], a[144:147], v[240:255]
    buffer_load_dwordx4 v[192:195], v40, s[24:27], s66 offen sc1
    v_mul_f32 v93, v196, v93
    v_mul_f32 v94, v196, v94
    v_mul_f32_e64 v95, v196, v95
    v_mfma_f32_32x32x16_bf16 a[32:47], v[128:131], a[148:151], a[32:47]
    v_mul_f32 v96, v197, v96
    v_mul_f32 v97, v197, v97
    v_mul_f32 v98, v197, v98
    v_mul_f32 v99, v197, v99
    v_mul_f32_e64 v100, v197, v100
    v_mul_f32 v101, v197, v101
    s_waitcnt vmcnt(14)
    v_mfma_f32_32x32x16_bf16 a[0:15], v[132:135], a[144:147], a[0:15]
    v_mul_f32 v102, v197, v102
    v_mul_f32 v103, v197, v103
    v_cvt_pk_bf16_f32 v136, v88, v89
    v_cvt_pk_bf16_f32 v137, v90, v91
    v_cvt_pk_bf16_f32 v138, v92, v93
    v_cvt_pk_bf16_f32 v139, v94, v95
    v_mfma_f32_32x32x16_bf16 a[48:63], v[132:135], a[148:151], a[48:63]
    v_cvt_pk_bf16_f32 v140, v96, v97
    v_cvt_pk_bf16_f32 v141, v98, v99
    v_cvt_pk_bf16_f32 v142, v100, v101
    v_cvt_pk_bf16_f32 v143, v102, v103
    v_fma_f32 v88, v204, v36, -v180
    v_fma_f32 v96, -v204, v36, v181
    s_cmp_lg_u32 s3, 0
    s_cbranch_scc1 L_w0_25
    s_waitcnt lgkmcnt(0)
    v_add_f32 v56, v56, v60
    v_add_f32 v57, v57, v61
    v_add_f32 v58, v58, v62
    v_add_f32 v59, v59, v63
    s_waitcnt lgkmcnt(0)
    v_add_f32 v56, v56, v64
    v_add_f32 v57, v57, v65
    v_add_f32 v58, v58, v66
    v_add_f32 v59, v59, v67
    s_waitcnt lgkmcnt(0)
    v_add_f32 v56, v56, v68
    v_add_f32 v57, v57, v69
    v_add_f32 v58, v58, v70
    v_add_f32 v59, v59, v71
    s_lshl_b32 s76, s7, 14
    s_lshl_b32 s81, s6, 9
    s_add_u32 s76, s76, s81
    s_add_u32 s76, s76, 12582912
    v_permlane32_swap_b32 v56, v57
    v_permlane32_swap_b32 v58, v59
    v_add_f32 v56, v56, v57
    v_add_f32 v58, v58, v59
    v_bfe_u32 v4, v1, 0, 5
    v_lshlrev_b32_e64 v4, 4, v4
    v_bfe_u32 v2, v1, 5, 1
    v_lshl_add_u32 v4, v2, 3, v4
    v_add_u32 v4, s76, v4
    v_permlane32_swap_b32 v56, v58
    v_cvt_pk_bf16_f32 v56, v56, v58
    v_mov_b32_e64 v57, s83
    buffer_store_dwordx2 v[56:57], v4, s[24:27], 0 offen sc1
L_w0_25:
    s_waitcnt vmcnt(13)
    v_mfma_f32_32x32x16_bf16 v[224:239], v[112:115], a[152:155], v[224:239]
    s_add_u32 s66, s66, 3072
    buffer_load_dwordx4 v[124:127], v38, s[24:27], s66 offen sc1
    v_fma_f32 v89, v205, v36, -v180
    v_fma_f32 v97, -v205, v36, v181
    v_fma_f32 v90, v206, v36, -v180
    v_mfma_f32_32x32x16_bf16 a[16:31], v[112:115], a[156:159], a[16:31]
    buffer_load_dwordx4 v[128:131], v39, s[24:27], s66 offen sc1
    v_fma_f32 v98, -v206, v36, v181
    v_fma_f32 v91, v207, v36, -v180
    v_fma_f32 v99, -v207, v36, v181
    s_waitcnt vmcnt(14)
    v_mfma_f32_32x32x16_bf16 v[240:255], v[116:119], a[152:155], v[240:255]
    buffer_load_dwordx4 v[132:135], v40, s[24:27], s66 offen sc1
    v_fma_f32 v92, v208, v36, -v180
    v_fma_f32 v100, -v208, v36, v181
    v_fma_f32 v93, v209, v36, -v180
    v_mfma_f32_32x32x16_bf16 a[32:47], v[116:119], a[156:159], a[32:47]
    v_fma_f32 v101, -v209, v36, v181
    v_fma_f32 v94, v210, v36, -v180
    v_fma_f32 v102, -v210, v36, v181
    v_fma_f32 v95, v211, v36, -v180
    v_fma_f32 v103, -v211, v36, v181
    v_exp_f32 v88, v88
    s_waitcnt vmcnt(14)
    v_mfma_f32_32x32x16_bf16 a[0:15], v[120:123], a[152:155], a[0:15]
    v_exp_f32 v89, v89
    v_exp_f32 v90, v90
    v_exp_f32 v91, v91
    v_exp_f32 v92, v92
    v_exp_f32 v93, v93
    v_exp_f32 v94, v94
    v_mfma_f32_32x32x16_bf16 a[48:63], v[120:123], a[156:159], a[48:63]
    v_exp_f32 v95, v95
    v_exp_f32 v96, v96
    v_exp_f32 v97, v97
    v_exp_f32 v98, v98
    v_exp_f32_e64 v99, v99
    v_exp_f32 v100, v100
    s_waitcnt vmcnt(10)
    v_mfma_f32_32x32x16_bf16 v[224:239], v[212:215], a[160:163], v[224:239]
    s_add_u32 s66, s66, 3072
    buffer_load_dwordx4 v[112:115], v38, s[24:27], s66 offen sc1
    v_exp_f32 v101, v101
    v_exp_f32 v102, v102
    v_exp_f32_e64 v103, v103
    v_mfma_f32_32x32x16_bf16 a[16:31], v[212:215], a[164:167], a[16:31]
    buffer_load_dwordx4 v[116:119], v39, s[24:27], s66 offen sc1
    v_add_f32 v204, v88, v90
    v_add_f32 v205, v89, v91
    v_add_f32 v206, v96, v98
    s_waitcnt vmcnt(11)
    v_mfma_f32_32x32x16_bf16 v[240:255], v[216:219], a[160:163], v[240:255]
    buffer_load_dwordx4 v[120:123], v40, s[24:27], s66 offen sc1
    v_add_f32 v207, v97, v99
    v_add_f32 v204, v204, v92
    v_add_f32_e64 v205, v205, v93
    v_mfma_f32_32x32x16_bf16 a[32:47], v[216:219], a[164:167], a[32:47]
    v_add_f32 v206, v206, v100
    v_add_f32 v207, v207, v101
    v_add_f32 v204, v204, v94
    v_add_f32 v205, v205, v95
    v_add_f32_e64 v206, v206, v102
    v_add_f32 v207, v207, v103
    s_waitcnt vmcnt(11)
    v_mfma_f32_32x32x16_bf16 a[0:15], v[220:223], a[160:163], a[0:15]
    v_add_f32 v204, v204, v205
    v_add_f32 v206, v206, v207
    v_mov_b32 v205, v204
    v_mov_b32 v207, v206
    s_nop 0
    v_permlane32_swap_b32 v204, v205
    v_permlane32_swap_b32_e64 v206, v207
    v_mfma_f32_32x32x16_bf16 a[48:63], v[220:223], a[164:167], a[48:63]
    v_add_f32 v204, v204, v205
    v_add_f32 v205, v206, v207
    v_rcp_f32 v204, v204
    v_rcp_f32 v205, v205
    v_mul_f32_e64 v88, v204, v88
    v_mul_f32 v89, v204, v89
    s_waitcnt vmcnt(8)
    v_mfma_f32_32x32x16_bf16 v[224:239], v[184:187], a[168:171], v[224:239]
    s_xor_b32 s66, s91, 2
    s_mul_i32 s66, s66, 12288
    s_add_u32 s66, s66, s63
    buffer_load_dwordx4 v[212:215], v38, s[24:27], s66 offen sc1
    v_mul_f32 v90, v204, v90
    v_mul_f32 v91, v204, v91
    v_mul_f32_e64 v92, v204, v92
    v_mfma_f32_32x32x16_bf16 a[16:31], v[184:187], a[172:175], a[16:31]
    buffer_load_dwordx4 v[216:219], v39, s[24:27], s66 offen sc1
    v_mul_f32 v93, v204, v93
    v_mul_f32 v94, v204, v94
    v_mul_f32 v95, v204, v95
    s_waitcnt vmcnt(9)
    v_mfma_f32_32x32x16_bf16 v[240:255], v[188:191], a[168:171], v[240:255]
    buffer_load_dwordx4 v[220:223], v40, s[24:27], s66 offen sc1
    v_mul_f32 v96, v205, v96
    v_mul_f32 v97, v205, v97
    v_mul_f32_e64 v98, v205, v98
    v_mfma_f32_32x32x16_bf16 a[32:47], v[188:191], a[172:175], a[32:47]
    v_mul_f32 v99, v205, v99
    v_mul_f32 v100, v205, v100
    v_mul_f32 v101, v205, v101
    v_mul_f32 v102, v205, v102
    v_mul_f32 v103, v205, v103
    v_cvt_pk_bf16_f32 v144, v88, v89
    s_waitcnt vmcnt(9)
    v_mfma_f32_32x32x16_bf16 a[0:15], v[192:195], a[168:171], a[0:15]
    v_cvt_pk_bf16_f32 v145, v90, v91
    v_cvt_pk_bf16_f32 v146, v92, v93
    v_cvt_pk_bf16_f32 v147, v94, v95
    v_cvt_pk_bf16_f32 v148, v96, v97
    v_cvt_pk_bf16_f32 v149, v98, v99
    v_cvt_pk_bf16_f32 v150, v100, v101
    v_mfma_f32_32x32x16_bf16 a[48:63], v[192:195], a[172:175], a[48:63]
    v_cvt_pk_bf16_f32 v151, v102, v103
    s_nop 0
    v_mul_f32 v88, v152, v152
    v_mul_f32 v89, v153, v153
    v_mul_f32 v90, v154, v154
    v_mul_f32 v91, v155, v155
    s_waitcnt vmcnt(8)
    v_mfma_f32_32x32x16_bf16 v[224:239], v[124:127], a[176:179], v[224:239]
    s_add_u32 s66, s66, 3072
    buffer_load_dwordx4 v[184:187], v38, s[24:27], s66 offen sc1
    v_mul_f32 v92, v156, v156
    v_mul_f32 v93, v157, v157
    v_mul_f32_e64 v94, v158, v158
    v_mfma_f32_32x32x16_bf16 a[16:31], v[124:127], a[180:183], a[16:31]
    buffer_load_dwordx4 v[188:191], v39, s[24:27], s66 offen sc1
    v_mul_f32 v95, v159, v159
    v_fma_f32 v88, v88, v32, v33
    v_fma_f32 v89, v89, v32, v33
    s_waitcnt vmcnt(9)
    v_mfma_f32_32x32x16_bf16 v[240:255], v[128:131], a[176:179], v[240:255]
    buffer_load_dwordx4 v[192:195], v40, s[24:27], s66 offen sc1
    v_fma_f32 v90, v90, v32, v33
    v_fma_f32 v91, v91, v32, v33
    v_fma_f32 v92, v92, v32, v33
    v_mfma_f32_32x32x16_bf16 a[32:47], v[128:131], a[180:183], a[32:47]
    v_fma_f32 v93, v93, v32, v33
    v_fma_f32 v94, v94, v32, v33
    v_fma_f32 v95, v95, v32, v33
    v_mul_f32 v88, v88, v152
    v_mul_f32 v89, v89, v153
    v_mul_f32 v90, v90, v154
    s_waitcnt vmcnt(9)
    v_mfma_f32_32x32x16_bf16 a[0:15], v[132:135], a[176:179], a[0:15]
    v_mul_f32 v91, v91, v155
    v_mul_f32 v92, v92, v156
    v_mul_f32 v93, v93, v157
    v_mul_f32 v94, v94, v158
    v_mul_f32 v95, v95, v159
    v_exp_f32 v88, v88
    v_mfma_f32_32x32x16_bf16 a[48:63], v[132:135], a[180:183], a[48:63]
    v_exp_f32 v89, v89
    v_exp_f32 v90, v90
    v_exp_f32 v91, v91
    v_exp_f32 v92, v92
    v_exp_f32_e64 v93, v93
    v_exp_f32 v94, v94
    s_waitcnt vmcnt(8)
    v_mfma_f32_32x32x16_bf16 v[224:239], v[112:115], a[184:187], v[224:239]
    s_add_u32 s66, s66, 3072
    buffer_load_dwordx4 v[124:127], v38, s[24:27], s66 offen sc1
    v_exp_f32 v95, v95
    v_add_f32 v88, 1.0, v88
    v_add_f32_e64 v89, 1.0, v89
    v_mfma_f32_32x32x16_bf16 a[16:31], v[112:115], a[188:191], a[16:31]
    buffer_load_dwordx4 v[128:131], v39, s[24:27], s66 offen sc1
    v_add_f32 v90, 1.0, v90
    v_add_f32 v91, 1.0, v91
    v_add_f32 v92, 1.0, v92
    s_waitcnt vmcnt(9)
    v_mfma_f32_32x32x16_bf16 v[240:255], v[116:119], a[184:187], v[240:255]
    buffer_load_dwordx4 v[132:135], v40, s[24:27], s66 offen sc1
    v_add_f32 v93, 1.0, v93
    v_add_f32 v94, 1.0, v94
    v_add_f32_e64 v95, 1.0, v95
    v_mfma_f32_32x32x16_bf16 a[32:47], v[116:119], a[188:191], a[32:47]
    v_rcp_f32 v88, v88
    v_rcp_f32 v89, v89
    v_rcp_f32 v90, v90
    v_rcp_f32 v91, v91
    v_rcp_f32_e64 v92, v92
    v_rcp_f32 v93, v93
    s_waitcnt vmcnt(9)
    v_mfma_f32_32x32x16_bf16 a[0:15], v[120:123], a[184:187], a[0:15]
    v_rcp_f32 v94, v94
    v_rcp_f32 v95, v95
    v_mul_f32 v152, v152, v88
    v_mul_f32 v153, v153, v89
    v_mul_f32 v154, v154, v90
    v_mul_f32 v155, v155, v91
    v_mfma_f32_32x32x16_bf16 a[48:63], v[120:123], a[188:191], a[48:63]
    v_mul_f32 v156, v156, v92
    v_mul_f32 v157, v157, v93
    v_mul_f32 v158, v158, v94
    v_mul_f32 v159, v159, v95
    v_mul_f32_e64 v88, v160, v160
    v_mul_f32 v89, v161, v161
    s_waitcnt vmcnt(8)
    v_mfma_f32_32x32x16_bf16 v[224:239], v[212:215], a[192:195], v[224:239]
    s_add_u32 s66, s66, 3072
    buffer_load_dwordx4 v[112:115], v38, s[24:27], s66 offen sc1
    v_mul_f32 v90, v162, v162
    v_mul_f32 v91, v163, v163
    v_mul_f32_e64 v92, v164, v164
    v_mfma_f32_32x32x16_bf16 a[16:31], v[212:215], a[196:199], a[16:31]
    buffer_load_dwordx4 v[116:119], v39, s[24:27], s66 offen sc1
    v_mul_f32 v93, v165, v165
    v_mul_f32 v94, v166, v166
    v_mul_f32 v95, v167, v167
    s_waitcnt vmcnt(9)
    v_mfma_f32_32x32x16_bf16 v[240:255], v[216:219], a[192:195], v[240:255]
    buffer_load_dwordx4 v[120:123], v40, s[24:27], s66 offen sc1
    v_fma_f32 v88, v88, v32, v33
    v_fma_f32 v89, v89, v32, v33
    v_fma_f32 v90, v90, v32, v33
    v_mfma_f32_32x32x16_bf16 a[32:47], v[216:219], a[196:199], a[32:47]
    v_fma_f32 v91, v91, v32, v33
    v_fma_f32 v92, v92, v32, v33
    v_fma_f32 v93, v93, v32, v33
    v_fma_f32 v94, v94, v32, v33
    v_fma_f32 v95, v95, v32, v33
    v_mul_f32 v88, v88, v160
    s_waitcnt vmcnt(9)
    v_mfma_f32_32x32x16_bf16 a[0:15], v[220:223], a[192:195], a[0:15]
    v_mul_f32 v89, v89, v161
    v_mul_f32 v90, v90, v162
    v_mul_f32 v91, v91, v163
    v_mul_f32 v92, v92, v164
    v_mul_f32 v93, v93, v165
    v_mul_f32 v94, v94, v166
    v_mfma_f32_32x32x16_bf16 a[48:63], v[220:223], a[196:199], a[48:63]
    v_mul_f32 v95, v95, v167
    v_exp_f32 v88, v88
    v_exp_f32 v89, v89
    v_exp_f32 v90, v90
    v_exp_f32_e64 v91, v91
    v_exp_f32 v92, v92
    s_waitcnt vmcnt(8)
    v_mfma_f32_32x32x16_bf16 v[224:239], v[184:187], a[200:203], v[224:239]
    s_xor_b32 s66, s91, 3
    s_mul_i32 s66, s66, 12288
    s_add_u32 s66, s66, s63
    buffer_load_dwordx4 v[212:215], v38, s[24:27], s66 offen sc1
    v_exp_f32 v93, v93
    v_exp_f32 v94, v94
    v_exp_f32_e64 v95, v95
    v_mfma_f32_32x32x16_bf16 a[16:31], v[184:187], a[204:207], a[16:31]
    buffer_load_dwordx4 v[216:219], v39, s[24:27], s66 offen sc1
    v_add_f32 v88, 1.0, v88
    v_add_f32 v89, 1.0, v89
    v_add_f32 v90, 1.0, v90
    s_waitcnt vmcnt(9)
    v_mfma_f32_32x32x16_bf16 v[240:255], v[188:191], a[200:203], v[240:255]
    buffer_load_dwordx4 v[220:223], v40, s[24:27], s66 offen sc1
    v_add_f32 v91, 1.0, v91
    v_add_f32 v92, 1.0, v92
    v_add_f32_e64 v93, 1.0, v93
    v_mfma_f32_32x32x16_bf16 a[32:47], v[188:191], a[204:207], a[32:47]
    v_add_f32 v94, 1.0, v94
    v_add_f32 v95, 1.0, v95
    v_rcp_f32 v88, v88
    v_rcp_f32 v89, v89
    v_rcp_f32_e64 v90, v90
    v_rcp_f32 v91, v91
    s_waitcnt vmcnt(9)
    v_mfma_f32_32x32x16_bf16 a[0:15], v[192:195], a[200:203], a[0:15]
    v_rcp_f32 v92, v92
    v_rcp_f32 v93, v93
    v_rcp_f32 v94, v94
    v_rcp_f32 v95, v95
    v_mul_f32 v160, v160, v88
    v_mul_f32 v161, v161, v89
    v_mfma_f32_32x32x16_bf16 a[48:63], v[192:195], a[204:207], a[48:63]
    v_mul_f32 v162, v162, v90
    v_mul_f32 v163, v163, v91
    v_mul_f32 v164, v164, v92
    v_mul_f32 v165, v165, v93
    v_mul_f32 v166, v166, v94
    v_mul_f32 v167, v167, v95
    s_getpc_b64 s[76:77]
    s_lshr_b32 s78, s2, 3
    s_lshl_b32 s78, s78, 9
    v_and_b32 v2, 7, v1
    v_lshl_add_u32 v2, v2, 6, s78
L_pc_26:
    v_min_u32 v2, L_code_end-L_pc_26-64, v2
    global_load_dword v3, v2, s[76:77]
    s_lshl_b32 s76, s6, 11
    s_add_u32 s76, s76, 13139968
    v_bfe_u32 v4, v1, 0, 3
    v_lshlrev_b32 v4, 8, v4
    v_bfe_u32 v2, v1, 3, 1
    v_lshl_add_u32 v4, v2, 7, v4
    v_bfe_u32 v2, v1, 4, 1
    v_lshl_add_u32 v4, v2, 16, v4
    v_add_u32 v4, s76, v4
    buffer_load_dword v3, v4, s[24:27], 0 offen sc1
    s_waitcnt vmcnt(10)
    v_mfma_f32_32x32x16_bf16 v[224:239], v[124:127], a[208:211], v[224:239]
    s_add_u32 s66, s66, 3072
    buffer_load_dwordx4 v[184:187], v38, s[24:27], s66 offen sc1
    v_mul_f32 v88, v168, v168
    v_mul_f32 v89, v169, v169
    v_mul_f32_e64 v90, v170, v170
    v_mfma_f32_32x32x16_bf16 a[16:31], v[124:127], a[212:215], a[16:31]
    buffer_load_dwordx4 v[188:191], v39, s[24:27], s66 offen sc1
    v_mul_f32 v91, v171, v171
    v_mul_f32 v92, v172, v172
    v_mul_f32 v93, v173, v173
    s_waitcnt vmcnt(11)
    v_mfma_f32_32x32x16_bf16 v[240:255], v[128:131], a[208:211], v[240:255]
    buffer_load_dwordx4 v[192:195], v40, s[24:27], s66 offen sc1
    v_mul_f32 v94, v174, v174
    v_mul_f32 v95, v175, v175
    v_fma_f32 v88, v88, v32, v33
    v_mfma_f32_32x32x16_bf16 a[32:47], v[128:131], a[212:215], a[32:47]
    v_fma_f32 v89, v89, v32, v33
    v_fma_f32 v90, v90, v32, v33
    v_fma_f32 v91, v91, v32, v33
    v_fma_f32 v92, v92, v32, v33
    v_fma_f32 v93, v93, v32, v33
    v_fma_f32 v94, v94, v32, v33
    s_waitcnt vmcnt(11)
    v_mfma_f32_32x32x16_bf16 a[0:15], v[132:135], a[208:211], a[0:15]
    v_fma_f32 v95, v95, v32, v33
    v_mul_f32 v88, v88, v168
    v_mul_f32 v89, v89, v169
    v_mul_f32 v90, v90, v170
    v_mul_f32 v91, v91, v171
    v_mul_f32 v92, v92, v172
    v_mfma_f32_32x32x16_bf16 a[48:63], v[132:135], a[212:215], a[48:63]
    v_mul_f32 v93, v93, v173
    v_mul_f32 v94, v94, v174
    v_mul_f32 v95, v95, v175
    v_exp_f32 v88, v88
    v_exp_f32_e64 v89, v89
    v_exp_f32 v90, v90
    s_lshl_b32 s68, s7, 14
    s_lshl_b32 s81, s5, 13
    s_add_u32 s68, s68, s81
    s_add_u32 s68, s68, 12582912
    s_add_u32 s69, s68, 4096
    buffer_load_dwordx4 v[56:59], v42, s[24:27], s68 offen offset:0 sc1
    buffer_load_dwordx4 v[60:63], v42, s[24:27], s68 offen offset:1024 sc1
    buffer_load_dwordx4 v[64:67], v42, s[24:27], s68 offen offset:2048 sc1
    buffer_load_dwordx4 v[68:71], v42, s[24:27], s68 offen offset:3072 sc1
    buffer_load_dwordx4 v[196:199], v42, s[24:27], s69 offen offset:0 sc1
    buffer_load_dwordx4 v[200:203], v42, s[24:27], s69 offen offset:1024 sc1
    buffer_load_dwordx4 v[204:207], v42, s[24:27], s69 offen offset:2048 sc1
    buffer_load_dwordx4 v[208:211], v42, s[24:27], s69 offen offset:3072 sc1
    s_waitcnt vmcnt(18)
    v_mfma_f32_32x32x16_bf16 v[224:239], v[112:115], a[216:219], v[224:239]
    s_add_u32 s66, s66, 3072
    buffer_load_dwordx4 v[124:127], v38, s[24:27], s66 offen sc1
    v_exp_f32 v91, v91
    v_exp_f32 v92, v92
    v_exp_f32 v93, v93
    v_mfma_f32_32x32x16_bf16 a[16:31], v[112:115], a[220:223], a[16:31]
    buffer_load_dwordx4 v[128:131], v39, s[24:27], s66 offen sc1
    v_exp_f32 v94, v94
    v_exp_f32 v95, v95
    v_add_f32 v88, 1.0, v88
    s_waitcnt vmcnt(19)
    v_mfma_f32_32x32x16_bf16 v[240:255], v[116:119], a[216:219], v[240:255]
    buffer_load_dwordx4 v[132:135], v40, s[24:27], s66 offen sc1
    v_add_f32 v89, 1.0, v89
    v_add_f32 v90, 1.0, v90
    v_add_f32_e64 v91, 1.0, v91
    v_mfma_f32_32x32x16_bf16 a[32:47], v[116:119], a[220:223], a[32:47]
    v_add_f32 v92, 1.0, v92
    v_add_f32 v93, 1.0, v93
    v_add_f32 v94, 1.0, v94
    v_add_f32 v95, 1.0, v95
    v_rcp_f32_e64 v88, v88
    v_rcp_f32 v89, v89
    s_waitcnt vmcnt(19)
    v_mfma_f32_32x32x16_bf16 a[0:15], v[120:123], a[216:219], a[0:15]
    v_rcp_f32 v90, v90
    v_rcp_f32 v91, v91
    v_rcp_f32 v92, v92
    v_rcp_f32 v93, v93
    v_rcp_f32 v94, v94
    v_rcp_f32 v95, v95
    v_mfma_f32_32x32x16_bf16 a[48:63], v[120:123], a[220:223], a[48:63]
    v_mul_f32 v168, v168, v88
    v_mul_f32 v169, v169, v89
    v_mul_f32 v170, v170, v90
    v_mul_f32 v171, v171, v91
    v_mul_f32_e64 v172, v172, v92
    v_mul_f32 v173, v173, v93
    s_waitcnt vmcnt(18)
    v_mfma_f32_32x32x16_bf16 v[224:239], v[212:215], a[224:227], v[224:239]
    s_add_u32 s66, s66, 3072
    buffer_load_dwordx4 v[112:115], v38, s[24:27], s66 offen sc1
    v_mul_f32 v174, v174, v94
    v_mul_f32 v175, v175, v95
    v_cvt_pk_bf16_f32 v152, v152, v153
    v_mfma_f32_32x32x16_bf16 a[16:31], v[212:215], a[228:231], a[16:31]
    buffer_load_dwordx4 v[116:119], v39, s[24:27], s66 offen sc1
    v_cvt_pk_bf16_f32 v153, v154, v155
    v_cvt_pk_bf16_f32 v154, v156, v157
    v_cvt_pk_bf16_f32 v155, v158, v159
    s_waitcnt vmcnt(19)
    v_mfma_f32_32x32x16_bf16 v[240:255], v[216:219], a[224:227], v[240:255]
    buffer_load_dwordx4 v[120:123], v40, s[24:27], s66 offen sc1
    v_cvt_pk_bf16_f32 v156, v160, v161
    v_cvt_pk_bf16_f32 v157, v162, v163
    v_cvt_pk_bf16_f32 v158, v164, v165
    v_mfma_f32_32x32x16_bf16 a[32:47], v[216:219], a[228:231], a[32:47]
    v_cvt_pk_bf16_f32 v159, v166, v167
    v_cvt_pk_bf16_f32 v160, v168, v169
    v_cvt_pk_bf16_f32 v161, v170, v171
    v_cvt_pk_bf16_f32 v162, v172, v173
    v_cvt_pk_bf16_f32 v163, v174, v175
    s_waitcnt vmcnt(19)
    v_mfma_f32_32x32x16_bf16 a[0:15], v[220:223], a[224:227], a[0:15]
    v_mfma_f32_32x32x16_bf16 a[48:63], v[220:223], a[228:231], a[48:63]
    s_waitcnt vmcnt(16)
    v_mfma_f32_32x32x16_bf16 v[224:239], v[184:187], a[232:235], v[224:239]
    s_xor_b32 s66, s91, 4
    s_mul_i32 s66, s66, 12288
    s_add_u32 s66, s66, s63
    buffer_load_dwordx4 v[212:215], v38, s[24:27], s66 offen sc1
    v_mfma_f32_32x32x16_bf16 a[16:31], v[184:187], a[236:239], a[16:31]
    buffer_load_dwordx4 v[216:219], v39, s[24:27], s66 offen sc1
    s_waitcnt vmcnt(17)
    v_mfma_f32_32x32x16_bf16 v[240:255], v[188:191], a[232:235], v[240:255]
    buffer_load_dwordx4 v[220:223], v40, s[24:27], s66 offen sc1
    v_mfma_f32_32x32x16_bf16 a[32:47], v[188:191], a[236:239], a[32:47]
    s_waitcnt vmcnt(17)
    v_mfma_f32_32x32x16_bf16 a[0:15], v[192:195], a[232:235], a[0:15]
    v_mfma_f32_32x32x16_bf16 a[48:63], v[192:195], a[236:239], a[48:63]
    s_waitcnt vmcnt(8)
    v_mfma_f32_32x32x16_bf16 v[224:239], v[124:127], a[240:243], v[224:239]
    s_add_u32 s66, s66, 3072
    buffer_load_dwordx4 v[184:187], v38, s[24:27], s66 offen sc1
    v_mfma_f32_32x32x16_bf16 a[16:31], v[124:127], a[244:247], a[16:31]
    buffer_load_dwordx4 v[188:191], v39, s[24:27], s66 offen sc1
    s_waitcnt vmcnt(9)
    v_mfma_f32_32x32x16_bf16 v[240:255], v[128:131], a[240:243], v[240:255]
    buffer_load_dwordx4 v[192:195], v40, s[24:27], s66 offen sc1
    v_mfma_f32_32x32x16_bf16 a[32:47], v[128:131], a[244:247], a[32:47]
    s_waitcnt vmcnt(9)
    v_mfma_f32_32x32x16_bf16 a[0:15], v[132:135], a[240:243], a[0:15]
    v_mfma_f32_32x32x16_bf16 a[48:63], v[132:135], a[244:247], a[48:63]
    v_add_u32 v26, 98304, v41
    v_xor_b32 v27, 32, v26
    v_xor_b32 v28, 64, v26
    v_xor_b32 v29, 96, v26
    v_min3_u32 v5, v57, v59, v61
    v_max3_u32 v6, v57, v59, v61
    v_min3_u32 v5, v5, v63, v65
    v_max3_u32 v6, v6, v63, v65
    v_min3_u32 v5, v5, v67, v69
    v_max3_u32 v6, v6, v67, v69
    v_min3_u32 v5, v5, v71, v197
    v_max3_u32 v6, v6, v71, v197
    v_min3_u32 v5, v5, v199, v201
    v_max3_u32 v6, v6, v199, v201
    v_min3_u32 v5, v5, v203, v205
    v_max3_u32 v6, v6, v203, v205
    v_min3_u32 v5, v5, v207, v209
    v_max3_u32 v6, v6, v207, v209
    v_min_u32 v5, v5, v211
    v_max_u32 v6, v6, v211
    v_xor_b32 v5, s83, v5
    v_xor_b32 v6, s83, v6
    v_or_b32_e64 v5, v5, v6
    v_cmp_ne_u32 vcc, 0, v5
    s_nop 0
    s_cbranch_vccnz L_slow_kvf_27
L_back_kvf_28:
    s_waitcnt vmcnt(8)
    v_mfma_f32_32x32x16_bf16 v[224:239], v[112:115], a[248:251], v[224:239]
    s_add_u32 s66, s66, 3072
    ds_read_b128 v[72:75], v26 offset:0
    buffer_load_dwordx4 v[124:127], v38, s[24:27], s66 offen sc1
    v_mov_b32 v57, v58
    v_mov_b32 v58, v60
    v_mov_b32_e64 v59, v62
    v_mfma_f32_32x32x16_bf16 a[16:31], v[112:115], a[252:255], a[16:31]
    ds_read_b128 v[76:79], v26 offset:4096
    buffer_load_dwordx4 v[128:131], v39, s[24:27], s66 offen sc1
    v_mov_b32 v60, v64
    v_mov_b32 v61, v66
    v_mov_b32 v62, v68
    s_waitcnt vmcnt(9)
    v_mfma_f32_32x32x16_bf16 v[240:255], v[116:119], a[248:251], v[240:255]
    buffer_load_dwordx4 v[132:135], v40, s[24:27], s66 offen sc1
    v_mov_b32 v63, v70
    v_mov_b32 v197, v198
    v_mov_b32_e64 v198, v200
    v_mfma_f32_32x32x16_bf16 a[32:47], v[116:119], a[252:255], a[32:47]
    v_mov_b32 v199, v202
    v_mov_b32 v200, v204
    v_mov_b32 v201, v206
    v_mov_b32 v202, v208
    v_mov_b32 v203, v210
    v_mfma_f32_32x32x16_bf16 a[64:79], v[56:59], v[136:139], 0
    s_waitcnt vmcnt(9)
    v_mfma_f32_32x32x16_bf16 a[0:15], v[120:123], a[248:251], a[0:15]
    v_mfma_f32_32x32x16_bf16 a[64:79], v[60:63], v[140:143], a[64:79]
    v_mfma_f32_32x32x16_bf16 a[80:95], v[196:199], v[144:147], 0
    v_mfma_f32_32x32x16_bf16 a[80:95], v[200:203], v[148:151], a[80:95]
    s_lshl_b32 s76, s6, 16
    s_lshl_b32 s81, s4, 15
    s_add_u32 s76, s76, s81
    v_mfma_f32_32x32x16_bf16 a[48:63], v[120:123], a[252:255], a[48:63]
    s_lshl_b32 s81, s88, 11
    s_add_u32 s76, s76, s81
    s_lshl_b32 s81, s5, 10
    s_add_u32 s76, s76, s81
    s_add_u32 s76, s76, 6291456
    v_bfe_u32 v7, v1, 4, 1
    s_waitcnt vmcnt(8) lgkmcnt(1)
    v_mfma_f32_32x32x16_bf16 v[224:239], v[212:215], v[72:75], v[224:239]
    s_add_u32 s66, s66, 3072
    ds_read_b128 v[80:83], v27 offset:0
    buffer_load_dwordx4 v[112:115], v38, s[24:27], s66 offen sc1
    v_lshlrev_b32 v7, 14, v7
    v_bfe_u32 v2, v1, 5, 1
    v_lshl_add_u32 v7, v2, 8, v7
    s_waitcnt lgkmcnt(1)
    v_mfma_f32_32x32x16_bf16 a[16:31], v[212:215], v[76:79], a[16:31]
    ds_read_b128 v[84:87], v27 offset:4096
    buffer_load_dwordx4 v[116:119], v39, s[24:27], s66 offen sc1
    v_bfe_u32 v2, v1, 0, 4
    v_lshl_add_u32 v7, v2, 4, v7
    v_add_u32 v7, s76, v7
    s_waitcnt vmcnt(9)
    v_mfma_f32_32x32x16_bf16 v[240:255], v[216:219], v[72:75], v[240:255]
    buffer_load_dwordx4 v[120:123], v40, s[24:27], s66 offen sc1
    v_accvgpr_read_b32 v56, a72
    v_accvgpr_read_b32 v64, a64
    v_accvgpr_read_b32 v65, a65
    v_mfma_f32_32x32x16_bf16 a[32:47], v[216:219], v[76:79], a[32:47]
    v_accvgpr_read_b32 v66, a66
    v_accvgpr_read_b32 v67, a67
    v_accvgpr_read_b32 v68, a68
    v_accvgpr_read_b32 v69, a69
    v_accvgpr_read_b32 v70, a70
    v_accvgpr_read_b32 v71, a71
    s_waitcnt vmcnt(9)
    v_mfma_f32_32x32x16_bf16 a[0:15], v[220:223], v[72:75], a[0:15]
    v_add_f32 v56, 0x358637bd, v56
    v_rcp_f32 v56, v56
    s_nop 0
    v_mul_f32 v64, v56, v64
    v_mul_f32 v65, v56, v65
    v_mul_f32 v66, v56, v66
    v_mul_f32_e64 v67, v56, v67
    v_mfma_f32_32x32x16_bf16 a[48:63], v[220:223], v[76:79], a[48:63]
    v_mul_f32 v68, v56, v68
    v_mul_f32 v69, v56, v69
    v_mul_f32 v70, v56, v70
    v_mul_f32 v71, v56, v71
    v_cvt_pk_bf16_f32 v176, v64, v65
    v_cvt_pk_bf16_f32 v177, v66, v67
    v_cvt_pk_bf16_f32 v178, v68, v69
    v_cvt_pk_bf16_f32 v179, v70, v71
    v_accvgpr_read_b32 v196, a80
    v_accvgpr_read_b32 v204, a88
    v_accvgpr_read_b32 v205, a89
    v_accvgpr_read_b32 v206, a90
    v_accvgpr_read_b32 v207, a91
    v_accvgpr_read_b32 v208, a92
    v_accvgpr_read_b32 v209, a93
    v_accvgpr_read_b32 v210, a94
    v_accvgpr_read_b32 v211, a95
    v_add_f32 v196, 0x358637bd, v196
    v_rcp_f32 v196, v196
    s_nop 0
    v_mul_f32 v204, v196, v204
    v_mul_f32 v205, v196, v205
    v_mul_f32 v206, v196, v206
    v_mul_f32 v207, v196, v207
    v_mul_f32 v208, v196, v208
    v_mul_f32 v209, v196, v209
    v_mul_f32 v210, v196, v210
    v_mul_f32 v211, v196, v211
    v_cvt_pk_bf16_f32 v180, v204, v205
    v_cvt_pk_bf16_f32 v181, v206, v207
    v_cvt_pk_bf16_f32 v182, v208, v209
    v_cvt_pk_bf16_f32 v183, v210, v211
    buffer_store_dwordx4 v[176:179], v7, s[24:27], 0 offen offset:0 sc1
    buffer_store_dwordx4 v[180:183], v7, s[24:27], 0 offen offset:512 sc1
    s_waitcnt vmcnt(10) lgkmcnt(1)
    v_mfma_f32_32x32x16_bf16 v[224:239], v[184:187], v[80:83], v[224:239]
    s_xor_b32 s66, s91, 5
    s_mul_i32 s66, s66, 12288
    s_add_u32 s66, s66, s63
    ds_read_b128 v[72:75], v28 offset:0
    buffer_load_dwordx4 v[212:215], v38, s[24:27], s66 offen sc1
    s_waitcnt lgkmcnt(1)
    v_mfma_f32_32x32x16_bf16 a[16:31], v[184:187], v[84:87], a[16:31]
    ds_read_b128 v[76:79], v28 offset:4096
    buffer_load_dwordx4 v[216:219], v39, s[24:27], s66 offen sc1
    s_waitcnt vmcnt(11)
    v_mfma_f32_32x32x16_bf16 v[240:255], v[188:191], v[80:83], v[240:255]
    buffer_load_dwordx4 v[220:223], v40, s[24:27], s66 offen sc1
    v_mfma_f32_32x32x16_bf16 a[32:47], v[188:191], v[84:87], a[32:47]
    s_waitcnt vmcnt(11)
    v_mfma_f32_32x32x16_bf16 a[0:15], v[192:195], v[80:83], a[0:15]
    v_mfma_f32_32x32x16_bf16 a[48:63], v[192:195], v[84:87], a[48:63]
    s_waitcnt vmcnt(10) lgkmcnt(1)
    v_mfma_f32_32x32x16_bf16 v[224:239], v[124:127], v[72:75], v[224:239]
    s_add_u32 s66, s66, 3072
    ds_read_b128 v[80:83], v29 offset:0
    buffer_load_dwordx4 v[184:187], v38, s[24:27], s66 offen sc1
    s_waitcnt lgkmcnt(1)
    v_mfma_f32_32x32x16_bf16 a[16:31], v[124:127], v[76:79], a[16:31]
    ds_read_b128 v[84:87], v29 offset:4096
    buffer_load_dwordx4 v[188:191], v39, s[24:27], s66 offen sc1
    s_waitcnt vmcnt(11)
    v_mfma_f32_32x32x16_bf16 v[240:255], v[128:131], v[72:75], v[240:255]
    buffer_load_dwordx4 v[192:195], v40, s[24:27], s66 offen sc1
    v_mfma_f32_32x32x16_bf16 a[32:47], v[128:131], v[76:79], a[32:47]
    s_waitcnt vmcnt(11)
    v_mfma_f32_32x32x16_bf16 a[0:15], v[132:135], v[72:75], a[0:15]
    v_mfma_f32_32x32x16_bf16 a[48:63], v[132:135], v[76:79], a[48:63]
    v_add_u32 v26, 131072, v41
    v_xor_b32_e64 v27, 32, v26
    v_xor_b32 v28, 64, v26
    v_xor_b32 v29, 96, v26
    s_waitcnt vmcnt(10) lgkmcnt(1)
    v_mfma_f32_32x32x16_bf16 v[224:239], v[112:115], v[80:83], v[224:239]
    s_add_u32 s66, s66, 3072
    ds_read_b128 v[72:75], v26 offset:0
    buffer_load_dwordx4 v[124:127], v38, s[24:27], s66 offen sc1
    s_waitcnt lgkmcnt(1)
    v_mfma_f32_32x32x16_bf16 a[16:31], v[112:115], v[84:87], a[16:31]
    ds_read_b128 v[76:79], v26 offset:4096
    buffer_load_dwordx4 v[128:131], v39, s[24:27], s66 offen sc1
    s_waitcnt vmcnt(11)
    v_mfma_f32_32x32x16_bf16 v[240:255], v[116:119], v[80:83], v[240:255]
    buffer_load_dwordx4 v[132:135], v40, s[24:27], s66 offen sc1
    v_mfma_f32_32x32x16_bf16 a[32:47], v[116:119], v[84:87], a[32:47]
    s_waitcnt vmcnt(11)
    v_mfma_f32_32x32x16_bf16 a[0:15], v[120:123], v[80:83], a[0:15]
    v_mfma_f32_32x32x16_bf16 a[48:63], v[120:123], v[84:87], a[48:63]
    s_waitcnt vmcnt(8) lgkmcnt(1)
    v_mfma_f32_32x32x16_bf16 v[224:239], v[212:215], v[72:75], v[224:239]
    s_add_u32 s66, s66, 3072
    ds_read_b128 v[80:83], v27 offset:0
    buffer_load_dwordx4 v[112:115], v38, s[24:27], s66 offen sc1
    s_waitcnt lgkmcnt(1)
    v_mfma_f32_32x32x16_bf16 a[16:31], v[212:215], v[76:79], a[16:31]
    ds_read_b128 v[84:87], v27 offset:4096
    buffer_load_dwordx4 v[116:119], v39, s[24:27], s66 offen sc1
    s_waitcnt vmcnt(9)
    v_mfma_f32_32x32x16_bf16 v[240:255], v[216:219], v[72:75], v[240:255]
    buffer_load_dwordx4 v[120:123], v40, s[24:27], s66 offen sc1
    v_mfma_f32_32x32x16_bf16 a[32:47], v[216:219], v[76:79], a[32:47]
    s_waitcnt vmcnt(9)
    v_mfma_f32_32x32x16_bf16 a[0:15], v[220:223], v[72:75], a[0:15]
    v_mfma_f32_32x32x16_bf16 a[48:63], v[220:223], v[76:79], a[48:63]
    s_waitcnt vmcnt(8) lgkmcnt(1)
    v_mfma_f32_32x32x16_bf16 v[224:239], v[184:187], v[80:83], v[224:239]
    s_xor_b32 s66, s91, 6
    s_mul_i32 s66, s66, 12288
    s_add_u32 s66, s66, s63
    ds_read_b128 v[72:75], v28 offset:0
    buffer_load_dwordx4 v[212:215], v38, s[24:27], s66 offen sc1
    s_waitcnt lgkmcnt(1)
    v_mfma_f32_32x32x16_bf16 a[16:31], v[184:187], v[84:87], a[16:31]
    ds_read_b128 v[76:79], v28 offset:4096
    buffer_load_dwordx4 v[216:219], v39, s[24:27], s66 offen sc1
    s_waitcnt vmcnt(9)
    v_mfma_f32_32x32x16_bf16 v[240:255], v[188:191], v[80:83], v[240:255]
    buffer_load_dwordx4 v[220:223], v40, s[24:27], s66 offen sc1
    v_mfma_f32_32x32x16_bf16 a[32:47], v[188:191], v[84:87], a[32:47]
    s_waitcnt vmcnt(9)
    v_mfma_f32_32x32x16_bf16 a[0:15], v[192:195], v[80:83], a[0:15]
    v_mfma_f32_32x32x16_bf16 a[48:63], v[192:195], v[84:87], a[48:63]
    s_barrier
    s_cmp_lg_u32 s3, 0
    s_cbranch_scc1 L_w0_30
    s_lshl_b32 s76, s6, 11
    s_lshl_b32 s81, s7, 8
    s_add_u32 s76, s76, s81
    s_add_u32 s76, s76, 13205504
    v_mov_b32 v8, s76
    v_mov_b32 v9, s83
    s_mov_b64 exec, 1
    buffer_store_dword v9, v8, s[24:27], 0 offen offset:128
    buffer_store_dword v9, v8, s[24:27], 0 offen sc1
    s_mov_b64 exec, -1
L_w0_30:
    s_waitcnt vmcnt(8) lgkmcnt(1)
    v_mfma_f32_32x32x16_bf16 v[224:239], v[124:127], v[72:75], v[224:239]
    s_add_u32 s66, s66, 3072
    ds_read_b128 v[80:83], v29 offset:0
    buffer_load_dwordx4 v[184:187], v38, s[24:27], s66 offen sc1
    s_waitcnt lgkmcnt(1)
    v_mfma_f32_32x32x16_bf16 a[16:31], v[124:127], v[76:79], a[16:31]
    ds_read_b128 v[84:87], v29 offset:4096
    buffer_load_dwordx4 v[188:191], v39, s[24:27], s66 offen sc1
    s_waitcnt vmcnt(9)
    v_mfma_f32_32x32x16_bf16 v[240:255], v[128:131], v[72:75], v[240:255]
    buffer_load_dwordx4 v[192:195], v40, s[24:27], s66 offen sc1
    v_mfma_f32_32x32x16_bf16 a[32:47], v[128:131], v[76:79], a[32:47]
    s_waitcnt vmcnt(9)
    v_mfma_f32_32x32x16_bf16 a[0:15], v[132:135], v[72:75], a[0:15]
    v_mfma_f32_32x32x16_bf16 a[48:63], v[132:135], v[76:79], a[48:63]
    v_add_u32 v26, 0, v41
    v_xor_b32_e64 v27, 32, v26
    v_xor_b32 v28, 64, v26
    v_xor_b32 v29, 96, v26
    s_waitcnt vmcnt(8) lgkmcnt(1)
    v_mfma_f32_32x32x16_bf16 v[224:239], v[112:115], v[80:83], v[224:239]
    s_add_u32 s66, s66, 3072
    ds_read_b128 v[72:75], v26 offset:0
    buffer_load_dwordx4 v[124:127], v38, s[24:27], s66 offen sc1
    s_waitcnt lgkmcnt(1)
    v_mfma_f32_32x32x16_bf16 a[16:31], v[112:115], v[84:87], a[16:31]
    ds_read_b128 v[76:79], v26 offset:4096
    buffer_load_dwordx4 v[128:131], v39, s[24:27], s66 offen sc1
    s_waitcnt vmcnt(9)
    v_mfma_f32_32x32x16_bf16 v[240:255], v[116:119], v[80:83], v[240:255]
    buffer_load_dwordx4 v[132:135], v40, s[24:27], s66 offen sc1
    v_mfma_f32_32x32x16_bf16 a[32:47], v[116:119], v[84:87], a[32:47]
    s_waitcnt vmcnt(9)
    v_mfma_f32_32x32x16_bf16 a[0:15], v[120:123], v[80:83], a[0:15]
    v_mfma_f32_32x32x16_bf16 a[48:63], v[120:123], v[84:87], a[48:63]
    s_waitcnt vmcnt(8) lgkmcnt(1)
    v_mfma_f32_32x32x16_bf16 v[224:239], v[212:215], v[72:75], v[224:239]
    s_add_u32 s66, s66, 3072
    ds_read_b128 v[80:83], v27 offset:0
    buffer_load_dwordx4 v[112:115], v38, s[24:27], s66 offen sc1
    s_waitcnt lgkmcnt(1)
    v_mfma_f32_32x32x16_bf16 a[16:31], v[212:215], v[76:79], a[16:31]
    ds_read_b128 v[84:87], v27 offset:4096
    buffer_load_dwordx4 v[116:119], v39, s[24:27], s66 offen sc1
    s_waitcnt vmcnt(9)
    v_mfma_f32_32x32x16_bf16 v[240:255], v[216:219], v[72:75], v[240:255]
    buffer_load_dwordx4 v[120:123], v40, s[24:27], s66 offen sc1
    v_mfma_f32_32x32x16_bf16 a[32:47], v[216:219], v[76:79], a[32:47]
    s_waitcnt vmcnt(9)
    v_mfma_f32_32x32x16_bf16 a[0:15], v[220:223], v[72:75], a[0:15]
    v_mfma_f32_32x32x16_bf16 a[48:63], v[220:223], v[76:79], a[48:63]
    s_waitcnt vmcnt(8) lgkmcnt(1)
    v_mfma_f32_32x32x16_bf16 v[224:239], v[184:187], v[80:83], v[224:239]
    s_xor_b32 s66, s91, 7
    s_mul_i32 s66, s66, 12288
    s_add_u32 s66, s66, s63
    ds_read_b128 v[72:75], v28 offset:0
    buffer_load_dwordx4 v[212:215], v38, s[24:27], s66 offen sc1
    s_waitcnt lgkmcnt(1)
    v_mfma_f32_32x32x16_bf16 a[16:31], v[184:187], v[84:87], a[16:31]
    ds_read_b128 v[76:79], v28 offset:4096
    buffer_load_dwordx4 v[216:219], v39, s[24:27], s66 offen sc1
    s_waitcnt vmcnt(9)
    v_mfma_f32_32x32x16_bf16 v[240:255], v[188:191], v[80:83], v[240:255]
    buffer_load_dwordx4 v[220:223], v40, s[24:27], s66 offen sc1
    v_mfma_f32_32x32x16_bf16 a[32:47], v[188:191], v[84:87], a[32:47]
    s_waitcnt vmcnt(9)
    v_mfma_f32_32x32x16_bf16 a[0:15], v[192:195], v[80:83], a[0:15]
    v_mfma_f32_32x32x16_bf16 a[48:63], v[192:195], v[84:87], a[48:63]
    s_lshl_b32 s76, s6, 11
    s_add_u32 s76, s76, 13205504
    v_bfe_u32 v43, v1, 0, 3
    v_lshlrev_b32_e64 v43, 8, v43
    v_bfe_u32 v2, v1, 3, 1
    v_lshl_add_u32 v43, v2, 7, v43
    v_add_u32 v43, s76, v43
    buffer_load_dword v44, v43, s[24:27], 0 offen sc1
    s_waitcnt vmcnt(9) lgkmcnt(1)
    v_mfma_f32_32x32x16_bf16 v[224:239], v[124:127], v[72:75], v[224:239]
    s_add_u32 s66, s66, 3072
    ds_read_b128 v[80:83], v29 offset:0
    buffer_load_dwordx4 v[184:187], v38, s[24:27], s66 offen sc1
    s_waitcnt lgkmcnt(1)
    v_mfma_f32_32x32x16_bf16 a[16:31], v[124:127], v[76:79], a[16:31]
    ds_read_b128 v[84:87], v29 offset:4096
    buffer_load_dwordx4 v[188:191], v39, s[24:27], s66 offen sc1
    s_waitcnt vmcnt(10)
    v_mfma_f32_32x32x16_bf16 v[240:255], v[128:131], v[72:75], v[240:255]
    buffer_load_dwordx4 v[192:195], v40, s[24:27], s66 offen sc1
    v_mfma_f32_32x32x16_bf16 a[32:47], v[128:131], v[76:79], a[32:47]
    s_waitcnt vmcnt(10)
    v_mfma_f32_32x32x16_bf16 a[0:15], v[132:135], v[72:75], a[0:15]
    v_mfma_f32_32x32x16_bf16 a[48:63], v[132:135], v[76:79], a[48:63]
    v_add_u32 v26, 32768, v41
    v_xor_b32 v27, 32, v26
    v_xor_b32 v28, 64, v26
    v_xor_b32 v29, 96, v26
    s_waitcnt vmcnt(9) lgkmcnt(1)
    v_mfma_f32_32x32x16_bf16 v[224:239], v[112:115], v[80:83], v[224:239]
    s_add_u32 s66, s66, 3072
    ds_read_b128 v[72:75], v26 offset:0
    buffer_load_dwordx4 v[124:127], v38, s[24:27], s66 offen sc1
    s_waitcnt lgkmcnt(1)
    v_mfma_f32_32x32x16_bf16 a[16:31], v[112:115], v[84:87], a[16:31]
    ds_read_b128 v[76:79], v26 offset:4096
    buffer_load_dwordx4 v[128:131], v39, s[24:27], s66 offen sc1
    s_waitcnt vmcnt(10)
    v_mfma_f32_32x32x16_bf16 v[240:255], v[116:119], v[80:83], v[240:255]
    buffer_load_dwordx4 v[132:135], v40, s[24:27], s66 offen sc1
    v_mfma_f32_32x32x16_bf16 a[32:47], v[116:119], v[84:87], a[32:47]
    s_waitcnt vmcnt(10)
    v_mfma_f32_32x32x16_bf16 a[0:15], v[120:123], v[80:83], a[0:15]
    v_mfma_f32_32x32x16_bf16 a[48:63], v[120:123], v[84:87], a[48:63]
    s_waitcnt vmcnt(9) lgkmcnt(1)
    v_mfma_f32_32x32x16_bf16 v[224:239], v[212:215], v[72:75], v[224:239]
    s_add_u32 s66, s66, 3072
    ds_read_b128 v[80:83], v27 offset:0
    buffer_load_dwordx4 v[112:115], v38, s[24:27], s66 offen sc1
    s_waitcnt lgkmcnt(1)
    v_mfma_f32_32x32x16_bf16 a[16:31], v[212:215], v[76:79], a[16:31]
    ds_read_b128 v[84:87], v27 offset:4096
    buffer_load_dwordx4 v[116:119], v39, s[24:27], s66 offen sc1
    s_waitcnt vmcnt(10)
    v_mfma_f32_32x32x16_bf16 v[240:255], v[216:219], v[72:75], v[240:255]
    buffer_load_dwordx4 v[120:123], v40, s[24:27], s66 offen sc1
    v_mfma_f32_32x32x16_bf16 a[32:47], v[216:219], v[76:79], a[32:47]
    s_waitcnt vmcnt(10)
    v_mfma_f32_32x32x16_bf16 a[0:15], v[220:223], v[72:75], a[0:15]
    v_mfma_f32_32x32x16_bf16 a[48:63], v[220:223], v[76:79], a[48:63]
    s_and_b32 s70, s7, 1
    s_min_u32 s70, s70, 1
    s_lshl_b32 s71, s6, 16
    s_lshl_b32 s81, s3, 14
    s_add_u32 s71, s71, s81
    s_lshl_b32 s81, s70, 13
    s_add_u32 s71, s71, s81
    s_add_u32 s71, s71, 6291456
    s_mul_i32 s92, s70, 16384
    s_sub_u32 s92, 4096, s92
    s_mul_i32 s93, s70, 22528
    s_sub_u32 s93, 3072, s93
    s_mul_i32 s94, s70, 90112
    s_sub_u32 s94, 45056, s94
    s_mul_i32 s95, s70, 65536
    s_sub_u32 s95, 32768, s95
    s_waitcnt vmcnt(9)
    v_cmp_eq_u32 vcc, s83, v44
    s_nop 3
    s_lshr_b32 s81, vcc_lo, 8
    s_or_b32 s81, s81, vcc_lo
    s_and_b32 s81, s81, 0xff
    s_cmp_eq_u32 s81, 0xff
    s_cbranch_scc0 L_slow_f5_31
L_back_f5_32:
    s_waitcnt vmcnt(8) lgkmcnt(1)
    v_mfma_f32_32x32x16_bf16 v[224:239], v[184:187], v[80:83], v[224:239]
    ds_read_b128 v[72:75], v28 offset:0
    buffer_load_dwordx4 a[128:131], v42, s[24:27], s71 offen offset:0 sc1
    s_waitcnt lgkmcnt(1)
    v_mfma_f32_32x32x16_bf16 a[16:31], v[184:187], v[84:87], a[16:31]
    ds_read_b128 v[76:79], v28 offset:4096
    buffer_load_dwordx4 a[132:135], v42, s[24:27], s71 offen offset:1024 sc1
    s_waitcnt vmcnt(9)
    v_mfma_f32_32x32x16_bf16 v[240:255], v[188:191], v[80:83], v[240:255]
    buffer_load_dwordx4 a[136:139], v42, s[24:27], s71 offen offset:2048 sc1
    v_mfma_f32_32x32x16_bf16 a[32:47], v[188:191], v[84:87], a[32:47]
    buffer_load_dwordx4 a[140:143], v42, s[24:27], s71 offen offset:3072 sc1
    s_waitcnt vmcnt(10)
    v_mfma_f32_32x32x16_bf16 a[0:15], v[192:195], v[80:83], a[0:15]
    s_add_u32 s71, s71, 4096
    buffer_load_dwordx4 a[144:147], v42, s[24:27], s71 offen offset:0 sc1
    v_mfma_f32_32x32x16_bf16 a[48:63], v[192:195], v[84:87], a[48:63]
    buffer_load_dwordx4 a[148:151], v42, s[24:27], s71 offen offset:1024 sc1
    s_waitcnt vmcnt(11) lgkmcnt(1)
    v_mfma_f32_32x32x16_bf16 v[224:239], v[124:127], v[72:75], v[224:239]
    ds_read_b128 v[80:83], v29 offset:0
    buffer_load_dwordx4 a[152:155], v42, s[24:27], s71 offen offset:2048 sc1
    s_waitcnt lgkmcnt(1)
    v_mfma_f32_32x32x16_bf16 a[16:31], v[124:127], v[76:79], a[16:31]
    ds_read_b128 v[84:87], v29 offset:4096
    buffer_load_dwordx4 a[156:159], v42, s[24:27], s71 offen offset:3072 sc1
    s_waitcnt vmcnt(12)
    v_mfma_f32_32x32x16_bf16 v[240:255], v[128:131], v[72:75], v[240:255]
    s_add_u32 s71, s71, s92
    buffer_load_dwordx4 a[160:163], v42, s[24:27], s71 offen offset:0 sc1
    v_mfma_f32_32x32x16_bf16 a[32:47], v[128:131], v[76:79], a[32:47]
    buffer_load_dwordx4 a[164:167], v42, s[24:27], s71 offen offset:1024 sc1
    s_waitcnt vmcnt(13)
    v_mfma_f32_32x32x16_bf16 a[0:15], v[132:135], v[72:75], a[0:15]
    buffer_load_dwordx4 a[168:171], v42, s[24:27], s71 offen offset:2048 sc1
    v_mfma_f32_32x32x16_bf16 a[48:63], v[132:135], v[76:79], a[48:63]
    buffer_load_dwordx4 a[172:175], v42, s[24:27], s71 offen offset:3072 sc1
    s_waitcnt vmcnt(14) lgkmcnt(1)
    v_mfma_f32_32x32x16_bf16 v[224:239], v[112:115], v[80:83], v[224:239]
    s_add_u32 s71, s71, 4096
    buffer_load_dwordx4 a[176:179], v42, s[24:27], s71 offen offset:0 sc1
    s_waitcnt lgkmcnt(0)
    v_mfma_f32_32x32x16_bf16 a[16:31], v[112:115], v[84:87], a[16:31]
    buffer_load_dwordx4 a[180:183], v42, s[24:27], s71 offen offset:1024 sc1
    s_waitcnt vmcnt(15)
    v_mfma_f32_32x32x16_bf16 v[240:255], v[116:119], v[80:83], v[240:255]
    buffer_load_dwordx4 a[184:187], v42, s[24:27], s71 offen offset:2048 sc1
    v_mfma_f32_32x32x16_bf16 a[32:47], v[116:119], v[84:87], a[32:47]
    buffer_load_dwordx4 a[188:191], v42, s[24:27], s71 offen offset:3072 sc1
    s_waitcnt vmcnt(16)
    v_mfma_f32_32x32x16_bf16 a[0:15], v[120:123], v[80:83], a[0:15]
    v_mfma_f32_32x32x16_bf16 a[48:63], v[120:123], v[84:87], a[48:63]
L_s2_join_13:
    v_add_u32 v18, s58, v42
    v_add_u32 v19, 65536, v18
    v_bfe_u32 v5, v1, 4, 2
    v_lshlrev_b32 v5, 1, v5
    v_and_b32 v6, 7, v1
    v_xor_b32_e64 v5, v5, v6
    v_bfe_u32 v4, v1, 3, 3
    v_lshlrev_b32_e64 v4, 10, v4
    v_lshl_add_u32 v4, v5, 4, v4
    s_lshl_b32 s76, s88, 7
    s_lshl_b32 s81, s3, 16
    s_add_u32 s76, s76, s81
    v_add_u32 v46, s76, v4
    s_lshl_b32 s76, s88, 7
    s_lshl_b32 s81, s3, 13
    s_add_u32 s76, s76, s81
    v_add_u32 v47, s76, v4
    s_lshl_b32 s73, s3, 10
    ds_write_b128 v18, a[16:19] offset:32768
    s_mul_i32 s76, s6, 98304
    s_mul_i32 s81, s4, 49152
    s_add_u32 s76, s76, s81
    s_mul_i32 s81, s7, 3072
    s_add_u32 s76, s76, s81
    s_mul_i32 s81, s5, 1536
    s_add_u32 s76, s76, s81
    ds_write_b128 v18, a[20:23] offset:33792
    s_add_u32 s76, s76, 3145728
    v_bfe_u32 v23, v1, 4, 1
    v_mul_u32_u24 v23, 24576, v23
    v_bfe_u32 v2, v1, 5, 1
    v_lshl_add_u32 v23, v2, 8, v23
    v_bfe_u32 v2, v1, 0, 4
    v_lshl_add_u32 v23, v2, 4, v23
    ds_write_b128 v18, a[24:27] offset:34816
    v_add_u32_e64 v23, s76, v23
    v_xor_b32 v20, 8192, v18
    v_xor_b32 v21, 16384, v18
    v_add_u32 v21, 32768, v21
    v_xor_b32 v22, 24576, v18
    v_add_u32 v22, 65536, v22
    v_lshlrev_b32_e64 v112, 16, v152
    ds_write_b128 v18, a[28:31] offset:35840
    v_and_b32_e64 v113, s62, v152
    v_pk_add_f32 v[224:225], v[224:225], v[30:31] op_sel_hi:[1,0]
    v_lshlrev_b32 v114, 16, v153
    v_and_b32 v115, s62, v153
    v_pk_add_f32 v[226:227], v[226:227], v[30:31] op_sel_hi:[1,0]
    v_lshlrev_b32 v116, 16, v154
    v_and_b32 v117, s62, v154
    ds_write_b128 v18, a[32:35] offset:36864
    v_pk_add_f32 v[228:229], v[228:229], v[30:31] op_sel_hi:[1,0]
    v_lshlrev_b32 v118, 16, v155
    v_and_b32 v119, s62, v155
    v_pk_add_f32 v[230:231], v[230:231], v[30:31] op_sel_hi:[1,0]
    v_lshlrev_b32 v120, 16, v156
    v_and_b32 v121, s62, v156
    v_pk_add_f32 v[232:233], v[232:233], v[30:31] op_sel_hi:[1,0]
    ds_write_b128 v18, a[36:39] offset:37888
    v_lshlrev_b32 v122, 16, v157
    v_and_b32 v123, s62, v157
    v_pk_add_f32 v[234:235], v[234:235], v[30:31] op_sel_hi:[1,0]
    v_lshlrev_b32 v124, 16, v158
    v_and_b32 v125, s62, v158
    v_pk_add_f32 v[236:237], v[236:237], v[30:31] op_sel_hi:[1,0]
    v_lshlrev_b32_e64 v126, 16, v159
    ds_write_b128 v19, a[40:43] offset:0
    v_and_b32_e64 v127, s62, v159
    v_pk_add_f32 v[238:239], v[238:239], v[30:31] op_sel_hi:[1,0]
    v_lshlrev_b32 v128, 16, v160
    v_and_b32 v129, s62, v160
    v_pk_add_f32 v[240:241], v[240:241], v[30:31] op_sel_hi:[1,0]
    v_lshlrev_b32 v130, 16, v161
    v_and_b32 v131, s62, v161
    s_mov_b32 s82, 0
    s_add_u32 m0, s58, 98304
    s_nop 0
    buffer_load_dwordx4 v46, s[28:31], s82 offen offset:0 lds
    ds_write_b128 v19, a[44:47] offset:1024
    v_pk_add_f32 v[242:243], v[242:243], v[30:31] op_sel_hi:[1,0]
    v_lshlrev_b32 v132, 16, v162
    v_and_b32 v133, s62, v162
    v_pk_add_f32 v[244:245], v[244:245], v[30:31] op_sel_hi:[1,0]
    v_lshlrev_b32 v134, 16, v163
    v_and_b32 v135, s62, v163
    v_pk_add_f32 v[246:247], v[246:247], v[30:31] op_sel_hi:[1,0]
    s_mov_b32 s82, 7168
    buffer_load_dwordx4 v46, s[28:31], s82 offen offset:1024 lds
    ds_write_b128 v19, a[48:51] offset:2048
    s_lshl_b32 s76, s70, 15
    s_add_u32 s76, s76, 98304
    v_bfe_u32 v24, v1, 5, 1
    v_lshlrev_b32 v24, 11, v24
    v_bfe_u32 v2, v1, 4, 1
    v_mul_u32_u24 v2, 576, v2
    v_add_u32_e64 v24, v24, v2
    s_mov_b32 s82, 14336
    buffer_load_dwordx4 v46, s[28:31], s82 offen offset:2048 lds
    ds_write_b128 v19, a[52:55] offset:3072
    v_bfe_u32 v2, v1, 2, 2
    v_lshl_add_u32 v24, v2, 7, v24
    v_bfe_u32 v2, v1, 3, 1
    v_lshl_add_u32 v24, v2, 5, v24
    v_bfe_u32 v2, v1, 0, 2
    v_lshl_add_u32 v24, v2, 3, v24
    v_add_u32_e64 v24, s76, v24
    s_mov_b32 s82, 21504
    buffer_load_dwordx4 v46, s[28:31], s82 offen offset:3072 lds
    ds_write_b128 v19, a[56:59] offset:4096
    v_xor_b32 v25, 32, v24
    v_xor_b32 v26, 64, v24
    v_xor_b32 v27, 96, v24
    s_mul_i32 s72, s6, 98304
    s_mul_i32 s81, s3, 24576
    s_add_u32 s72, s72, s81
    s_mul_i32 s81, s70, 11264
    s_mov_b32 s82, 32768
    s_add_u32 m0, s58, 102400
    s_nop 0
    buffer_load_dwordx4 v46, s[28:31], s82 offen offset:0 lds
    ds_write_b128 v19, a[60:63] offset:5120
    s_add_u32 s72, s72, s81
    s_add_u32 s72, s72, 3147776
    v_mov_b32 v28, 0xbfb8aa3b
    v_lshlrev_b32 v72, 16, v10
    v_and_b32 v73, s62, v10
    v_lshlrev_b32 v74, 16, v11
    v_and_b32_e64 v75, s62, v11
    s_mov_b32 s82, 39936
    buffer_load_dwordx4 v46, s[28:31], s82 offen offset:1024 lds
    ds_write_b128 v18, v[248:251] offset:0
    v_lshlrev_b32 v76, 16, v12
    v_and_b32 v77, s62, v12
    v_lshlrev_b32 v78, 16, v13
    v_and_b32 v79, s62, v13
    v_lshlrev_b32 v80, 16, v14
    v_and_b32 v81, s62, v14
    v_lshlrev_b32_e64 v82, 16, v15
    s_mov_b32 s82, 47104
    buffer_load_dwordx4 v46, s[28:31], s82 offen offset:2048 lds
    ds_write_b128 v18, v[252:255] offset:1024
    v_and_b32 v83, s62, v15
    v_lshlrev_b32 v84, 16, v16
    v_and_b32 v85, s62, v16
    v_lshlrev_b32 v86, 16, v17
    v_and_b32 v87, s62, v17
    s_lshl_b32 s77, s3, 11
    s_add_u32 s77, s77, 90112
    s_mov_b32 s82, 54272
    buffer_load_dwordx4 v46, s[28:31], s82 offen offset:3072 lds
    ds_write_b128 v18, a[0:3] offset:2048
    v_and_b32_e64 v6, 7, v1
    v_bfe_u32 v5, v1, 5, 1
    v_lshlrev_b32 v5, 0, v5
    v_xor_b32 v5, v5, v6
    v_bfe_u32 v32, v1, 0, 4
    v_lshlrev_b32 v32, 7, v32
    v_bfe_u32 v2, v1, 4, 1
    s_mov_b32 s82, 262144
    s_add_u32 m0, s58, 131072
    s_nop 0
    buffer_load_dwordx4 v46, s[28:31], s82 offen offset:0 lds
    ds_write_b128 v18, a[4:7] offset:3072
    v_lshl_add_u32 v32, v2, 3, v32
    v_add_u32_e64 v32, s77, v32
    v_lshl_add_u32 v32, v5, 4, v32
    v_bfe_u32 v4, v1, 3, 3
    v_lshlrev_b32 v4, 0, v4
    v_xor_b32 v5, v4, v6
    v_lshl_add_u32 v33, v4, 7, s77
    s_mov_b32 s82, 269312
    buffer_load_dwordx4 v46, s[28:31], s82 offen offset:1024 lds
    ds_write_b128 v18, a[8:11] offset:4096
    v_lshl_add_u32 v33, v5, 4, v33
    v_lshlrev_b32_e64 v4, 10, v4
    v_lshl_add_u32 v34, v6, 4, v4
    v_xor_b32_e64 v35, 32, v32
    v_xor_b32 v36, 64, v32
    v_xor_b32 v37, 96, v32
    v_subrev_u32 v43, 65536, v43
    s_mov_b32 s82, 276480
    buffer_load_dwordx4 v46, s[28:31], s82 offen offset:2048 lds
    ds_write_b128 v18, a[12:15] offset:5120
    s_mov_b32 s82, 283648
    buffer_load_dwordx4 v46, s[28:31], s82 offen offset:3072 lds
    s_cmp_eq_u32 s5, 0
    s_mov_b32 s78, 512
    s_cmov_b32 s78, 0
    s_mov_b32 s79, 1024
    s_cmov_b32 s79, 512
    s_mov_b32 s80, 0
    s_cmov_b32 s80, 1024
    s_waitcnt lgkmcnt(0)
    s_barrier
    ds_read_b128 v[212:215], v20 offset:2048
    ds_read_b128 v[216:219], v21 offset:0
    ds_read_b128 v[220:223], v22 offset:2048
    ds_read_b128 v[200:203], v20 offset:3072
    ds_read_b128 v[204:207], v21 offset:1024
    ds_read_b128 v[208:211], v22 offset:3072
    ds_read_b128 v[188:191], v20 offset:4096
    ds_read_b128 v[192:195], v21 offset:2048
    ds_read_b128 v[196:199], v22 offset:4096
    ds_read_b128 v[176:179], v20 offset:5120
    ds_read_b128 v[180:183], v21 offset:3072
    ds_read_b128 v[184:187], v22 offset:5120
    ds_read_b128 v[164:167], v20 offset:0
    ds_read_b128 v[168:171], v21 offset:4096
    ds_read_b128 v[172:175], v22 offset:0
    ds_read_b128 v[152:155], v20 offset:1024
    ds_read_b128 v[156:159], v21 offset:5120
    ds_read_b128 v[160:163], v22 offset:1024
    s_mov_b32 s82, 294912
    s_add_u32 m0, s58, 135168
    s_nop 0
    buffer_load_dwordx4 v46, s[28:31], s82 offen offset:0 lds
    s_mov_b32 s82, 302080
    buffer_load_dwordx4 v46, s[28:31], s82 offen offset:1024 lds
    s_mov_b32 s82, 309248
    buffer_load_dwordx4 v46, s[28:31], s82 offen offset:2048 lds
    s_mov_b32 s82, 316416
    buffer_load_dwordx4 v46, s[28:31], s82 offen offset:3072 lds
    s_waitcnt lgkmcnt(15)
    v_pk_add_f32 v[224:225], v[224:225], v[212:213]
    v_pk_add_f32 v[216:217], v[216:217], v[220:221]
    v_pk_add_f32 v[226:227], v[226:227], v[214:215]
    v_pk_add_f32 v[218:219], v[218:219], v[222:223]
    v_pk_add_f32 v[224:225], v[224:225], v[216:217]
    v_pk_add_f32 v[226:227], v[226:227], v[218:219]
    v_pk_mul_f32 v[224:225], v[224:225], v[112:113]
    v_pk_mul_f32 v[226:227], v[226:227], v[114:115]
    v_cvt_pk_bf16_f32 v140, v224, v225
    v_cvt_pk_bf16_f32 v141, v226, v227
    s_waitcnt lgkmcnt(14)
    v_pk_add_f32 v[228:229], v[228:229], v[200:201]
    s_waitcnt lgkmcnt(12)
    v_pk_add_f32 v[204:205], v[204:205], v[208:209]
    v_pk_add_f32 v[230:231], v[230:231], v[202:203]
    v_pk_add_f32 v[206:207], v[206:207], v[210:211]
    v_pk_add_f32 v[228:229], v[228:229], v[204:205]
    v_pk_add_f32 v[230:231], v[230:231], v[206:207]
    v_pk_mul_f32 v[228:229], v[228:229], v[116:117]
    v_pk_mul_f32 v[230:231], v[230:231], v[118:119]
    v_cvt_pk_bf16_f32 v142, v228, v229
    v_cvt_pk_bf16_f32 v143, v230, v231
    buffer_store_dwordx4 v[140:143], v23, s[24:27], s78 offen sc1
    s_waitcnt lgkmcnt(11)
    v_pk_add_f32 v[232:233], v[232:233], v[188:189]
    s_waitcnt lgkmcnt(9)
    v_pk_add_f32 v[192:193], v[192:193], v[196:197]
    v_pk_add_f32 v[234:235], v[234:235], v[190:191]
    v_pk_add_f32 v[194:195], v[194:195], v[198:199]
    v_pk_add_f32 v[232:233], v[232:233], v[192:193]
    v_pk_add_f32 v[234:235], v[234:235], v[194:195]
    v_pk_mul_f32 v[232:233], v[232:233], v[120:121]
    v_pk_mul_f32 v[234:235], v[234:235], v[122:123]
    v_cvt_pk_bf16_f32 v144, v232, v233
    v_cvt_pk_bf16_f32 v145, v234, v235
    s_waitcnt lgkmcnt(8)
    v_pk_add_f32 v[236:237], v[236:237], v[176:177]
    s_waitcnt lgkmcnt(6)
    v_pk_add_f32 v[180:181], v[180:181], v[184:185]
    v_pk_add_f32 v[238:239], v[238:239], v[178:179]
    v_pk_add_f32 v[182:183], v[182:183], v[186:187]
    v_pk_add_f32 v[236:237], v[236:237], v[180:181]
    v_pk_add_f32 v[238:239], v[238:239], v[182:183]
    v_pk_mul_f32 v[236:237], v[236:237], v[124:125]
    v_pk_mul_f32 v[238:239], v[238:239], v[126:127]
    v_cvt_pk_bf16_f32 v146, v236, v237
    v_cvt_pk_bf16_f32 v147, v238, v239
    buffer_store_dwordx4 v[144:147], v23, s[24:27], s79 offen sc1
    s_waitcnt lgkmcnt(5)
    v_pk_add_f32 v[240:241], v[240:241], v[164:165]
    s_waitcnt lgkmcnt(3)
    v_pk_add_f32 v[168:169], v[168:169], v[172:173]
    v_pk_add_f32 v[242:243], v[242:243], v[166:167]
    v_pk_add_f32 v[170:171], v[170:171], v[174:175]
    v_pk_add_f32 v[240:241], v[240:241], v[168:169]
    v_pk_add_f32 v[242:243], v[242:243], v[170:171]
    v_pk_mul_f32 v[240:241], v[240:241], v[128:129]
    v_pk_mul_f32 v[242:243], v[242:243], v[130:131]
    v_cvt_pk_bf16_f32 v148, v240, v241
    v_cvt_pk_bf16_f32 v149, v242, v243
    s_waitcnt lgkmcnt(2)
    v_pk_add_f32 v[244:245], v[244:245], v[152:153]
    s_waitcnt lgkmcnt(0)
    v_pk_add_f32 v[156:157], v[156:157], v[160:161]
    v_pk_add_f32 v[246:247], v[246:247], v[154:155]
    v_pk_add_f32 v[158:159], v[158:159], v[162:163]
    v_pk_add_f32 v[244:245], v[244:245], v[156:157]
    v_pk_add_f32 v[246:247], v[246:247], v[158:159]
    v_pk_mul_f32 v[244:245], v[244:245], v[132:133]
    v_pk_mul_f32 v[246:247], v[246:247], v[134:135]
    v_cvt_pk_bf16_f32 v150, v244, v245
    v_cvt_pk_bf16_f32 v151, v246, v247
    buffer_store_dwordx4 v[148:151], v23, s[24:27], s80 offen sc1
    s_barrier
    s_add_u32 m0, s73, 0
    v_subrev_u32 v46, 16384, v47
    buffer_load_dwordx4 v46, s[32:35], 0 offen lds
    s_add_u32 m0, s73, 4096
    s_mov_b32 s82, 16384
    buffer_load_dwordx4 v47, s[32:35], s82 offen lds
    s_add_u32 m0, s73, 8192
    s_mov_b32 s82, 49152
    buffer_load_dwordx4 v47, s[32:35], s82 offen lds
    s_add_u32 m0, s73, 12288
    s_mov_b32 s82, 81920
    buffer_load_dwordx4 v47, s[32:35], s82 offen lds
    s_add_u32 m0, s73, 16384
    s_mov_b32 s82, 114688
    buffer_load_dwordx4 v47, s[32:35], s82 offen lds
    s_add_u32 m0, s73, 20480
    s_mov_b32 s82, 147456
    buffer_load_dwordx4 v47, s[32:35], s82 offen lds
    s_mul_i32 s80, s70, 77824
    s_sub_u32 s80, s80, 131072
    s_waitcnt vmcnt(9)
    s_waitcnt vmcnt(6)
    s_barrier
    s_cmp_lg_u32 s3, 0
    s_cbranch_scc1 L_w0_34
    s_lshl_b32 s76, s6, 11
    s_lshl_b32 s81, s7, 8
    s_add_u32 s76, s76, s81
    s_add_u32 s76, s76, 13139968
    v_mov_b32_e64 v8, s76
    v_mov_b32 v9, s83
    s_mov_b64 exec, 1
    buffer_store_dword v9, v8, s[24:27], 0 offen offset:128
    buffer_store_dword v9, v8, s[24:27], 0 offen sc1
    s_mov_b64 exec, -1
L_w0_34:
    ds_read_b64_tr_b16 v[224:225], v24 offset:0
    ds_read_b64_tr_b16 v[226:227], v24 offset:1024
    ds_read_b64_tr_b16 v[228:229], v25 offset:0
    ds_read_b64_tr_b16 v[230:231], v25 offset:1024
    ds_read_b64_tr_b16 v[232:233], v26 offset:0
    ds_read_b64_tr_b16 v[234:235], v26 offset:1024
    ds_read_b64_tr_b16 v[236:237], v27 offset:0
    ds_read_b64_tr_b16 v[238:239], v27 offset:1024
    s_waitcnt lgkmcnt(6)
    v_mfma_f32_16x16x32_bf16 v[208:211], v[224:227], a[128:131], 0
    s_add_u32 m0, s73, 24576
    s_mov_b32 s82, 180224
    ds_read_b64_tr_b16 v[240:241], v24 offset:4096
    buffer_load_dwordx4 v47, s[32:35], s82 offen lds
    ds_read_b64_tr_b16 v[242:243], v24 offset:5120
    s_waitcnt lgkmcnt(6)
    v_mfma_f32_16x16x32_bf16 v[212:215], v[228:231], a[128:131], 0
    ds_read_b64_tr_b16 v[244:245], v25 offset:4096
    ds_read_b64_tr_b16 v[246:247], v25 offset:5120
    s_waitcnt lgkmcnt(6)
    v_mfma_f32_16x16x32_bf16 v[216:219], v[232:235], a[128:131], 0
    s_add_u32 m0, s73, 28672
    s_mov_b32 s82, 212992
    ds_read_b64_tr_b16 v[248:249], v26 offset:4096
    buffer_load_dwordx4 v47, s[32:35], s82 offen lds
    ds_read_b64_tr_b16 v[250:251], v26 offset:5120
    s_waitcnt lgkmcnt(6)
    v_mfma_f32_16x16x32_bf16 v[220:223], v[236:239], a[128:131], 0
    ds_read_b64_tr_b16 v[252:253], v27 offset:4096
    ds_read_b64_tr_b16 v[254:255], v27 offset:5120
    s_waitcnt lgkmcnt(6)
    v_mfma_f32_16x16x32_bf16 v[208:211], v[240:243], a[132:135], v[208:211]
    s_add_u32 m0, s73, 32768
    s_mov_b32 s82, 245760
    ds_read_b64_tr_b16 v[224:225], v24 offset:8192
    buffer_load_dwordx4 v47, s[32:35], s82 offen lds
    ds_read_b64_tr_b16 v[226:227], v24 offset:9216
    s_waitcnt lgkmcnt(6)
    v_mfma_f32_16x16x32_bf16 v[212:215], v[244:247], a[132:135], v[212:215]
    ds_read_b64_tr_b16 v[228:229], v25 offset:8192
    ds_read_b64_tr_b16 v[230:231], v25 offset:9216
    s_waitcnt lgkmcnt(6)
    v_mfma_f32_16x16x32_bf16 v[216:219], v[248:251], a[132:135], v[216:219]
    s_add_u32 m0, s73, 36864
    s_mov_b32 s82, 278528
    ds_read_b64_tr_b16 v[232:233], v26 offset:8192
    buffer_load_dwordx4 v47, s[32:35], s82 offen lds
    ds_read_b64_tr_b16 v[234:235], v26 offset:9216
    s_waitcnt lgkmcnt(6)
    v_mfma_f32_16x16x32_bf16 v[220:223], v[252:255], a[132:135], v[220:223]
    ds_read_b64_tr_b16 v[236:237], v27 offset:8192
    ds_read_b64_tr_b16 v[238:239], v27 offset:9216
    s_waitcnt lgkmcnt(6)
    v_mfma_f32_16x16x32_bf16 v[208:211], v[224:227], a[136:139], v[208:211]
    s_add_u32 m0, s73, 40960
    s_mov_b32 s82, 311296
    ds_read_b64_tr_b16 v[240:241], v24 offset:12288
    buffer_load_dwordx4 v47, s[32:35], s82 offen lds
    ds_read_b64_tr_b16 v[242:243], v24 offset:13312
    s_waitcnt lgkmcnt(6)
    v_mfma_f32_16x16x32_bf16 v[212:215], v[228:231], a[136:139], v[212:215]
    ds_read_b64_tr_b16 v[244:245], v25 offset:12288
    ds_read_b64_tr_b16 v[246:247], v25 offset:13312
    s_waitcnt lgkmcnt(6)
    v_mfma_f32_16x16x32_bf16 v[216:219], v[232:235], a[136:139], v[216:219]
    s_add_u32 m0, s73, 45056
    s_mov_b32 s82, 344064
    ds_read_b64_tr_b16 v[248:249], v26 offset:12288
    buffer_load_dwordx4 v47, s[32:35], s82 offen lds
    ds_read_b64_tr_b16 v[250:251], v26 offset:13312
    s_waitcnt lgkmcnt(6)
    v_mfma_f32_16x16x32_bf16 v[220:223], v[236:239], a[136:139], v[220:223]
    ds_read_b64_tr_b16 v[252:253], v27 offset:12288
    ds_read_b64_tr_b16 v[254:255], v27 offset:13312
    s_waitcnt lgkmcnt(6)
    v_mfma_f32_16x16x32_bf16 v[208:211], v[240:243], a[140:143], v[208:211]
    s_add_u32 m0, s73, 49152
    s_mov_b32 s82, 376832
    ds_read_b64_tr_b16 v[224:225], v24 offset:16384
    buffer_load_dwordx4 v47, s[32:35], s82 offen lds
    ds_read_b64_tr_b16 v[226:227], v24 offset:17408
    s_waitcnt lgkmcnt(6)
    v_mfma_f32_16x16x32_bf16 v[212:215], v[244:247], a[140:143], v[212:215]
    ds_read_b64_tr_b16 v[228:229], v25 offset:16384
    ds_read_b64_tr_b16 v[230:231], v25 offset:17408
    s_waitcnt lgkmcnt(6)
    v_mfma_f32_16x16x32_bf16 v[216:219], v[248:251], a[140:143], v[216:219]
    s_add_u32 m0, s73, 53248
    s_mov_b32 s82, 409600
    ds_read_b64_tr_b16 v[232:233], v26 offset:16384
    buffer_load_dwordx4 v47, s[32:35], s82 offen lds
    ds_read_b64_tr_b16 v[234:235], v26 offset:17408
    s_waitcnt lgkmcnt(6)
    v_mfma_f32_16x16x32_bf16 v[220:223], v[252:255], a[140:143], v[220:223]
    ds_read_b64_tr_b16 v[236:237], v27 offset:16384
    ds_read_b64_tr_b16 v[238:239], v27 offset:17408
    s_waitcnt lgkmcnt(6)
    v_mfma_f32_16x16x32_bf16 v[208:211], v[224:227], a[144:147], v[208:211]
    s_add_u32 m0, s73, 57344
    s_mov_b32 s82, 442368
    ds_read_b64_tr_b16 v[240:241], v24 offset:20480
    buffer_load_dwordx4 v47, s[32:35], s82 offen lds
    ds_read_b64_tr_b16 v[242:243], v24 offset:21504
    s_waitcnt lgkmcnt(6)
    v_mfma_f32_16x16x32_bf16 v[212:215], v[228:231], a[144:147], v[212:215]
    ds_read_b64_tr_b16 v[244:245], v25 offset:20480
    ds_read_b64_tr_b16 v[246:247], v25 offset:21504
    s_waitcnt lgkmcnt(6)
    v_mfma_f32_16x16x32_bf16 v[216:219], v[232:235], a[144:147], v[216:219]
    s_add_u32 m0, s73, 61440
    s_mov_b32 s82, 475136
    ds_read_b64_tr_b16 v[248:249], v26 offset:20480
    buffer_load_dwordx4 v47, s[32:35], s82 offen lds
    ds_read_b64_tr_b16 v[250:251], v26 offset:21504
    s_waitcnt lgkmcnt(6)
    v_mfma_f32_16x16x32_bf16 v[220:223], v[236:239], a[144:147], v[220:223]
    ds_read_b64_tr_b16 v[252:253], v27 offset:20480
    ds_read_b64_tr_b16 v[254:255], v27 offset:21504
    s_waitcnt lgkmcnt(6)
    v_mfma_f32_16x16x32_bf16 v[208:211], v[240:243], a[148:151], v[208:211]
    s_add_u32 m0, s73, 65536
    s_mov_b32 s82, 507904
    ds_read_b64_tr_b16 v[224:225], v24 offset:24576
    buffer_load_dwordx4 v47, s[32:35], s82 offen lds
    ds_read_b64_tr_b16 v[226:227], v24 offset:25600
    s_waitcnt lgkmcnt(6)
    v_mfma_f32_16x16x32_bf16 v[212:215], v[244:247], a[148:151], v[212:215]
    ds_read_b64_tr_b16 v[228:229], v25 offset:24576
    ds_read_b64_tr_b16 v[230:231], v25 offset:25600
    s_waitcnt lgkmcnt(6)
    v_mfma_f32_16x16x32_bf16 v[216:219], v[248:251], a[148:151], v[216:219]
    s_add_u32 m0, s73, 69632
    s_mov_b32 s82, 540672
    ds_read_b64_tr_b16 v[232:233], v26 offset:24576
    buffer_load_dwordx4 v47, s[32:35], s82 offen lds
    ds_read_b64_tr_b16 v[234:235], v26 offset:25600
    s_waitcnt lgkmcnt(6)
    v_mfma_f32_16x16x32_bf16 v[220:223], v[252:255], a[148:151], v[220:223]
    ds_read_b64_tr_b16 v[236:237], v27 offset:24576
    ds_read_b64_tr_b16 v[238:239], v27 offset:25600
    buffer_load_dword v44, v43, s[24:27], 0 offen sc1
    s_waitcnt lgkmcnt(6)
    v_mfma_f32_16x16x32_bf16 v[208:211], v[224:227], a[152:155], v[208:211]
    s_add_u32 m0, s73, 73728
    s_mov_b32 s82, 573440
    ds_read_b64_tr_b16 v[240:241], v24 offset:28672
    buffer_load_dwordx4 v47, s[32:35], s82 offen lds
    ds_read_b64_tr_b16 v[242:243], v24 offset:29696
    s_waitcnt lgkmcnt(6)
    v_mfma_f32_16x16x32_bf16 v[212:215], v[228:231], a[152:155], v[212:215]
    ds_read_b64_tr_b16 v[244:245], v25 offset:28672
    ds_read_b64_tr_b16 v[246:247], v25 offset:29696
    s_waitcnt lgkmcnt(6)
    v_mfma_f32_16x16x32_bf16 v[216:219], v[232:235], a[152:155], v[216:219]
    s_add_u32 m0, s73, 77824
    s_mov_b32 s82, 606208
    ds_read_b64_tr_b16 v[248:249], v26 offset:28672
    buffer_load_dwordx4 v47, s[32:35], s82 offen lds
    ds_read_b64_tr_b16 v[250:251], v26 offset:29696
    s_waitcnt lgkmcnt(6)
    v_mfma_f32_16x16x32_bf16 v[220:223], v[236:239], a[152:155], v[220:223]
    ds_read_b64_tr_b16 v[252:253], v27 offset:28672
    ds_read_b64_tr_b16 v[254:255], v27 offset:29696
    v_add_u32 v24, s95, v24
    v_add_u32 v25, s95, v25
    v_add_u32 v26, s95, v26
    v_add_u32 v27, s95, v27
    s_waitcnt lgkmcnt(6)
    v_mfma_f32_16x16x32_bf16 v[208:211], v[240:243], a[156:159], v[208:211]
    s_add_u32 m0, s73, 81920
    s_mov_b32 s82, 638976
    ds_read_b64_tr_b16 v[224:225], v24 offset:0
    buffer_load_dwordx4 v47, s[32:35], s82 offen lds
    ds_read_b64_tr_b16 v[226:227], v24 offset:1024
    s_waitcnt lgkmcnt(6)
    v_mfma_f32_16x16x32_bf16 v[212:215], v[244:247], a[156:159], v[212:215]
    ds_read_b64_tr_b16 v[228:229], v25 offset:0
    ds_read_b64_tr_b16 v[230:231], v25 offset:1024
    s_waitcnt lgkmcnt(6)
    v_mfma_f32_16x16x32_bf16 v[216:219], v[248:251], a[156:159], v[216:219]
    s_add_u32 m0, s73, 86016
    s_mov_b32 s82, 671744
    ds_read_b64_tr_b16 v[232:233], v26 offset:0
    buffer_load_dwordx4 v47, s[32:35], s82 offen lds
    ds_read_b64_tr_b16 v[234:235], v26 offset:1024
    s_waitcnt lgkmcnt(6)
    v_mfma_f32_16x16x32_bf16 v[220:223], v[252:255], a[156:159], v[220:223]
    ds_read_b64_tr_b16 v[236:237], v27 offset:0
    ds_read_b64_tr_b16 v[238:239], v27 offset:1024
    s_waitcnt lgkmcnt(6)
    v_mfma_f32_16x16x32_bf16 v[208:211], v[224:227], a[160:163], v[208:211]
    ds_read_b64_tr_b16 v[240:241], v24 offset:4096
    ds_read_b64_tr_b16 v[242:243], v24 offset:5120
    s_waitcnt lgkmcnt(6)
    v_mfma_f32_16x16x32_bf16 v[212:215], v[228:231], a[160:163], v[212:215]
    ds_read_b64_tr_b16 v[244:245], v25 offset:4096
    ds_read_b64_tr_b16 v[246:247], v25 offset:5120
    s_waitcnt lgkmcnt(6)
    v_mfma_f32_16x16x32_bf16 v[216:219], v[232:235], a[160:163], v[216:219]
    ds_read_b64_tr_b16 v[248:249], v26 offset:4096
    ds_read_b64_tr_b16 v[250:251], v26 offset:5120
    s_waitcnt lgkmcnt(6)
    v_mfma_f32_16x16x32_bf16 v[220:223], v[236:239], a[160:163], v[220:223]
    ds_read_b64_tr_b16 v[252:253], v27 offset:4096
    ds_read_b64_tr_b16 v[254:255], v27 offset:5120
    s_waitcnt lgkmcnt(6)
    v_mfma_f32_16x16x32_bf16 v[208:211], v[240:243], a[164:167], v[208:211]
    ds_read_b64_tr_b16 v[224:225], v24 offset:8192
    ds_read_b64_tr_b16 v[226:227], v24 offset:9216
    s_waitcnt lgkmcnt(6)
    v_mfma_f32_16x16x32_bf16 v[212:215], v[244:247], a[164:167], v[212:215]
    ds_read_b64_tr_b16 v[228:229], v25 offset:8192
    ds_read_b64_tr_b16 v[230:231], v25 offset:9216
    s_waitcnt lgkmcnt(6)
    v_mfma_f32_16x16x32_bf16 v[216:219], v[248:251], a[164:167], v[216:219]
    ds_read_b64_tr_b16 v[232:233], v26 offset:8192
    ds_read_b64_tr_b16 v[234:235], v26 offset:9216
    s_waitcnt lgkmcnt(6)
    v_mfma_f32_16x16x32_bf16 v[220:223], v[252:255], a[164:167], v[220:223]
    ds_read_b64_tr_b16 v[236:237], v27 offset:8192
    ds_read_b64_tr_b16 v[238:239], v27 offset:9216
    s_waitcnt lgkmcnt(6)
    v_mfma_f32_16x16x32_bf16 v[208:211], v[224:227], a[168:171], v[208:211]
    ds_read_b64_tr_b16 v[240:241], v24 offset:12288
    ds_read_b64_tr_b16 v[242:243], v24 offset:13312
    s_waitcnt lgkmcnt(6)
    v_mfma_f32_16x16x32_bf16 v[212:215], v[228:231], a[168:171], v[212:215]
    ds_read_b64_tr_b16 v[244:245], v25 offset:12288
    ds_read_b64_tr_b16 v[246:247], v25 offset:13312
    s_waitcnt lgkmcnt(6)
    v_mfma_f32_16x16x32_bf16 v[216:219], v[232:235], a[168:171], v[216:219]
    ds_read_b64_tr_b16 v[248:249], v26 offset:12288
    ds_read_b64_tr_b16 v[250:251], v26 offset:13312
    s_waitcnt lgkmcnt(6)
    v_mfma_f32_16x16x32_bf16 v[220:223], v[236:239], a[168:171], v[220:223]
    ds_read_b64_tr_b16 v[252:253], v27 offset:12288
    ds_read_b64_tr_b16 v[254:255], v27 offset:13312
    s_waitcnt lgkmcnt(6)
    v_mfma_f32_16x16x32_bf16 v[208:211], v[240:243], a[172:175], v[208:211]
    ds_read_b64_tr_b16 v[224:225], v24 offset:16384
    ds_read_b64_tr_b16 v[226:227], v24 offset:17408
    s_waitcnt lgkmcnt(6)
    v_mfma_f32_16x16x32_bf16 v[212:215], v[244:247], a[172:175], v[212:215]
    ds_read_b64_tr_b16 v[228:229], v25 offset:16384
    ds_read_b64_tr_b16 v[230:231], v25 offset:17408
    s_waitcnt lgkmcnt(6)
    v_mfma_f32_16x16x32_bf16 v[216:219], v[248:251], a[172:175], v[216:219]
    ds_read_b64_tr_b16 v[232:233], v26 offset:16384
    ds_read_b64_tr_b16 v[234:235], v26 offset:17408
    s_waitcnt lgkmcnt(6)
    v_mfma_f32_16x16x32_bf16 v[220:223], v[252:255], a[172:175], v[220:223]
    ds_read_b64_tr_b16 v[236:237], v27 offset:16384
    ds_read_b64_tr_b16 v[238:239], v27 offset:17408
    s_waitcnt vmcnt(4)
    v_cmp_eq_u32 vcc, s83, v44
    s_nop 3
    s_lshr_b32 s81, vcc_lo, 8
    s_or_b32 s81, s81, vcc_lo
    s_and_b32 s81, s81, 0xff
    s_cmp_eq_u32 s81, 0xff
    s_cbranch_scc0 L_slow_f4_35
L_back_f4_36:
    s_waitcnt lgkmcnt(6)
    v_mfma_f32_16x16x32_bf16 v[208:211], v[224:227], a[176:179], v[208:211]
    ds_read_b64_tr_b16 v[240:241], v24 offset:20480
    buffer_load_dwordx4 v[12:15], v42, s[24:27], s72 offen offset:0 sc1
    ds_read_b64_tr_b16 v[242:243], v24 offset:21504
    s_waitcnt lgkmcnt(6)
    v_mfma_f32_16x16x32_bf16 v[212:215], v[228:231], a[176:179], v[212:215]
    ds_read_b64_tr_b16 v[244:245], v25 offset:20480
    ds_read_b64_tr_b16 v[246:247], v25 offset:21504
    s_waitcnt lgkmcnt(6)
    v_mfma_f32_16x16x32_bf16 v[216:219], v[232:235], a[176:179], v[216:219]
    ds_read_b64_tr_b16 v[248:249], v26 offset:20480
    buffer_load_dwordx4 v[16:19], v42, s[24:27], s72 offen offset:1024 sc1
    ds_read_b64_tr_b16 v[250:251], v26 offset:21504
    s_waitcnt lgkmcnt(6)
    v_mfma_f32_16x16x32_bf16 v[220:223], v[236:239], a[176:179], v[220:223]
    ds_read_b64_tr_b16 v[252:253], v27 offset:20480
    ds_read_b64_tr_b16 v[254:255], v27 offset:21504
    s_waitcnt lgkmcnt(6)
    v_mfma_f32_16x16x32_bf16 v[208:211], v[240:243], a[180:183], v[208:211]
    ds_read_b64_tr_b16 v[224:225], v24 offset:24576
    buffer_load_dwordx4 v[20:23], v42, s[24:27], s72 offen offset:2048 sc1
    ds_read_b64_tr_b16 v[226:227], v24 offset:25600
    s_waitcnt lgkmcnt(6)
    v_mfma_f32_16x16x32_bf16 v[212:215], v[244:247], a[180:183], v[212:215]
    ds_read_b64_tr_b16 v[228:229], v25 offset:24576
    ds_read_b64_tr_b16 v[230:231], v25 offset:25600
    s_waitcnt lgkmcnt(6)
    v_mfma_f32_16x16x32_bf16 v[216:219], v[248:251], a[180:183], v[216:219]
    ds_read_b64_tr_b16 v[232:233], v26 offset:24576
    buffer_load_dwordx4 v[48:51], v42, s[24:27], s72 offen offset:3072 sc1
    ds_read_b64_tr_b16 v[234:235], v26 offset:25600
    s_waitcnt lgkmcnt(6)
    v_mfma_f32_16x16x32_bf16 v[220:223], v[252:255], a[180:183], v[220:223]
    ds_read_b64_tr_b16 v[236:237], v27 offset:24576
    ds_read_b64_tr_b16 v[238:239], v27 offset:25600
    s_waitcnt lgkmcnt(6)
    v_mfma_f32_16x16x32_bf16 v[208:211], v[224:227], a[184:187], v[208:211]
    s_add_u32 s72, s72, 4096
    ds_read_b64_tr_b16 v[240:241], v24 offset:28672
    buffer_load_dwordx4 v[52:55], v42, s[24:27], s72 offen offset:0 sc1
    ds_read_b64_tr_b16 v[242:243], v24 offset:29696
    s_waitcnt lgkmcnt(6)
    v_mfma_f32_16x16x32_bf16 v[212:215], v[228:231], a[184:187], v[212:215]
    ds_read_b64_tr_b16 v[244:245], v25 offset:28672
    ds_read_b64_tr_b16 v[246:247], v25 offset:29696
    s_waitcnt lgkmcnt(6)
    v_mfma_f32_16x16x32_bf16 v[216:219], v[232:235], a[184:187], v[216:219]
    ds_read_b64_tr_b16 v[248:249], v26 offset:28672
    buffer_load_dwordx4 v[56:59], v42, s[24:27], s72 offen offset:1024 sc1
    ds_read_b64_tr_b16 v[250:251], v26 offset:29696
    s_waitcnt lgkmcnt(6)
    v_mfma_f32_16x16x32_bf16 v[220:223], v[236:239], a[184:187], v[220:223]
    ds_read_b64_tr_b16 v[252:253], v27 offset:28672
    ds_read_b64_tr_b16 v[254:255], v27 offset:29696
    s_waitcnt vmcnt(6)
    s_barrier
    v_add_u32 v24, s80, v24
    v_add_u32 v25, s80, v25
    v_add_u32 v26, s80, v26
    v_add_u32_e64 v27, s80, v27
    s_waitcnt lgkmcnt(6)
    v_mfma_f32_16x16x32_bf16 v[208:211], v[240:243], a[188:191], v[208:211]
    ds_read_b64_tr_b16 v[224:225], v24 offset:0
    buffer_load_dwordx4 v[60:63], v42, s[24:27], s72 offen offset:2048 sc1
    ds_read_b64_tr_b16 v[226:227], v24 offset:1024
    s_waitcnt lgkmcnt(6)
    v_mfma_f32_16x16x32_bf16 v[212:215], v[244:247], a[188:191], v[212:215]
    ds_read_b64_tr_b16 v[228:229], v25 offset:0
    ds_read_b64_tr_b16 v[230:231], v25 offset:1024
    s_waitcnt lgkmcnt(6)
    v_mfma_f32_16x16x32_bf16 v[216:219], v[248:251], a[188:191], v[216:219]
    ds_read_b64_tr_b16 v[232:233], v26 offset:0
    buffer_load_dwordx4 v[64:67], v42, s[24:27], s72 offen offset:3072 sc1
    ds_read_b64_tr_b16 v[234:235], v26 offset:1024
    s_waitcnt lgkmcnt(6)
    v_mfma_f32_16x16x32_bf16 v[220:223], v[252:255], a[188:191], v[220:223]
    ds_read_b64_tr_b16 v[236:237], v27 offset:0
    ds_read_b64_tr_b16 v[238:239], v27 offset:1024
    s_add_u32 s72, s72, 4096
    buffer_load_dwordx4 v[68:71], v42, s[24:27], s72 offen offset:0 sc1
    buffer_load_dwordx4 v[88:91], v42, s[24:27], s72 offen offset:1024 sc1
    s_waitcnt vmcnt(9) lgkmcnt(6)
    v_mfma_f32_16x16x32_bf16 v[192:195], v[224:227], v[12:15], 0
    ds_read_b64_tr_b16 v[240:241], v24 offset:4096
    buffer_load_dwordx4 v[92:95], v42, s[24:27], s72 offen offset:2048 sc1
    ds_read_b64_tr_b16 v[242:243], v24 offset:5120
    s_waitcnt lgkmcnt(6)
    v_mfma_f32_16x16x32_bf16 v[196:199], v[228:231], v[12:15], 0
    ds_read_b64_tr_b16 v[244:245], v25 offset:4096
    ds_read_b64_tr_b16 v[246:247], v25 offset:5120
    s_waitcnt lgkmcnt(6)
    v_mfma_f32_16x16x32_bf16 v[200:203], v[232:235], v[12:15], 0
    s_add_u32 s72, s72, s93
    ds_read_b64_tr_b16 v[248:249], v26 offset:4096
    buffer_load_dwordx4 v[96:99], v42, s[24:27], s72 offen offset:0 sc1
    ds_read_b64_tr_b16 v[250:251], v26 offset:5120
    s_waitcnt lgkmcnt(6)
    v_mfma_f32_16x16x32_bf16 v[204:207], v[236:239], v[12:15], 0
    ds_read_b64_tr_b16 v[252:253], v27 offset:4096
    ds_read_b64_tr_b16 v[254:255], v27 offset:5120
    s_waitcnt vmcnt(10) lgkmcnt(6)
    v_mfma_f32_16x16x32_bf16 v[192:195], v[240:243], v[16:19], v[192:195]
    ds_read_b64_tr_b16 v[224:225], v24 offset:8192
    buffer_load_dwordx4 v[100:103], v42, s[24:27], s72 offen offset:1024 sc1
    ds_read_b64_tr_b16 v[226:227], v24 offset:9216
    s_waitcnt lgkmcnt(6)
    v_mfma_f32_16x16x32_bf16 v[196:199], v[244:247], v[16:19], v[196:199]
    ds_read_b64_tr_b16 v[228:229], v25 offset:8192
    ds_read_b64_tr_b16 v[230:231], v25 offset:9216
    s_waitcnt lgkmcnt(6)
    v_mfma_f32_16x16x32_bf16 v[200:203], v[248:251], v[16:19], v[200:203]
    ds_read_b64_tr_b16 v[232:233], v26 offset:8192
    buffer_load_dwordx4 v[104:107], v42, s[24:27], s72 offen offset:2048 sc1
    ds_read_b64_tr_b16 v[234:235], v26 offset:9216
    s_waitcnt lgkmcnt(6)
    v_mfma_f32_16x16x32_bf16 v[204:207], v[252:255], v[16:19], v[204:207]
    ds_read_b64_tr_b16 v[236:237], v27 offset:8192
    ds_read_b64_tr_b16 v[238:239], v27 offset:9216
    s_waitcnt vmcnt(11) lgkmcnt(6)
    v_mfma_f32_16x16x32_bf16 v[192:195], v[224:227], v[20:23], v[192:195]
    ds_read_b64_tr_b16 v[240:241], v24 offset:12288
    buffer_load_dwordx4 v[108:111], v42, s[24:27], s72 offen offset:3072 sc1
    ds_read_b64_tr_b16 v[242:243], v24 offset:13312
    s_waitcnt lgkmcnt(6)
    v_mfma_f32_16x16x32_bf16 v[196:199], v[228:231], v[20:23], v[196:199]
    ds_read_b64_tr_b16 v[244:245], v25 offset:12288
    ds_read_b64_tr_b16 v[246:247], v25 offset:13312
    s_waitcnt lgkmcnt(6)
    v_mfma_f32_16x16x32_bf16 v[200:203], v[232:235], v[20:23], v[200:203]
    s_add_u32 s72, s72, 4096
    ds_read_b64_tr_b16 v[248:249], v26 offset:12288
    buffer_load_dwordx4 v[112:115], v42, s[24:27], s72 offen offset:0 sc1
    ds_read_b64_tr_b16 v[250:251], v26 offset:13312
    s_waitcnt lgkmcnt(6)
    v_mfma_f32_16x16x32_bf16 v[204:207], v[236:239], v[20:23], v[204:207]
    ds_read_b64_tr_b16 v[252:253], v27 offset:12288
    ds_read_b64_tr_b16 v[254:255], v27 offset:13312
    s_waitcnt vmcnt(12) lgkmcnt(6)
    v_mfma_f32_16x16x32_bf16 v[192:195], v[240:243], v[48:51], v[192:195]
    ds_read_b64_tr_b16 v[224:225], v24 offset:16384
    buffer_load_dwordx4 v[116:119], v42, s[24:27], s72 offen offset:1024 sc1
    ds_read_b64_tr_b16 v[226:227], v24 offset:17408
    s_waitcnt lgkmcnt(6)
    v_mfma_f32_16x16x32_bf16 v[196:199], v[244:247], v[48:51], v[196:199]
    ds_read_b64_tr_b16 v[228:229], v25 offset:16384
    ds_read_b64_tr_b16 v[230:231], v25 offset:17408
    s_waitcnt lgkmcnt(6)
    v_mfma_f32_16x16x32_bf16 v[200:203], v[248:251], v[48:51], v[200:203]
    ds_read_b64_tr_b16 v[232:233], v26 offset:16384
    buffer_load_dwordx4 v[120:123], v42, s[24:27], s72 offen offset:2048 sc1
    ds_read_b64_tr_b16 v[234:235], v26 offset:17408
    s_waitcnt lgkmcnt(6)
    v_mfma_f32_16x16x32_bf16 v[204:207], v[252:255], v[48:51], v[204:207]
    ds_read_b64_tr_b16 v[236:237], v27 offset:16384
    ds_read_b64_tr_b16 v[238:239], v27 offset:17408
    s_waitcnt vmcnt(13) lgkmcnt(6)
    v_mfma_f32_16x16x32_bf16 v[192:195], v[224:227], v[52:55], v[192:195]
    ds_read_b64_tr_b16 v[240:241], v24 offset:20480
    buffer_load_dwordx4 v[124:127], v42, s[24:27], s72 offen offset:3072 sc1
    ds_read_b64_tr_b16 v[242:243], v24 offset:21504
    s_waitcnt lgkmcnt(6)
    v_mfma_f32_16x16x32_bf16 v[196:199], v[228:231], v[52:55], v[196:199]
    ds_read_b64_tr_b16 v[244:245], v25 offset:20480
    ds_read_b64_tr_b16 v[246:247], v25 offset:21504
    s_waitcnt lgkmcnt(6)
    v_mfma_f32_16x16x32_bf16 v[200:203], v[232:235], v[52:55], v[200:203]
    s_add_u32 s72, s72, 4096
    ds_read_b64_tr_b16 v[248:249], v26 offset:20480
    buffer_load_dwordx4 v[128:131], v42, s[24:27], s72 offen offset:0 sc1
    ds_read_b64_tr_b16 v[250:251], v26 offset:21504
    s_waitcnt lgkmcnt(6)
    v_mfma_f32_16x16x32_bf16 v[204:207], v[236:239], v[52:55], v[204:207]
    ds_read_b64_tr_b16 v[252:253], v27 offset:20480
    ds_read_b64_tr_b16 v[254:255], v27 offset:21504
    s_waitcnt vmcnt(14) lgkmcnt(6)
    v_mfma_f32_16x16x32_bf16 v[192:195], v[240:243], v[56:59], v[192:195]
    ds_read_b64_tr_b16 v[224:225], v24 offset:24576
    buffer_load_dwordx4 v[132:135], v42, s[24:27], s72 offen offset:1024 sc1
    ds_read_b64_tr_b16 v[226:227], v24 offset:25600
    s_waitcnt lgkmcnt(6)
    v_mfma_f32_16x16x32_bf16 v[196:199], v[244:247], v[56:59], v[196:199]
    ds_read_b64_tr_b16 v[228:229], v25 offset:24576
    ds_read_b64_tr_b16 v[230:231], v25 offset:25600
    s_waitcnt lgkmcnt(6)
    v_mfma_f32_16x16x32_bf16 v[200:203], v[248:251], v[56:59], v[200:203]
    ds_read_b64_tr_b16 v[232:233], v26 offset:24576
    buffer_load_dwordx4 v[136:139], v42, s[24:27], s72 offen offset:2048 sc1
    ds_read_b64_tr_b16 v[234:235], v26 offset:25600
    s_waitcnt lgkmcnt(6)
    v_mfma_f32_16x16x32_bf16 v[204:207], v[252:255], v[56:59], v[204:207]
    ds_read_b64_tr_b16 v[236:237], v27 offset:24576
    ds_read_b64_tr_b16 v[238:239], v27 offset:25600
    s_waitcnt vmcnt(15) lgkmcnt(6)
    v_mfma_f32_16x16x32_bf16 v[192:195], v[224:227], v[60:63], v[192:195]
    ds_read_b64_tr_b16 v[240:241], v24 offset:28672
    ds_read_b64_tr_b16 v[242:243], v24 offset:29696
    s_waitcnt lgkmcnt(6)
    v_mfma_f32_16x16x32_bf16 v[196:199], v[228:231], v[60:63], v[196:199]
    ds_read_b64_tr_b16 v[244:245], v25 offset:28672
    ds_read_b64_tr_b16 v[246:247], v25 offset:29696
    s_waitcnt lgkmcnt(6)
    v_mfma_f32_16x16x32_bf16 v[200:203], v[232:235], v[60:63], v[200:203]
    ds_read_b64_tr_b16 v[248:249], v26 offset:28672
    ds_read_b64_tr_b16 v[250:251], v26 offset:29696
    s_waitcnt lgkmcnt(6)
    v_mfma_f32_16x16x32_bf16 v[204:207], v[236:239], v[60:63], v[204:207]
    ds_read_b64_tr_b16 v[252:253], v27 offset:28672
    ds_read_b64_tr_b16 v[254:255], v27 offset:29696
    s_waitcnt vmcnt(14) lgkmcnt(6)
    v_mfma_f32_16x16x32_bf16 v[192:195], v[240:243], v[64:67], v[192:195]
    ds_read_b64_tr_b16 v[224:225], v24 offset:32768
    ds_read_b64_tr_b16 v[226:227], v24 offset:33792
    s_waitcnt lgkmcnt(6)
    v_mfma_f32_16x16x32_bf16 v[196:199], v[244:247], v[64:67], v[196:199]
    ds_read_b64_tr_b16 v[228:229], v25 offset:32768
    ds_read_b64_tr_b16 v[230:231], v25 offset:33792
    s_waitcnt lgkmcnt(6)
    v_mfma_f32_16x16x32_bf16 v[200:203], v[248:251], v[64:67], v[200:203]
    ds_read_b64_tr_b16 v[232:233], v26 offset:32768
    ds_read_b64_tr_b16 v[234:235], v26 offset:33792
    s_waitcnt lgkmcnt(6)
    v_mfma_f32_16x16x32_bf16 v[204:207], v[252:255], v[64:67], v[204:207]
    ds_read_b64_tr_b16 v[236:237], v27 offset:32768
    ds_read_b64_tr_b16 v[238:239], v27 offset:33792
    s_waitcnt vmcnt(13) lgkmcnt(6)
    v_mfma_f32_16x16x32_bf16 v[192:195], v[224:227], v[68:71], v[192:195]
    ds_read_b64_tr_b16 v[240:241], v24 offset:36864
    ds_read_b64_tr_b16 v[242:243], v24 offset:37888
    s_waitcnt lgkmcnt(6)
    v_mfma_f32_16x16x32_bf16 v[196:199], v[228:231], v[68:71], v[196:199]
    ds_read_b64_tr_b16 v[244:245], v25 offset:36864
    ds_read_b64_tr_b16 v[246:247], v25 offset:37888
    s_waitcnt lgkmcnt(6)
    v_mfma_f32_16x16x32_bf16 v[200:203], v[232:235], v[68:71], v[200:203]
    ds_read_b64_tr_b16 v[248:249], v26 offset:36864
    ds_read_b64_tr_b16 v[250:251], v26 offset:37888
    s_waitcnt lgkmcnt(6)
    v_mfma_f32_16x16x32_bf16 v[204:207], v[236:239], v[68:71], v[204:207]
    ds_read_b64_tr_b16 v[252:253], v27 offset:36864
    ds_read_b64_tr_b16 v[254:255], v27 offset:37888
    s_waitcnt vmcnt(12) lgkmcnt(6)
    v_mfma_f32_16x16x32_bf16 v[192:195], v[240:243], v[88:91], v[192:195]
    ds_read_b64_tr_b16 v[224:225], v24 offset:40960
    ds_read_b64_tr_b16 v[226:227], v24 offset:41984
    s_waitcnt lgkmcnt(6)
    v_mfma_f32_16x16x32_bf16 v[196:199], v[244:247], v[88:91], v[196:199]
    ds_read_b64_tr_b16 v[228:229], v25 offset:40960
    ds_read_b64_tr_b16 v[230:231], v25 offset:41984
    s_waitcnt lgkmcnt(6)
    v_mfma_f32_16x16x32_bf16 v[200:203], v[248:251], v[88:91], v[200:203]
    ds_read_b64_tr_b16 v[232:233], v26 offset:40960
    ds_read_b64_tr_b16 v[234:235], v26 offset:41984
    s_waitcnt lgkmcnt(6)
    v_mfma_f32_16x16x32_bf16 v[204:207], v[252:255], v[88:91], v[204:207]
    ds_read_b64_tr_b16 v[236:237], v27 offset:40960
    ds_read_b64_tr_b16 v[238:239], v27 offset:41984
    v_add_u32 v24, s94, v24
    v_add_u32 v25, s94, v25
    v_add_u32 v26, s94, v26
    v_add_u32 v27, s94, v27
    s_waitcnt vmcnt(11) lgkmcnt(6)
    v_mfma_f32_16x16x32_bf16 v[192:195], v[224:227], v[92:95], v[192:195]
    ds_read_b64_tr_b16 v[240:241], v24 offset:0
    ds_read_b64_tr_b16 v[242:243], v24 offset:1024
    s_waitcnt lgkmcnt(6)
    v_mfma_f32_16x16x32_bf16 v[196:199], v[228:231], v[92:95], v[196:199]
    ds_read_b64_tr_b16 v[244:245], v25 offset:0
    ds_read_b64_tr_b16 v[246:247], v25 offset:1024
    s_waitcnt lgkmcnt(6)
    v_mfma_f32_16x16x32_bf16 v[200:203], v[232:235], v[92:95], v[200:203]
    ds_read_b64_tr_b16 v[248:249], v26 offset:0
    ds_read_b64_tr_b16 v[250:251], v26 offset:1024
    s_waitcnt lgkmcnt(6)
    v_mfma_f32_16x16x32_bf16 v[204:207], v[236:239], v[92:95], v[204:207]
    ds_read_b64_tr_b16 v[252:253], v27 offset:0
    ds_read_b64_tr_b16 v[254:255], v27 offset:1024
    s_waitcnt vmcnt(10) lgkmcnt(6)
    v_mfma_f32_16x16x32_bf16 v[192:195], v[240:243], v[96:99], v[192:195]
    ds_read_b64_tr_b16 v[224:225], v24 offset:4096
    ds_read_b64_tr_b16 v[226:227], v24 offset:5120
    s_waitcnt lgkmcnt(6)
    v_mfma_f32_16x16x32_bf16 v[196:199], v[244:247], v[96:99], v[196:199]
    ds_read_b64_tr_b16 v[228:229], v25 offset:4096
    ds_read_b64_tr_b16 v[230:231], v25 offset:5120
    s_waitcnt lgkmcnt(6)
    v_mfma_f32_16x16x32_bf16 v[200:203], v[248:251], v[96:99], v[200:203]
    ds_read_b64_tr_b16 v[232:233], v26 offset:4096
    ds_read_b64_tr_b16 v[234:235], v26 offset:5120
    s_waitcnt lgkmcnt(6)
    v_mfma_f32_16x16x32_bf16 v[204:207], v[252:255], v[96:99], v[204:207]
    ds_read_b64_tr_b16 v[236:237], v27 offset:4096
    ds_read_b64_tr_b16 v[238:239], v27 offset:5120
    s_waitcnt vmcnt(9) lgkmcnt(6)
    v_mfma_f32_16x16x32_bf16 v[192:195], v[224:227], v[100:103], v[192:195]
    ds_read_b64_tr_b16 v[240:241], v24 offset:8192
    ds_read_b64_tr_b16 v[242:243], v24 offset:9216
    s_waitcnt lgkmcnt(6)
    v_mfma_f32_16x16x32_bf16 v[196:199], v[228:231], v[100:103], v[196:199]
    ds_read_b64_tr_b16 v[244:245], v25 offset:8192
    ds_read_b64_tr_b16 v[246:247], v25 offset:9216
    s_waitcnt lgkmcnt(6)
    v_mfma_f32_16x16x32_bf16 v[200:203], v[232:235], v[100:103], v[200:203]
    ds_read_b64_tr_b16 v[248:249], v26 offset:8192
    ds_read_b64_tr_b16 v[250:251], v26 offset:9216
    s_waitcnt lgkmcnt(6)
    v_mfma_f32_16x16x32_bf16 v[204:207], v[236:239], v[100:103], v[204:207]
    ds_read_b64_tr_b16 v[252:253], v27 offset:8192
    ds_read_b64_tr_b16 v[254:255], v27 offset:9216
    s_waitcnt vmcnt(8) lgkmcnt(6)
    v_mfma_f32_16x16x32_bf16 v[192:195], v[240:243], v[104:107], v[192:195]
    ds_read_b64_tr_b16 v[224:225], v24 offset:12288
    ds_read_b64_tr_b16 v[226:227], v24 offset:13312
    s_waitcnt lgkmcnt(6)
    v_mfma_f32_16x16x32_bf16 v[196:199], v[244:247], v[104:107], v[196:199]
    ds_read_b64_tr_b16 v[228:229], v25 offset:12288
    ds_read_b64_tr_b16 v[230:231], v25 offset:13312
    s_waitcnt lgkmcnt(6)
    v_mfma_f32_16x16x32_bf16 v[200:203], v[248:251], v[104:107], v[200:203]
    ds_read_b64_tr_b16 v[232:233], v26 offset:12288
    ds_read_b64_tr_b16 v[234:235], v26 offset:13312
    s_waitcnt lgkmcnt(6)
    v_mfma_f32_16x16x32_bf16 v[204:207], v[252:255], v[104:107], v[204:207]
    ds_read_b64_tr_b16 v[236:237], v27 offset:12288
    ds_read_b64_tr_b16 v[238:239], v27 offset:13312
    s_waitcnt vmcnt(7) lgkmcnt(6)
    v_mfma_f32_16x16x32_bf16 v[192:195], v[224:227], v[108:111], v[192:195]
    ds_read_b64_tr_b16 v[240:241], v24 offset:16384
    ds_read_b64_tr_b16 v[242:243], v24 offset:17408
    s_waitcnt lgkmcnt(6)
    v_mfma_f32_16x16x32_bf16 v[196:199], v[228:231], v[108:111], v[196:199]
    ds_read_b64_tr_b16 v[244:245], v25 offset:16384
    ds_read_b64_tr_b16 v[246:247], v25 offset:17408
    s_waitcnt lgkmcnt(6)
    v_mfma_f32_16x16x32_bf16 v[200:203], v[232:235], v[108:111], v[200:203]
    ds_read_b64_tr_b16 v[248:249], v26 offset:16384
    ds_read_b64_tr_b16 v[250:251], v26 offset:17408
    s_waitcnt lgkmcnt(6)
    v_mfma_f32_16x16x32_bf16 v[204:207], v[236:239], v[108:111], v[204:207]
    ds_read_b64_tr_b16 v[252:253], v27 offset:16384
    ds_read_b64_tr_b16 v[254:255], v27 offset:17408
    s_waitcnt vmcnt(6) lgkmcnt(6)
    v_mfma_f32_16x16x32_bf16 v[192:195], v[240:243], v[112:115], v[192:195]
    ds_read_b64_tr_b16 v[224:225], v24 offset:20480
    ds_read_b64_tr_b16 v[226:227], v24 offset:21504
    s_waitcnt lgkmcnt(6)
    v_mfma_f32_16x16x32_bf16 v[196:199], v[244:247], v[112:115], v[196:199]
    ds_read_b64_tr_b16 v[228:229], v25 offset:20480
    ds_read_b64_tr_b16 v[230:231], v25 offset:21504
    s_waitcnt lgkmcnt(6)
    v_mfma_f32_16x16x32_bf16 v[200:203], v[248:251], v[112:115], v[200:203]
    ds_read_b64_tr_b16 v[232:233], v26 offset:20480
    ds_read_b64_tr_b16 v[234:235], v26 offset:21504
    s_waitcnt lgkmcnt(6)
    v_mfma_f32_16x16x32_bf16 v[204:207], v[252:255], v[112:115], v[204:207]
    ds_read_b64_tr_b16 v[236:237], v27 offset:20480
    ds_read_b64_tr_b16 v[238:239], v27 offset:21504
    s_waitcnt vmcnt(5) lgkmcnt(6)
    v_mfma_f32_16x16x32_bf16 v[192:195], v[224:227], v[116:119], v[192:195]
    ds_read_b64_tr_b16 v[240:241], v24 offset:24576
    ds_read_b64_tr_b16 v[242:243], v24 offset:25600
    s_waitcnt lgkmcnt(6)
    v_mfma_f32_16x16x32_bf16 v[196:199], v[228:231], v[116:119], v[196:199]
    ds_read_b64_tr_b16 v[244:245], v25 offset:24576
    ds_read_b64_tr_b16 v[246:247], v25 offset:25600
    s_waitcnt lgkmcnt(6)
    v_mfma_f32_16x16x32_bf16 v[200:203], v[232:235], v[116:119], v[200:203]
    ds_read_b64_tr_b16 v[248:249], v26 offset:24576
    ds_read_b64_tr_b16 v[250:251], v26 offset:25600
    s_waitcnt lgkmcnt(6)
    v_mfma_f32_16x16x32_bf16 v[204:207], v[236:239], v[116:119], v[204:207]
    ds_read_b64_tr_b16 v[252:253], v27 offset:24576
    ds_read_b64_tr_b16 v[254:255], v27 offset:25600
    s_waitcnt vmcnt(4) lgkmcnt(6)
    v_mfma_f32_16x16x32_bf16 v[192:195], v[240:243], v[120:123], v[192:195]
    ds_read_b64_tr_b16 v[224:225], v24 offset:28672
    ds_read_b64_tr_b16 v[226:227], v24 offset:29696
    s_waitcnt lgkmcnt(6)
    v_mfma_f32_16x16x32_bf16 v[196:199], v[244:247], v[120:123], v[196:199]
    ds_read_b64_tr_b16 v[228:229], v25 offset:28672
    ds_read_b64_tr_b16 v[230:231], v25 offset:29696
    s_waitcnt lgkmcnt(6)
    v_mfma_f32_16x16x32_bf16 v[200:203], v[248:251], v[120:123], v[200:203]
    ds_read_b64_tr_b16 v[232:233], v26 offset:28672
    ds_read_b64_tr_b16 v[234:235], v26 offset:29696
    s_waitcnt lgkmcnt(6)
    v_mfma_f32_16x16x32_bf16 v[204:207], v[252:255], v[120:123], v[204:207]
    ds_read_b64_tr_b16 v[236:237], v27 offset:28672
    ds_read_b64_tr_b16 v[238:239], v27 offset:29696
    s_waitcnt vmcnt(3) lgkmcnt(6)
    v_mfma_f32_16x16x32_bf16 v[192:195], v[224:227], v[124:127], v[192:195]
    ds_read_b64_tr_b16 v[240:241], v24 offset:32768
    ds_read_b64_tr_b16 v[242:243], v24 offset:33792
    s_waitcnt lgkmcnt(6)
    v_mfma_f32_16x16x32_bf16 v[196:199], v[228:231], v[124:127], v[196:199]
    ds_read_b64_tr_b16 v[244:245], v25 offset:32768
    ds_read_b64_tr_b16 v[246:247], v25 offset:33792
    s_waitcnt lgkmcnt(6)
    v_mfma_f32_16x16x32_bf16 v[200:203], v[232:235], v[124:127], v[200:203]
    ds_read_b64_tr_b16 v[248:249], v26 offset:32768
    ds_read_b64_tr_b16 v[250:251], v26 offset:33792
    s_waitcnt lgkmcnt(6)
    v_mfma_f32_16x16x32_bf16 v[204:207], v[236:239], v[124:127], v[204:207]
    ds_read_b64_tr_b16 v[252:253], v27 offset:32768
    ds_read_b64_tr_b16 v[254:255], v27 offset:33792
    s_waitcnt vmcnt(2) lgkmcnt(6)
    v_mfma_f32_16x16x32_bf16 v[192:195], v[240:243], v[128:131], v[192:195]
    ds_read_b64_tr_b16 v[224:225], v24 offset:36864
    ds_read_b64_tr_b16 v[226:227], v24 offset:37888
    s_waitcnt lgkmcnt(6)
    v_mfma_f32_16x16x32_bf16 v[196:199], v[244:247], v[128:131], v[196:199]
    ds_read_b64_tr_b16 v[228:229], v25 offset:36864
    ds_read_b64_tr_b16 v[230:231], v25 offset:37888
    s_waitcnt lgkmcnt(6)
    v_mfma_f32_16x16x32_bf16 v[200:203], v[248:251], v[128:131], v[200:203]
    ds_read_b64_tr_b16 v[232:233], v26 offset:36864
    ds_read_b64_tr_b16 v[234:235], v26 offset:37888
    s_waitcnt lgkmcnt(6)
    v_mfma_f32_16x16x32_bf16 v[204:207], v[252:255], v[128:131], v[204:207]
    ds_read_b64_tr_b16 v[236:237], v27 offset:36864
    ds_read_b64_tr_b16 v[238:239], v27 offset:37888
    s_waitcnt vmcnt(1) lgkmcnt(6)
    v_mfma_f32_16x16x32_bf16 v[192:195], v[224:227], v[132:135], v[192:195]
    ds_read_b64_tr_b16 v[240:241], v24 offset:40960
    ds_read_b64_tr_b16 v[242:243], v24 offset:41984
    s_waitcnt lgkmcnt(6)
    v_mfma_f32_16x16x32_bf16 v[196:199], v[228:231], v[132:135], v[196:199]
    ds_read_b64_tr_b16 v[244:245], v25 offset:40960
    ds_read_b64_tr_b16 v[246:247], v25 offset:41984
    s_waitcnt lgkmcnt(6)
    v_mfma_f32_16x16x32_bf16 v[200:203], v[232:235], v[132:135], v[200:203]
    ds_read_b64_tr_b16 v[248:249], v26 offset:40960
    ds_read_b64_tr_b16 v[250:251], v26 offset:41984
    s_waitcnt lgkmcnt(6)
    v_mfma_f32_16x16x32_bf16 v[204:207], v[236:239], v[132:135], v[204:207]
    ds_read_b64_tr_b16 v[252:253], v27 offset:40960
    ds_read_b64_tr_b16 v[254:255], v27 offset:41984
    s_waitcnt vmcnt(0) lgkmcnt(6)
    v_mfma_f32_16x16x32_bf16 v[192:195], v[240:243], v[136:139], v[192:195]
    s_waitcnt lgkmcnt(4)
    v_mfma_f32_16x16x32_bf16 v[196:199], v[244:247], v[136:139], v[196:199]
    s_waitcnt lgkmcnt(2)
    v_mfma_f32_16x16x32_bf16 v[200:203], v[248:251], v[136:139], v[200:203]
    s_waitcnt lgkmcnt(0)
    v_mfma_f32_16x16x32_bf16 v[204:207], v[252:255], v[136:139], v[204:207]
    s_nop 1
    v_pk_mul_f32 v[240:241], v[192:193], v[28:29] op_sel_hi:[1,0]
    v_pk_mul_f32 v[242:243], v[194:195], v[28:29] op_sel_hi:[1,0]
    v_pk_mul_f32 v[244:245], v[196:197], v[28:29] op_sel_hi:[1,0]
    v_pk_mul_f32 v[246:247], v[198:199], v[28:29] op_sel_hi:[1,0]
    v_pk_mul_f32 v[248:249], v[200:201], v[28:29] op_sel_hi:[1,0]
    v_pk_mul_f32 v[250:251], v[202:203], v[28:29] op_sel_hi:[1,0]
    v_pk_mul_f32 v[252:253], v[204:205], v[28:29] op_sel_hi:[1,0]
    v_pk_mul_f32 v[254:255], v[206:207], v[28:29] op_sel_hi:[1,0]
    v_exp_f32 v240, v240
    v_exp_f32 v241, v241
    v_exp_f32 v242, v242
    v_exp_f32 v243, v243
    v_exp_f32 v244, v244
    v_exp_f32 v245, v245
    v_exp_f32 v246, v246
    v_exp_f32 v247, v247
    v_exp_f32 v248, v248
    v_exp_f32 v249, v249
    v_exp_f32 v250, v250
    v_exp_f32 v251, v251
    v_exp_f32 v252, v252
    v_exp_f32 v253, v253
    v_exp_f32 v254, v254
    v_exp_f32 v255, v255
    v_pk_add_f32 v[240:241], v[240:241], 1.0 op_sel_hi:[1,0]
    v_pk_mul_f32 v[208:209], v[208:209], v[192:193]
    v_pk_add_f32 v[242:243], v[242:243], 1.0 op_sel_hi:[1,0]
    v_pk_mul_f32 v[210:211], v[210:211], v[194:195]
    v_pk_add_f32 v[244:245], v[244:245], 1.0 op_sel_hi:[1,0]
    v_pk_mul_f32 v[212:213], v[212:213], v[196:197]
    v_pk_add_f32 v[246:247], v[246:247], 1.0 op_sel_hi:[1,0]
    v_pk_mul_f32 v[214:215], v[214:215], v[198:199]
    v_pk_add_f32 v[248:249], v[248:249], 1.0 op_sel_hi:[1,0]
    v_pk_mul_f32 v[216:217], v[216:217], v[200:201]
    v_pk_add_f32 v[250:251], v[250:251], 1.0 op_sel_hi:[1,0]
    v_pk_mul_f32 v[218:219], v[218:219], v[202:203]
    v_pk_add_f32 v[252:253], v[252:253], 1.0 op_sel_hi:[1,0]
    v_pk_mul_f32 v[220:221], v[220:221], v[204:205]
    v_pk_add_f32 v[254:255], v[254:255], 1.0 op_sel_hi:[1,0]
    v_pk_mul_f32 v[222:223], v[222:223], v[206:207]
    v_rcp_f32 v240, v240
    v_rcp_f32 v241, v241
    v_rcp_f32 v242, v242
    v_rcp_f32 v243, v243
    v_pk_fma_f32 v[240:241], v[240:241], v[208:209], v[72:73]
    v_pk_fma_f32 v[242:243], v[242:243], v[210:211], v[74:75]
    v_cvt_pk_bf16_f32 v192, v240, v241
    v_cvt_pk_bf16_f32 v193, v242, v243
    ds_write_b64 v32, v[192:193]
    v_rcp_f32 v244, v244
    v_rcp_f32 v245, v245
    v_rcp_f32 v246, v246
    v_rcp_f32 v247, v247
    v_pk_fma_f32 v[244:245], v[244:245], v[212:213], v[76:77]
    v_pk_fma_f32 v[246:247], v[246:247], v[214:215], v[78:79]
    v_cvt_pk_bf16_f32 v194, v244, v245
    v_cvt_pk_bf16_f32 v195, v246, v247
    ds_write_b64 v35, v[194:195]
    v_rcp_f32 v248, v248
    v_rcp_f32 v249, v249
    v_rcp_f32 v250, v250
    v_rcp_f32 v251, v251
    v_pk_fma_f32 v[248:249], v[248:249], v[216:217], v[80:81]
    v_pk_fma_f32 v[250:251], v[250:251], v[218:219], v[82:83]
    v_cvt_pk_bf16_f32 v196, v248, v249
    v_cvt_pk_bf16_f32 v197, v250, v251
    ds_write_b64 v36, v[196:197]
    v_rcp_f32 v252, v252
    v_rcp_f32 v253, v253
    v_rcp_f32 v254, v254
    v_rcp_f32 v255, v255
    v_pk_fma_f32 v[252:253], v[252:253], v[220:221], v[84:85]
    v_pk_fma_f32 v[254:255], v[254:255], v[222:223], v[86:87]
    v_cvt_pk_bf16_f32 v198, v252, v253
    v_cvt_pk_bf16_f32 v199, v254, v255
    ds_write_b64 v37, v[198:199]
    ds_read_b128 v[240:243], v33 offset:0
    ds_read_b128 v[244:247], v33 offset:1024
    s_add_u32 s77, s56, 8192
    s_waitcnt lgkmcnt(1)
    buffer_store_dwordx4 v[240:243], v34, s[36:39], s56 offen sc1
    s_waitcnt lgkmcnt(0)
    buffer_store_dwordx4 v[244:247], v34, s[36:39], s77 offen sc1
L_end:
    s_endpgm
L_slow_n_2:
    s_mov_b32 s85, 32768
L_loop_4:
    buffer_load_dword v55, v45, s[48:51], 0 offen sc1
    s_waitcnt vmcnt(0)
    v_cmp_eq_u32 vcc, 0, v55
    s_sub_u32 s85, s85, 1
    s_cbranch_vccz L_back_n_3
    s_cmp_lg_u32 s85, 0
    s_cbranch_scc1 L_loop_4
    s_branch L_back_n_3
L_slow_st_5:
    s_mov_b32 s85, 32768
L_loop_7:
    buffer_load_dwordx2 v[196:197], v191, s[24:27], 0 offen offset:0 sc1
    buffer_load_dwordx2 v[198:199], v191, s[24:27], 0 offen offset:1024 sc1
    buffer_load_dwordx2 v[200:201], v191, s[24:27], 0 offen offset:2048 sc1
    buffer_load_dwordx2 v[202:203], v191, s[24:27], 0 offen offset:3072 sc1
    buffer_load_dwordx2 v[204:205], v9, s[24:27], 0 offen offset:0 sc1
    buffer_load_dwordx2 v[206:207], v9, s[24:27], 0 offen offset:1024 sc1
    buffer_load_dwordx2 v[208:209], v9, s[24:27], 0 offen offset:2048 sc1
    buffer_load_dwordx2 v[210:211], v9, s[24:27], 0 offen offset:3072 sc1
    s_waitcnt vmcnt(0)
    v_min3_u32 v5, v197, v199, v201
    v_max3_u32 v6, v197, v199, v201
    v_min3_u32 v5, v5, v203, v205
    v_max3_u32 v6, v6, v203, v205
    v_min3_u32 v5, v5, v207, v209
    v_max3_u32 v6, v6, v207, v209
    v_min_u32 v5, v5, v211
    v_max_u32 v6, v6, v211
    v_xor_b32 v5, s83, v5
    v_xor_b32 v6, s83, v6
    v_or_b32 v5, v5, v6
    v_cmp_ne_u32 vcc, 0, v5
    s_sub_u32 s85, s85, 1
    s_cbranch_vccz L_back_st_6
    s_cmp_lg_u32 s85, 0
    s_cbranch_scc1 L_loop_7
    s_branch L_back_st_6
L_slow_f1_9:
    s_mov_b32 s85, 32768
L_loop_11:
    buffer_load_dword v44, v43, s[24:27], 0 offen sc1
    s_waitcnt vmcnt(0)
    v_cmp_ne_u32 vcc, s83, v44
    s_sub_u32 s85, s85, 1
    s_cbranch_vccz L_back_f1_10
    s_cmp_lg_u32 s85, 0
    s_cbranch_scc1 L_loop_11
    s_branch L_back_f1_10
L_slow_kvf_17:
    s_mov_b32 s85, 32768
L_loop_19:
    buffer_load_dwordx4 v[56:59], v42, s[24:27], s68 offen offset:0 sc1
    buffer_load_dwordx4 v[60:63], v42, s[24:27], s68 offen offset:1024 sc1
    buffer_load_dwordx4 v[64:67], v42, s[24:27], s68 offen offset:2048 sc1
    buffer_load_dwordx4 v[68:71], v42, s[24:27], s68 offen offset:3072 sc1
    buffer_load_dwordx4 v[196:199], v42, s[24:27], s69 offen offset:0 sc1
    buffer_load_dwordx4 v[200:203], v42, s[24:27], s69 offen offset:1024 sc1
    buffer_load_dwordx4 v[204:207], v42, s[24:27], s69 offen offset:2048 sc1
    buffer_load_dwordx4 v[208:211], v42, s[24:27], s69 offen offset:3072 sc1
    s_waitcnt vmcnt(0)
    v_min3_u32 v5, v57, v59, v61
    v_max3_u32 v6, v57, v59, v61
    v_min3_u32 v5, v5, v63, v65
    v_max3_u32 v6, v6, v63, v65
    v_min3_u32 v5, v5, v67, v69
    v_max3_u32 v6, v6, v67, v69
    v_min3_u32 v5, v5, v71, v197
    v_max3_u32 v6, v6, v71, v197
    v_min3_u32 v5, v5, v199, v201
    v_max3_u32 v6, v6, v199, v201
    v_min3_u32 v5, v5, v203, v205
    v_max3_u32 v6, v6, v203, v205
    v_min3_u32 v5, v5, v207, v209
    v_max3_u32 v6, v6, v207, v209
    v_min_u32 v5, v5, v211
    v_max_u32 v6, v6, v211
    v_xor_b32 v5, s83, v5
    v_xor_b32 v6, s83, v6
    v_or_b32_e64 v5, v5, v6
    v_cmp_ne_u32 vcc, 0, v5
    s_sub_u32 s85, s85, 1
    s_cbranch_vccz L_back_kvf_18
    s_cmp_lg_u32 s85, 0
    s_cbranch_scc1 L_loop_19
    s_branch L_back_kvf_18
L_slow_f5_21:
    s_mov_b32 s85, 32768
L_loop_23:
    buffer_load_dword v44, v43, s[24:27], 0 offen sc1
    s_sub_u32 s85, s85, 1
    s_waitcnt vmcnt(0)
    v_cmp_eq_u32 vcc, s83, v44
    s_nop 3
    s_lshr_b32 s81, vcc_lo, 8
    s_or_b32 s81, s81, vcc_lo
    s_and_b32 s81, s81, 0xff
    s_cmp_eq_u32 s81, 0xff
    s_cbranch_scc1 L_back_f5_22
    s_cmp_lg_u32 s85, 0
    s_cbranch_scc1 L_loop_23
    s_branch L_back_f5_22
L_light_12:
    s_waitcnt vmcnt(0) lgkmcnt(0)
    s_nop 15
    s_cmp_eq_u32 s5, 0
    s_cselect_b64 vcc, -1, 0
    v_cndmask_b32 v39, v38, v40, vcc
    v_mov_b32 v240, 0
    v_accvgpr_write_b32 a32, 0
    v_mov_b32_e64 v241, 0
    v_accvgpr_write_b32 a33, 0
    v_mov_b32_e64 v242, 0
    v_accvgpr_write_b32 a34, 0
    v_mov_b32_e64 v243, 0
    v_accvgpr_write_b32 a35, 0
    v_mov_b32_e64 v244, 0
    v_accvgpr_write_b32 a36, 0
    v_mov_b32_e64 v245, 0
    v_accvgpr_write_b32 a37, 0
    v_mov_b32_e64 v246, 0
    v_accvgpr_write_b32 a38, 0
    v_mov_b32_e64 v247, 0
    v_accvgpr_write_b32 a39, 0
    v_mov_b32_e64 v248, 0
    v_accvgpr_write_b32 a40, 0
    v_mov_b32_e64 v249, 0
    v_accvgpr_write_b32 a41, 0
    v_mov_b32_e64 v250, 0
    v_accvgpr_write_b32 a42, 0
    v_mov_b32_e64 v251, 0
    v_accvgpr_write_b32 a43, 0
    v_mov_b32_e64 v252, 0
    v_accvgpr_write_b32 a44, 0
    v_mov_b32_e64 v253, 0
    v_accvgpr_write_b32 a45, 0
    v_mov_b32_e64 v254, 0
    v_accvgpr_write_b32 a46, 0
    v_mov_b32_e64 v255, 0
    v_accvgpr_write_b32 a47, 0
    s_xor_b32 s66, s91, 0
    s_mul_i32 s66, s66, 12288
    s_add_u32 s66, s66, s63
    buffer_load_dwordx4 v[212:215], v39, s[24:27], s66 offen sc1
    s_add_u32 s66, s66, 3072
    buffer_load_dwordx4 v[216:219], v39, s[24:27], s66 offen sc1
    s_add_u32 s66, s66, 3072
    buffer_load_dwordx4 v[220:223], v39, s[24:27], s66 offen sc1
    s_add_u32 s66, s66, 3072
    buffer_load_dwordx4 v[184:187], v39, s[24:27], s66 offen sc1
    s_xor_b32 s66, s91, 1
    s_mul_i32 s66, s66, 12288
    s_add_u32 s66, s66, s63
    buffer_load_dwordx4 v[188:191], v39, s[24:27], s66 offen sc1
    s_add_u32 s66, s66, 3072
    buffer_load_dwordx4 v[192:195], v39, s[24:27], s66 offen sc1
    s_add_u32 s66, s66, 3072
    buffer_load_dwordx4 v[124:127], v39, s[24:27], s66 offen sc1
    s_add_u32 s66, s66, 3072
    buffer_load_dwordx4 v[128:131], v39, s[24:27], s66 offen sc1
    s_xor_b32 s66, s91, 2
    s_mul_i32 s66, s66, 12288
    s_add_u32 s66, s66, s63
    buffer_load_dwordx4 v[132:135], v39, s[24:27], s66 offen sc1
    s_add_u32 s66, s66, 3072
    buffer_load_dwordx4 v[112:115], v39, s[24:27], s66 offen sc1
    s_waitcnt vmcnt(9)
    v_mfma_f32_32x32x16_bf16 v[224:239], v[212:215], a[128:131], 0
    s_add_u32 s66, s66, 3072
    buffer_load_dwordx4 v[116:119], v39, s[24:27], s66 offen sc1
    v_fma_f32 v95, v203, v36, -v176
    v_fma_f32 v103, -v203, v36, v177
    v_exp_f32 v88, v88
    v_mfma_f32_32x32x16_bf16 a[16:31], v[212:215], a[132:135], 0
    s_add_u32 s82, s82, 31744
    buffer_load_dwordx4 v35, s[20:23], s82 offen offset:3072 lds
    v_exp_f32 v89, v89
    v_exp_f32 v90, v90
    v_exp_f32_e64 v91, v91
    v_mfma_f32_32x32x16_bf16 a[0:15], v[212:215], a[128:131], 0
    s_add_u32 s82, s82, s59
    s_add_u32 m0, s58, 36864
    s_nop 0
    buffer_load_dwordx4 v34, s[20:23], s82 offen offset:0 lds
    v_exp_f32 v92, v92
    v_exp_f32 v93, v93
    v_exp_f32_e64 v94, v94
    v_mfma_f32_32x32x16_bf16 a[48:63], v[212:215], a[132:135], 0
    s_add_u32 s82, s82, 31744
    buffer_load_dwordx4 v35, s[20:23], s82 offen offset:1024 lds
    v_exp_f32 v95, v95
    v_exp_f32 v96, v96
    v_exp_f32 v97, v97
    v_add_f32 v56, v56, v60
    v_add_f32 v57, v57, v61
    v_add_f32 v58, v58, v62
    v_add_f32 v59, v59, v63
    v_add_f32 v56, v56, v64
    v_add_f32 v57, v57, v65
    v_add_f32 v58, v58, v66
    v_add_f32 v59, v59, v67
    v_add_f32 v56, v56, v68
    v_add_f32 v57, v57, v69
    v_add_f32 v58, v58, v70
    v_add_f32 v59, v59, v71
    s_lshl_b32 s76, s3, 10
    s_add_u32 s76, s76, 65536
    v_add_u32 v4, s76, v42
    ds_write_b128 v4, v[56:59]
    s_waitcnt vmcnt(12)
    v_mfma_f32_32x32x16_bf16 v[224:239], v[216:219], a[136:139], v[224:239]
    s_add_u32 s66, s66, 3072
    buffer_load_dwordx4 v[212:215], v39, s[24:27], s66 offen sc1
    v_exp_f32 v98, v98
    v_exp_f32 v99, v99
    v_exp_f32_e64 v100, v100
    v_mfma_f32_32x32x16_bf16 a[16:31], v[216:219], a[140:143], a[16:31]
    s_add_u32 s82, s82, 31744
    buffer_load_dwordx4 v34, s[20:23], s82 offen offset:2048 lds
    v_exp_f32 v101, v101
    v_exp_f32 v102, v102
    v_exp_f32_e64 v103, v103
    v_mfma_f32_32x32x16_bf16 a[0:15], v[216:219], a[136:139], a[0:15]
    s_add_u32 s82, s82, 31744
    buffer_load_dwordx4 v35, s[20:23], s82 offen offset:3072 lds
    v_add_f32 v196, v88, v90
    v_add_f32 v197, v89, v91
    v_add_f32_e64 v198, v96, v98
    v_mfma_f32_32x32x16_bf16 a[48:63], v[216:219], a[140:143], a[48:63]
    v_add_f32 v199, v97, v99
    v_add_f32 v196, v196, v92
    v_add_f32 v197, v197, v93
    v_add_f32 v198, v198, v100
    v_add_f32 v199, v199, v101
    v_add_f32 v196, v196, v94
    s_waitcnt lgkmcnt(0)
    s_barrier
    s_cmp_lg_u32 s3, 0
    s_cbranch_scc1 L_w0_14
    v_add_u32 v4, 65536, v42
    ds_read_b128 v[56:59], v4 offset:0
    ds_read_b128 v[60:63], v4 offset:1024
    ds_read_b128 v[64:67], v4 offset:2048
    ds_read_b128 v[68:71], v4 offset:3072
L_w0_14:
    s_waitcnt vmcnt(14)
    v_mfma_f32_32x32x16_bf16 v[224:239], v[220:223], a[144:147], v[224:239]
    s_xor_b32 s66, s91, 3
    s_mul_i32 s66, s66, 12288
    s_add_u32 s66, s66, s63
    buffer_load_dwordx4 v[216:219], v39, s[24:27], s66 offen sc1
    v_add_f32 v197, v197, v95
    v_add_f32 v198, v198, v102
    v_add_f32 v199, v199, v103
    v_mfma_f32_32x32x16_bf16 a[16:31], v[220:223], a[148:151], a[16:31]
    v_add_f32 v196, v196, v197
    v_add_f32 v198, v198, v199
    v_mov_b32 v197, v196
    v_mov_b32 v199, v198
    s_nop 0
    v_permlane32_swap_b32 v196, v197
    v_permlane32_swap_b32_e64 v198, v199
    v_mfma_f32_32x32x16_bf16 a[0:15], v[220:223], a[144:147], a[0:15]
    v_add_f32 v196, v196, v197
    v_add_f32 v197, v198, v199
    v_rcp_f32 v196, v196
    v_rcp_f32 v197, v197
    v_mul_f32 v88, v196, v88
    v_mul_f32 v89, v196, v89
    v_mfma_f32_32x32x16_bf16 a[48:63], v[220:223], a[148:151], a[48:63]
    v_mul_f32 v90, v196, v90
    v_mul_f32 v91, v196, v91
    v_mul_f32 v92, v196, v92
    v_mul_f32 v93, v196, v93
    v_mul_f32 v94, v196, v94
    v_mul_f32 v95, v196, v95
    s_cmp_lg_u32 s3, 0
    s_cbranch_scc1 L_w0_15
    s_waitcnt lgkmcnt(0)
    v_add_f32 v56, v56, v60
    v_add_f32 v57, v57, v61
    v_add_f32 v58, v58, v62
    v_add_f32 v59, v59, v63
    s_waitcnt lgkmcnt(0)
    v_add_f32 v56, v56, v64
    v_add_f32 v57, v57, v65
    v_add_f32 v58, v58, v66
    v_add_f32 v59, v59, v67
    s_waitcnt lgkmcnt(0)
    v_add_f32 v56, v56, v68
    v_add_f32 v57, v57, v69
    v_add_f32 v58, v58, v70
    v_add_f32 v59, v59, v71
    s_lshl_b32 s76, s7, 14
    s_lshl_b32 s81, s6, 9
    s_add_u32 s76, s76, s81
    s_add_u32 s76, s76, 12582912
    v_permlane32_swap_b32 v56, v57
    v_permlane32_swap_b32 v58, v59
    v_add_f32 v56, v56, v57
    v_add_f32 v58, v58, v59
    v_bfe_u32 v4, v1, 0, 5
    v_lshlrev_b32_e64 v4, 4, v4
    v_bfe_u32 v2, v1, 5, 1
    v_lshl_add_u32 v4, v2, 3, v4
    v_add_u32 v4, s76, v4
    v_permlane32_swap_b32 v56, v58
    v_cvt_pk_bf16_f32 v56, v56, v58
    v_mov_b32 v57, s83
    buffer_store_dwordx2 v[56:57], v4, s[24:27], 0 offen sc1
L_w0_15:
    s_waitcnt vmcnt(14)
    v_mfma_f32_32x32x16_bf16 v[224:239], v[184:187], a[152:155], v[224:239]
    s_add_u32 s66, s66, 3072
    buffer_load_dwordx4 v[220:223], v39, s[24:27], s66 offen sc1
    v_mul_f32 v96, v197, v96
    v_mul_f32 v97, v197, v97
    v_mul_f32_e64 v98, v197, v98
    v_mfma_f32_32x32x16_bf16 a[16:31], v[184:187], a[156:159], a[16:31]
    v_mul_f32 v99, v197, v99
    v_mul_f32 v100, v197, v100
    v_mul_f32 v101, v197, v101
    v_mul_f32 v102, v197, v102
    v_mul_f32 v103, v197, v103
    v_cvt_pk_bf16_f32 v136, v88, v89
    v_mfma_f32_32x32x16_bf16 a[0:15], v[184:187], a[152:155], a[0:15]
    v_cvt_pk_bf16_f32 v137, v90, v91
    v_cvt_pk_bf16_f32 v138, v92, v93
    v_cvt_pk_bf16_f32 v139, v94, v95
    v_cvt_pk_bf16_f32 v140, v96, v97
    v_cvt_pk_bf16_f32 v141, v98, v99
    v_cvt_pk_bf16_f32 v142, v100, v101
    v_mfma_f32_32x32x16_bf16 a[48:63], v[184:187], a[156:159], a[48:63]
    v_cvt_pk_bf16_f32 v143, v102, v103
    v_fma_f32 v88, v204, v36, -v180
    v_fma_f32 v96, -v204, v36, v181
    v_fma_f32 v89, v205, v36, -v180
    v_fma_f32 v97, -v205, v36, v181
    v_fma_f32 v90, v206, v36, -v180
    s_waitcnt vmcnt(14)
    v_mfma_f32_32x32x16_bf16 v[224:239], v[188:191], a[160:163], v[224:239]
    s_add_u32 s66, s66, 3072
    buffer_load_dwordx4 v[184:187], v39, s[24:27], s66 offen sc1
    v_fma_f32 v98, -v206, v36, v181
    v_fma_f32 v91, v207, v36, -v180
    v_fma_f32 v99, -v207, v36, v181
    v_mfma_f32_32x32x16_bf16 a[16:31], v[188:191], a[164:167], a[16:31]
    v_fma_f32 v92, v208, v36, -v180
    v_fma_f32 v100, -v208, v36, v181
    v_fma_f32 v93, v209, v36, -v180
    v_fma_f32 v101, -v209, v36, v181
    v_fma_f32 v94, v210, v36, -v180
    v_fma_f32 v102, -v210, v36, v181
    v_mfma_f32_32x32x16_bf16 a[0:15], v[188:191], a[160:163], a[0:15]
    v_fma_f32 v95, v211, v36, -v180
    v_fma_f32 v103, -v211, v36, v181
    v_exp_f32 v88, v88
    v_exp_f32 v89, v89
    v_exp_f32 v90, v90
    v_exp_f32 v91, v91
    v_mfma_f32_32x32x16_bf16 a[48:63], v[188:191], a[164:167], a[48:63]
    v_exp_f32 v92, v92
    v_exp_f32 v93, v93
    v_exp_f32 v94, v94
    v_exp_f32 v95, v95
    v_exp_f32_e64 v96, v96
    v_exp_f32 v97, v97
    s_waitcnt vmcnt(14)
    v_mfma_f32_32x32x16_bf16 v[224:239], v[192:195], a[168:171], v[224:239]
    s_add_u32 s66, s66, 3072
    buffer_load_dwordx4 v[188:191], v39, s[24:27], s66 offen sc1
    v_exp_f32 v98, v98
    v_exp_f32 v99, v99
    v_exp_f32_e64 v100, v100
    v_mfma_f32_32x32x16_bf16 a[16:31], v[192:195], a[172:175], a[16:31]
    v_exp_f32 v101, v101
    v_exp_f32 v102, v102
    v_exp_f32 v103, v103
    v_add_f32 v204, v88, v90
    v_add_f32 v205, v89, v91
    v_add_f32 v206, v96, v98
    v_mfma_f32_32x32x16_bf16 a[0:15], v[192:195], a[168:171], a[0:15]
    v_add_f32 v207, v97, v99
    v_add_f32 v204, v204, v92
    v_add_f32 v205, v205, v93
    v_add_f32 v206, v206, v100
    v_add_f32 v207, v207, v101
    v_add_f32 v204, v204, v94
    v_mfma_f32_32x32x16_bf16 a[48:63], v[192:195], a[172:175], a[48:63]
    v_add_f32 v205, v205, v95
    v_add_f32 v206, v206, v102
    v_add_f32 v207, v207, v103
    v_add_f32 v204, v204, v205
    v_add_f32 v206, v206, v207
    v_mov_b32 v205, v204
    s_lshl_b32 s76, s6, 2
    s_lshl_b32 s81, s3, 0
    s_add_u32 s76, s76, s81
    s_mov_b32 s55, 0x20000
    s_mul_i32 s77, s76, 4096
    s_add_u32 s54, s77, 4096
    s_cmp_eq_u32 s7, 0
    s_cselect_b32 s54, s54, 0
    s_mov_b64 s[52:53], s[28:29]
    v_lshl_add_u32 v2, v1, 7, s77
    buffer_load_dword v3, v2, s[52:55], 0 offen
    s_mul_i32 s77, s76, 5504
    s_add_u32 s54, s77, 5504
    s_cmp_eq_u32 s7, 0
    s_cselect_b32 s54, s54, 0
    s_mov_b64 s[52:53], s[32:33]
    v_lshl_add_u32 v2, v1, 7, s77
    buffer_load_dword v3, v2, s[52:55], 0 offen
    s_waitcnt vmcnt(16)
    v_mfma_f32_32x32x16_bf16 v[224:239], v[124:127], a[176:179], v[224:239]
    s_xor_b32 s66, s91, 4
    s_mul_i32 s66, s66, 12288
    s_add_u32 s66, s66, s63
    buffer_load_dwordx4 v[192:195], v39, s[24:27], s66 offen sc1
    v_mov_b32 v207, v206
    v_permlane32_swap_b32 v204, v205
    s_nop 0
    v_permlane32_swap_b32 v206, v207
    v_mfma_f32_32x32x16_bf16 a[16:31], v[124:127], a[180:183], a[16:31]
    v_add_f32 v204, v204, v205
    v_add_f32 v205, v206, v207
    v_rcp_f32 v204, v204
    v_rcp_f32 v205, v205
    v_mul_f32 v88, v204, v88
    v_mul_f32 v89, v204, v89
    v_mfma_f32_32x32x16_bf16 a[0:15], v[124:127], a[176:179], a[0:15]
    v_mul_f32 v90, v204, v90
    v_mul_f32 v91, v204, v91
    v_mul_f32 v92, v204, v92
    v_mul_f32 v93, v204, v93
    v_mul_f32 v94, v204, v94
    v_mul_f32 v95, v204, v95
    v_mfma_f32_32x32x16_bf16 a[48:63], v[124:127], a[180:183], a[48:63]
    v_mul_f32 v96, v205, v96
    v_mul_f32 v97, v205, v97
    v_mul_f32 v98, v205, v98
    v_mul_f32 v99, v205, v99
    v_mul_f32_e64 v100, v205, v100
    v_mul_f32 v101, v205, v101
    s_waitcnt vmcnt(16)
    v_mfma_f32_32x32x16_bf16 v[224:239], v[128:131], a[184:187], v[224:239]
    s_add_u32 s66, s66, 3072
    buffer_load_dwordx4 v[124:127], v39, s[24:27], s66 offen sc1
    v_mul_f32 v102, v205, v102
    v_mul_f32 v103, v205, v103
    v_cvt_pk_bf16_f32 v144, v88, v89
    v_mfma_f32_32x32x16_bf16 a[16:31], v[128:131], a[188:191], a[16:31]
    v_cvt_pk_bf16_f32 v145, v90, v91
    v_cvt_pk_bf16_f32 v146, v92, v93
    v_cvt_pk_bf16_f32 v147, v94, v95
    v_cvt_pk_bf16_f32 v148, v96, v97
    v_cvt_pk_bf16_f32 v149, v98, v99
    v_cvt_pk_bf16_f32 v150, v100, v101
    v_mfma_f32_32x32x16_bf16 a[0:15], v[128:131], a[184:187], a[0:15]
    v_cvt_pk_bf16_f32 v151, v102, v103
    s_nop 0
    v_mul_f32 v88, v152, v152
    v_mul_f32 v89, v153, v153
    v_mul_f32 v90, v154, v154
    v_mul_f32_e64 v91, v155, v155
    v_mfma_f32_32x32x16_bf16 a[48:63], v[128:131], a[188:191], a[48:63]
    v_mul_f32 v92, v156, v156
    v_mul_f32 v93, v157, v157
    v_mul_f32_e64 v94, v158, v158
    v_mul_f32 v95, v159, v159
    v_fma_f32 v88, v88, v32, v33
    v_fma_f32 v89, v89, v32, v33
    s_waitcnt vmcnt(16)
    v_mfma_f32_32x32x16_bf16 v[224:239], v[132:135], a[192:195], v[224:239]
    s_add_u32 s66, s66, 3072
    buffer_load_dwordx4 v[128:131], v39, s[24:27], s66 offen sc1
    v_fma_f32 v90, v90, v32, v33
    v_fma_f32 v91, v91, v32, v33
    v_fma_f32 v92, v92, v32, v33
    v_mfma_f32_32x32x16_bf16 a[16:31], v[132:135], a[196:199], a[16:31]
    v_fma_f32 v93, v93, v32, v33
    v_fma_f32 v94, v94, v32, v33
    v_fma_f32 v95, v95, v32, v33
    v_mul_f32 v88, v88, v152
    v_mul_f32 v89, v89, v153
    v_mul_f32_e64 v90, v90, v154
    v_mfma_f32_32x32x16_bf16 a[0:15], v[132:135], a[192:195], a[0:15]
    v_mul_f32 v91, v91, v155
    v_mul_f32 v92, v92, v156
    v_mul_f32 v93, v93, v157
    v_mul_f32 v94, v94, v158
    v_mul_f32 v95, v95, v159
    v_exp_f32 v88, v88
    v_mfma_f32_32x32x16_bf16 a[48:63], v[132:135], a[196:199], a[48:63]
    v_exp_f32 v89, v89
    v_exp_f32 v90, v90
    v_exp_f32 v91, v91
    v_exp_f32 v92, v92
    v_exp_f32_e64 v93, v93
    v_exp_f32 v94, v94
    s_waitcnt vmcnt(16)
    v_mfma_f32_32x32x16_bf16 v[224:239], v[112:115], a[200:203], v[224:239]
    s_add_u32 s66, s66, 3072
    buffer_load_dwordx4 v[132:135], v39, s[24:27], s66 offen sc1
    v_exp_f32 v95, v95
    v_add_f32 v88, 1.0, v88
    v_add_f32_e64 v89, 1.0, v89
    v_mfma_f32_32x32x16_bf16 a[16:31], v[112:115], a[204:207], a[16:31]
    v_add_f32 v90, 1.0, v90
    v_add_f32 v91, 1.0, v91
    v_add_f32 v92, 1.0, v92
    v_add_f32 v93, 1.0, v93
    v_add_f32 v94, 1.0, v94
    v_add_f32 v95, 1.0, v95
    v_mfma_f32_32x32x16_bf16 a[0:15], v[112:115], a[200:203], a[0:15]
    v_rcp_f32 v88, v88
    v_rcp_f32 v89, v89
    v_rcp_f32 v90, v90
    v_rcp_f32 v91, v91
    v_rcp_f32 v92, v92
    v_rcp_f32 v93, v93
    v_mfma_f32_32x32x16_bf16 a[48:63], v[112:115], a[204:207], a[48:63]
    v_rcp_f32 v94, v94
    v_rcp_f32 v95, v95
    v_mul_f32 v152, v152, v88
    v_mul_f32 v153, v153, v89
    v_mul_f32 v154, v154, v90
    v_mul_f32 v155, v155, v91
    s_getpc_b64 s[76:77]
    s_lshr_b32 s78, s2, 3
    s_lshl_b32 s78, s78, 9
    v_and_b32 v2, 7, v1
    v_lshl_add_u32 v2, v2, 6, s78
L_pc_16:
    v_min_u32 v2, L_code_end-L_pc_16-64, v2
    global_load_dword v3, v2, s[76:77]
    s_lshl_b32 s76, s6, 11
    s_add_u32 s76, s76, 13139968
    v_bfe_u32 v4, v1, 0, 3
    v_lshlrev_b32 v4, 8, v4
    v_bfe_u32 v2, v1, 3, 1
    v_lshl_add_u32 v4, v2, 7, v4
    v_bfe_u32 v2, v1, 4, 1
    v_lshl_add_u32 v4, v2, 16, v4
    v_add_u32 v4, s76, v4
    buffer_load_dword v3, v4, s[24:27], 0 offen sc1
    s_waitcnt vmcnt(18)
    v_mfma_f32_32x32x16_bf16 v[224:239], v[116:119], a[208:211], v[224:239]
    s_xor_b32 s66, s91, 5
    s_mul_i32 s66, s66, 12288
    s_add_u32 s66, s66, s63
    buffer_load_dwordx4 v[112:115], v39, s[24:27], s66 offen sc1
    v_mul_f32 v156, v156, v92
    v_mul_f32 v157, v157, v93
    v_mul_f32_e64 v158, v158, v94
    v_mfma_f32_32x32x16_bf16 a[16:31], v[116:119], a[212:215], a[16:31]
    v_mul_f32 v159, v159, v95
    v_mul_f32 v88, v160, v160
    v_mul_f32 v89, v161, v161
    v_mul_f32 v90, v162, v162
    v_mul_f32 v91, v163, v163
    v_mul_f32 v92, v164, v164
    v_mfma_f32_32x32x16_bf16 a[0:15], v[116:119], a[208:211], a[0:15]
    v_mul_f32 v93, v165, v165
    v_mul_f32 v94, v166, v166
    v_mul_f32_e64 v95, v167, v167
    v_fma_f32 v88, v88, v32, v33
    v_fma_f32 v89, v89, v32, v33
    v_fma_f32 v90, v90, v32, v33
    v_mfma_f32_32x32x16_bf16 a[48:63], v[116:119], a[212:215], a[48:63]
    v_fma_f32 v91, v91, v32, v33
    v_fma_f32 v92, v92, v32, v33
    v_fma_f32 v93, v93, v32, v33
    v_fma_f32 v94, v94, v32, v33
    v_fma_f32 v95, v95, v32, v33
    v_mul_f32 v88, v88, v160
    s_lshl_b32 s68, s7, 14
    s_lshl_b32 s81, s5, 13
    s_add_u32 s68, s68, s81
    s_add_u32 s68, s68, 12582912
    s_add_u32 s69, s68, 4096
    buffer_load_dwordx4 v[56:59], v42, s[24:27], s68 offen offset:0 sc1
    buffer_load_dwordx4 v[60:63], v42, s[24:27], s68 offen offset:1024 sc1
    buffer_load_dwordx4 v[64:67], v42, s[24:27], s68 offen offset:2048 sc1
    buffer_load_dwordx4 v[68:71], v42, s[24:27], s68 offen offset:3072 sc1
    buffer_load_dwordx4 v[196:199], v42, s[24:27], s69 offen offset:0 sc1
    buffer_load_dwordx4 v[200:203], v42, s[24:27], s69 offen offset:1024 sc1
    buffer_load_dwordx4 v[204:207], v42, s[24:27], s69 offen offset:2048 sc1
    buffer_load_dwordx4 v[208:211], v42, s[24:27], s69 offen offset:3072 sc1
    s_waitcnt vmcnt(23)
    v_mfma_f32_32x32x16_bf16 v[224:239], v[212:215], a[216:219], v[224:239]
    s_add_u32 s66, s66, 3072
    buffer_load_dwordx4 v[116:119], v39, s[24:27], s66 offen sc1
    v_mul_f32 v89, v89, v161
    v_mul_f32 v90, v90, v162
    v_mul_f32 v91, v91, v163
    v_mfma_f32_32x32x16_bf16 a[16:31], v[212:215], a[220:223], a[16:31]
    v_mul_f32 v92, v92, v164
    v_mul_f32 v93, v93, v165
    v_mul_f32 v94, v94, v166
    v_mul_f32 v95, v95, v167
    v_exp_f32 v88, v88
    v_exp_f32 v89, v89
    v_mfma_f32_32x32x16_bf16 a[0:15], v[212:215], a[216:219], a[0:15]
    v_exp_f32 v90, v90
    v_exp_f32 v91, v91
    v_exp_f32 v92, v92
    v_exp_f32 v93, v93
    v_exp_f32 v94, v94
    v_exp_f32 v95, v95
    v_mfma_f32_32x32x16_bf16 a[48:63], v[212:215], a[220:223], a[48:63]
    v_add_f32 v88, 1.0, v88
    v_add_f32 v89, 1.0, v89
    v_add_f32 v90, 1.0, v90
    v_add_f32 v91, 1.0, v91
    v_add_f32_e64 v92, 1.0, v92
    v_add_f32 v93, 1.0, v93
    s_waitcnt vmcnt(21)
    v_mfma_f32_32x32x16_bf16 v[224:239], v[216:219], a[224:227], v[224:239]
    s_add_u32 s66, s66, 3072
    buffer_load_dwordx4 v[212:215], v39, s[24:27], s66 offen sc1
    v_add_f32 v94, 1.0, v94
    v_add_f32 v95, 1.0, v95
    v_rcp_f32_e64 v88, v88
    v_mfma_f32_32x32x16_bf16 a[16:31], v[216:219], a[228:231], a[16:31]
    v_rcp_f32 v89, v89
    v_rcp_f32 v90, v90
    v_rcp_f32 v91, v91
    v_rcp_f32 v92, v92
    v_rcp_f32 v93, v93
    v_rcp_f32 v94, v94
    v_mfma_f32_32x32x16_bf16 a[0:15], v[216:219], a[224:227], a[0:15]
    v_rcp_f32 v95, v95
    v_mul_f32 v160, v160, v88
    v_mul_f32 v161, v161, v89
    v_mul_f32 v162, v162, v90
    v_mul_f32 v163, v163, v91
    v_mul_f32 v164, v164, v92
    v_mfma_f32_32x32x16_bf16 a[48:63], v[216:219], a[228:231], a[48:63]
    v_mul_f32 v165, v165, v93
    v_mul_f32 v166, v166, v94
    v_mul_f32 v167, v167, v95
    v_mul_f32 v88, v168, v168
    v_mul_f32_e64 v89, v169, v169
    v_mul_f32 v90, v170, v170
    s_waitcnt vmcnt(21)
    v_mfma_f32_32x32x16_bf16 v[224:239], v[220:223], a[232:235], v[224:239]
    s_add_u32 s66, s66, 3072
    buffer_load_dwordx4 v[216:219], v39, s[24:27], s66 offen sc1
    v_mul_f32 v91, v171, v171
    v_mul_f32 v92, v172, v172
    v_mul_f32_e64 v93, v173, v173
    v_mfma_f32_32x32x16_bf16 a[16:31], v[220:223], a[236:239], a[16:31]
    v_mul_f32 v94, v174, v174
    v_mul_f32 v95, v175, v175
    v_fma_f32 v88, v88, v32, v33
    v_fma_f32 v89, v89, v32, v33
    v_fma_f32 v90, v90, v32, v33
    v_fma_f32 v91, v91, v32, v33
    v_mfma_f32_32x32x16_bf16 a[0:15], v[220:223], a[232:235], a[0:15]
    v_fma_f32 v92, v92, v32, v33
    v_fma_f32 v93, v93, v32, v33
    v_fma_f32 v94, v94, v32, v33
    v_fma_f32 v95, v95, v32, v33
    v_mul_f32 v88, v88, v168
    v_mul_f32 v89, v89, v169
    v_mfma_f32_32x32x16_bf16 a[48:63], v[220:223], a[236:239], a[48:63]
    v_mul_f32 v90, v90, v170
    v_mul_f32 v91, v91, v171
    v_mul_f32 v92, v92, v172
    v_mul_f32 v93, v93, v173
    v_mul_f32_e64 v94, v94, v174
    v_mul_f32 v95, v95, v175
    s_waitcnt vmcnt(21)
    v_mfma_f32_32x32x16_bf16 v[224:239], v[184:187], a[240:243], v[224:239]
    s_xor_b32 s66, s91, 6
    s_mul_i32 s66, s66, 12288
    s_add_u32 s66, s66, s63
    buffer_load_dwordx4 v[220:223], v39, s[24:27], s66 offen sc1
    v_exp_f32 v88, v88
    v_exp_f32 v89, v89
    v_exp_f32_e64 v90, v90
    v_mfma_f32_32x32x16_bf16 a[16:31], v[184:187], a[244:247], a[16:31]
    v_exp_f32 v91, v91
    v_exp_f32 v92, v92
    v_exp_f32 v93, v93
    v_exp_f32 v94, v94
    v_exp_f32 v95, v95
    v_add_f32 v88, 1.0, v88
    v_mfma_f32_32x32x16_bf16 a[0:15], v[184:187], a[240:243], a[0:15]
    v_add_f32 v89, 1.0, v89
    v_add_f32 v90, 1.0, v90
    v_add_f32 v91, 1.0, v91
    v_add_f32 v92, 1.0, v92
    v_add_f32 v93, 1.0, v93
    v_add_f32 v94, 1.0, v94
    v_mfma_f32_32x32x16_bf16 a[48:63], v[184:187], a[244:247], a[48:63]
    v_add_f32 v95, 1.0, v95
    v_rcp_f32 v88, v88
    v_rcp_f32 v89, v89
    v_rcp_f32 v90, v90
    v_rcp_f32 v91, v91
    v_rcp_f32 v92, v92
    v_add_u32 v26, 98304, v41
    v_xor_b32_e64 v27, 32, v26
    v_xor_b32 v28, 64, v26
    v_xor_b32 v29, 96, v26
    s_waitcnt vmcnt(10)
    v_min3_u32 v5, v57, v59, v61
    v_max3_u32 v6, v57, v59, v61
    s_waitcnt vmcnt(9)
    v_min3_u32 v5, v5, v63, v65
    v_max3_u32 v6, v6, v63, v65
    s_waitcnt vmcnt(8)
    v_min3_u32 v5, v5, v67, v69
    v_max3_u32 v6, v6, v67, v69
    s_waitcnt vmcnt(7)
    v_min3_u32 v5, v5, v71, v197
    v_max3_u32 v6, v6, v71, v197
    s_waitcnt vmcnt(6)
    v_min3_u32 v5, v5, v199, v201
    v_max3_u32 v6, v6, v199, v201
    s_waitcnt vmcnt(5)
    v_min3_u32 v5, v5, v203, v205
    v_max3_u32 v6, v6, v203, v205
    s_waitcnt vmcnt(4)
    v_min3_u32 v5, v5, v207, v209
    v_max3_u32 v6, v6, v207, v209
    v_min_u32 v5, v5, v211
    v_max_u32 v6, v6, v211
    v_xor_b32 v5, s83, v5
    v_xor_b32 v6, s83, v6
    v_or_b32 v5, v5, v6
    v_cmp_ne_u32 vcc, 0, v5
    s_nop 0
    s_cbranch_vccnz L_slow_kvf_17
L_back_kvf_18:
    v_mfma_f32_32x32x16_bf16 v[224:239], v[188:191], a[248:251], v[224:239]
    s_add_u32 s66, s66, 3072
    ds_read_b128 v[72:75], v26 offset:0
    buffer_load_dwordx4 v[184:187], v39, s[24:27], s66 offen sc1
    v_mov_b32 v57, v58
    v_mov_b32 v58, v60
    v_mov_b32_e64 v59, v62
    v_mfma_f32_32x32x16_bf16 a[16:31], v[188:191], a[252:255], a[16:31]
    ds_read_b128 v[76:79], v26 offset:4096
    v_mov_b32 v60, v64
    v_mov_b32 v61, v66
    v_mov_b32 v62, v68
    v_mov_b32 v63, v70
    v_mov_b32 v197, v198
    v_mov_b32 v198, v200
    v_mfma_f32_32x32x16_bf16 a[0:15], v[188:191], a[248:251], a[0:15]
    v_mov_b32 v199, v202
    v_mov_b32 v200, v204
    v_mov_b32 v201, v206
    v_mov_b32 v202, v208
    v_mov_b32_e64 v203, v210
    v_mfma_f32_32x32x16_bf16 a[64:79], v[56:59], v[136:139], 0
    v_mfma_f32_32x32x16_bf16 a[48:63], v[188:191], a[252:255], a[48:63]
    v_mfma_f32_32x32x16_bf16 a[64:79], v[60:63], v[140:143], a[64:79]
    v_mfma_f32_32x32x16_bf16 a[80:95], v[196:199], v[144:147], 0
    v_mfma_f32_32x32x16_bf16 a[80:95], v[200:203], v[148:151], a[80:95]
    s_lshl_b32 s76, s6, 16
    s_lshl_b32 s81, s4, 15
    s_add_u32 s76, s76, s81
    s_waitcnt lgkmcnt(1)
    v_mfma_f32_32x32x16_bf16 v[224:239], v[192:195], v[72:75], v[224:239]
    s_add_u32 s66, s66, 3072
    ds_read_b128 v[80:83], v27 offset:0
    buffer_load_dwordx4 v[188:191], v39, s[24:27], s66 offen sc1
    s_lshl_b32 s81, s88, 11
    s_add_u32 s76, s76, s81
    s_lshl_b32 s81, s5, 10
    s_waitcnt lgkmcnt(1)
    v_mfma_f32_32x32x16_bf16 a[16:31], v[192:195], v[76:79], a[16:31]
    ds_read_b128 v[84:87], v27 offset:4096
    s_add_u32 s76, s76, s81
    s_add_u32 s76, s76, 6291456
    v_bfe_u32 v7, v1, 4, 1
    v_lshlrev_b32 v7, 14, v7
    v_bfe_u32 v2, v1, 5, 1
    v_lshl_add_u32 v7, v2, 8, v7
    v_mfma_f32_32x32x16_bf16 a[0:15], v[192:195], v[72:75], a[0:15]
    v_bfe_u32 v2, v1, 0, 4
    v_lshl_add_u32 v7, v2, 4, v7
    v_add_u32_e64 v7, s76, v7
    v_accvgpr_read_b32 v56, a72
    v_accvgpr_read_b32 v64, a64
    v_accvgpr_read_b32 v65, a65
    v_mfma_f32_32x32x16_bf16 a[48:63], v[192:195], v[76:79], a[48:63]
    v_accvgpr_read_b32 v66, a66
    v_accvgpr_read_b32 v67, a67
    v_accvgpr_read_b32 v68, a68
    v_accvgpr_read_b32 v69, a69
    v_accvgpr_read_b32 v70, a70
    v_accvgpr_read_b32 v71, a71
    v_add_f32 v56, 0x358637bd, v56
    v_rcp_f32 v56, v56
    s_nop 0
    v_mul_f32 v64, v56, v64
    v_mul_f32 v65, v56, v65
    v_mul_f32 v66, v56, v66
    v_mul_f32 v67, v56, v67
    v_mul_f32 v68, v56, v68
    v_mul_f32 v69, v56, v69
    v_mul_f32 v70, v56, v70
    v_mul_f32 v71, v56, v71
    v_cvt_pk_bf16_f32 v176, v64, v65
    v_cvt_pk_bf16_f32 v177, v66, v67
    v_cvt_pk_bf16_f32 v178, v68, v69
    v_cvt_pk_bf16_f32 v179, v70, v71
    v_accvgpr_read_b32 v196, a80
    v_accvgpr_read_b32 v204, a88
    v_accvgpr_read_b32 v205, a89
    v_accvgpr_read_b32 v206, a90
    v_accvgpr_read_b32 v207, a91
    v_accvgpr_read_b32 v208, a92
    v_accvgpr_read_b32 v209, a93
    v_accvgpr_read_b32 v210, a94
    v_accvgpr_read_b32 v211, a95
    v_add_f32 v196, 0x358637bd, v196
    v_rcp_f32 v196, v196
    s_nop 0
    v_mul_f32 v204, v196, v204
    v_mul_f32 v205, v196, v205
    v_mul_f32 v206, v196, v206
    v_mul_f32 v207, v196, v207
    v_mul_f32 v208, v196, v208
    v_mul_f32 v209, v196, v209
    v_mul_f32 v210, v196, v210
    v_mul_f32 v211, v196, v211
    v_cvt_pk_bf16_f32 v180, v204, v205
    v_cvt_pk_bf16_f32 v181, v206, v207
    v_cvt_pk_bf16_f32 v182, v208, v209
    v_cvt_pk_bf16_f32 v183, v210, v211
    buffer_store_dwordx4 v[176:179], v7, s[24:27], 0 offen offset:0 sc1
    buffer_store_dwordx4 v[180:183], v7, s[24:27], 0 offen offset:512 sc1
    s_waitcnt lgkmcnt(1)
    v_mfma_f32_32x32x16_bf16 v[224:239], v[124:127], v[80:83], v[224:239]
    s_add_u32 s66, s66, 3072
    ds_read_b128 v[72:75], v28 offset:0
    buffer_load_dwordx4 v[192:195], v39, s[24:27], s66 offen sc1
    v_rcp_f32 v93, v93
    v_rcp_f32_e64 v94, v94
    v_rcp_f32 v95, v95
    s_waitcnt lgkmcnt(1)
    v_mfma_f32_32x32x16_bf16 a[16:31], v[124:127], v[84:87], a[16:31]
    ds_read_b128 v[76:79], v28 offset:4096
    v_mul_f32 v168, v168, v88
    v_mul_f32 v169, v169, v89
    v_mul_f32 v170, v170, v90
    v_mul_f32 v171, v171, v91
    v_mul_f32 v172, v172, v92
    v_mul_f32 v173, v173, v93
    v_mfma_f32_32x32x16_bf16 a[0:15], v[124:127], v[80:83], a[0:15]
    v_mul_f32 v174, v174, v94
    v_mul_f32 v175, v175, v95
    v_cvt_pk_bf16_f32 v152, v152, v153
    v_cvt_pk_bf16_f32 v153, v154, v155
    v_cvt_pk_bf16_f32 v154, v156, v157
    v_cvt_pk_bf16_f32 v155, v158, v159
    v_mfma_f32_32x32x16_bf16 a[48:63], v[124:127], v[84:87], a[48:63]
    v_cvt_pk_bf16_f32 v156, v160, v161
    v_cvt_pk_bf16_f32 v157, v162, v163
    v_cvt_pk_bf16_f32 v158, v164, v165
    v_cvt_pk_bf16_f32 v159, v166, v167
    v_cvt_pk_bf16_f32 v160, v168, v169
    v_cvt_pk_bf16_f32 v161, v170, v171
    s_waitcnt lgkmcnt(1)
    v_mfma_f32_32x32x16_bf16 v[224:239], v[128:131], v[72:75], v[224:239]
    s_xor_b32 s66, s91, 7
    s_mul_i32 s66, s66, 12288
    s_add_u32 s66, s66, s63
    ds_read_b128 v[80:83], v29 offset:0
    buffer_load_dwordx4 v[124:127], v39, s[24:27], s66 offen sc1
    v_cvt_pk_bf16_f32 v162, v172, v173
    v_cvt_pk_bf16_f32 v163, v174, v175
    s_waitcnt lgkmcnt(1)
    v_mfma_f32_32x32x16_bf16 a[16:31], v[128:131], v[76:79], a[16:31]
    ds_read_b128 v[84:87], v29 offset:4096
    v_mfma_f32_32x32x16_bf16 a[0:15], v[128:131], v[72:75], a[0:15]
    v_mfma_f32_32x32x16_bf16 a[48:63], v[128:131], v[76:79], a[48:63]
    v_add_u32 v26, 131072, v41
    v_xor_b32 v27, 32, v26
    v_xor_b32 v28, 64, v26
    v_xor_b32 v29, 96, v26
    s_waitcnt lgkmcnt(1)
    v_mfma_f32_32x32x16_bf16 v[224:239], v[132:135], v[80:83], v[224:239]
    s_add_u32 s66, s66, 3072
    ds_read_b128 v[72:75], v26 offset:0
    buffer_load_dwordx4 v[128:131], v39, s[24:27], s66 offen sc1
    s_waitcnt lgkmcnt(1)
    v_mfma_f32_32x32x16_bf16 a[16:31], v[132:135], v[84:87], a[16:31]
    ds_read_b128 v[76:79], v26 offset:4096
    v_mfma_f32_32x32x16_bf16 a[0:15], v[132:135], v[80:83], a[0:15]
    v_mfma_f32_32x32x16_bf16 a[48:63], v[132:135], v[84:87], a[48:63]
    s_waitcnt lgkmcnt(1)
    v_mfma_f32_32x32x16_bf16 v[224:239], v[112:115], v[72:75], v[224:239]
    s_add_u32 s66, s66, 3072
    ds_read_b128 v[80:83], v27 offset:0
    buffer_load_dwordx4 v[132:135], v39, s[24:27], s66 offen sc1
    s_waitcnt lgkmcnt(1)
    v_mfma_f32_32x32x16_bf16 a[16:31], v[112:115], v[76:79], a[16:31]
    ds_read_b128 v[84:87], v27 offset:4096
    v_mfma_f32_32x32x16_bf16 a[0:15], v[112:115], v[72:75], a[0:15]
    v_mfma_f32_32x32x16_bf16 a[48:63], v[112:115], v[76:79], a[48:63]
    s_waitcnt vmcnt(11) lgkmcnt(1)
    v_mfma_f32_32x32x16_bf16 v[224:239], v[116:119], v[80:83], v[224:239]
    s_add_u32 s66, s66, 3072
    ds_read_b128 v[72:75], v28 offset:0
    buffer_load_dwordx4 v[112:115], v39, s[24:27], s66 offen sc1
    s_waitcnt lgkmcnt(1)
    v_mfma_f32_32x32x16_bf16 a[16:31], v[116:119], v[84:87], a[16:31]
    ds_read_b128 v[76:79], v28 offset:4096
    v_mfma_f32_32x32x16_bf16 a[0:15], v[116:119], v[80:83], a[0:15]
    v_mfma_f32_32x32x16_bf16 a[48:63], v[116:119], v[84:87], a[48:63]
    s_waitcnt vmcnt(5)
    s_barrier
    s_cmp_lg_u32 s3, 0
    s_cbranch_scc1 L_w0_20
    s_lshl_b32 s76, s6, 11
    s_lshl_b32 s81, s7, 8
    s_add_u32 s76, s76, s81
    s_add_u32 s76, s76, 13205504
    v_mov_b32 v8, s76
    v_mov_b32 v9, s83
    s_mov_b64 exec, 1
    buffer_store_dword v9, v8, s[24:27], 0 offen offset:128
    buffer_store_dword v9, v8, s[24:27], 0 offen sc1
    s_mov_b64 exec, -1
L_w0_20:
    s_waitcnt lgkmcnt(1)
    v_mfma_f32_32x32x16_bf16 v[224:239], v[212:215], v[72:75], v[224:239]
    ds_read_b128 v[80:83], v29 offset:0
    s_waitcnt lgkmcnt(1)
    v_mfma_f32_32x32x16_bf16 a[16:31], v[212:215], v[76:79], a[16:31]
    ds_read_b128 v[84:87], v29 offset:4096
    v_mfma_f32_32x32x16_bf16 a[0:15], v[212:215], v[72:75], a[0:15]
    v_mfma_f32_32x32x16_bf16 a[48:63], v[212:215], v[76:79], a[48:63]
    v_add_u32 v26, 0, v41
    v_xor_b32 v27, 32, v26
    v_xor_b32 v28, 64, v26
    v_xor_b32 v29, 96, v26
    s_waitcnt lgkmcnt(1)
    v_mfma_f32_32x32x16_bf16 v[224:239], v[216:219], v[80:83], v[224:239]
    ds_read_b128 v[72:75], v26 offset:0
    s_waitcnt lgkmcnt(1)
    v_mfma_f32_32x32x16_bf16 a[16:31], v[216:219], v[84:87], a[16:31]
    ds_read_b128 v[76:79], v26 offset:4096
    v_mfma_f32_32x32x16_bf16 a[0:15], v[216:219], v[80:83], a[0:15]
    v_mfma_f32_32x32x16_bf16 a[48:63], v[216:219], v[84:87], a[48:63]
    s_waitcnt lgkmcnt(1)
    v_mfma_f32_32x32x16_bf16 v[224:239], v[220:223], v[72:75], v[224:239]
    ds_read_b128 v[80:83], v27 offset:0
    s_waitcnt lgkmcnt(1)
    v_mfma_f32_32x32x16_bf16 a[16:31], v[220:223], v[76:79], a[16:31]
    ds_read_b128 v[84:87], v27 offset:4096
    v_mfma_f32_32x32x16_bf16 a[0:15], v[220:223], v[72:75], a[0:15]
    v_mfma_f32_32x32x16_bf16 a[48:63], v[220:223], v[76:79], a[48:63]
    s_waitcnt lgkmcnt(1)
    v_mfma_f32_32x32x16_bf16 v[224:239], v[184:187], v[80:83], v[224:239]
    ds_read_b128 v[72:75], v28 offset:0
    s_waitcnt lgkmcnt(1)
    v_mfma_f32_32x32x16_bf16 a[16:31], v[184:187], v[84:87], a[16:31]
    ds_read_b128 v[76:79], v28 offset:4096
    v_mfma_f32_32x32x16_bf16 a[0:15], v[184:187], v[80:83], a[0:15]
    v_mfma_f32_32x32x16_bf16 a[48:63], v[184:187], v[84:87], a[48:63]
    s_lshl_b32 s76, s6, 11
    s_add_u32 s76, s76, 13205504
    v_bfe_u32 v43, v1, 0, 3
    v_lshlrev_b32 v43, 8, v43
    v_bfe_u32 v2, v1, 3, 1
    v_lshl_add_u32 v43, v2, 7, v43
    v_add_u32_e64 v43, s76, v43
    buffer_load_dword v44, v43, s[24:27], 0 offen sc1
    s_waitcnt lgkmcnt(1)
    v_mfma_f32_32x32x16_bf16 v[224:239], v[188:191], v[72:75], v[224:239]
    ds_read_b128 v[80:83], v29 offset:0
    s_waitcnt lgkmcnt(1)
    v_mfma_f32_32x32x16_bf16 a[16:31], v[188:191], v[76:79], a[16:31]
    ds_read_b128 v[84:87], v29 offset:4096
    v_mfma_f32_32x32x16_bf16 a[0:15], v[188:191], v[72:75], a[0:15]
    v_mfma_f32_32x32x16_bf16 a[48:63], v[188:191], v[76:79], a[48:63]
    v_add_u32 v26, 32768, v41
    v_xor_b32_e64 v27, 32, v26
    v_xor_b32 v28, 64, v26
    v_xor_b32 v29, 96, v26
    s_waitcnt vmcnt(5) lgkmcnt(1)
    v_mfma_f32_32x32x16_bf16 v[224:239], v[192:195], v[80:83], v[224:239]
    ds_read_b128 v[72:75], v26 offset:0
    s_waitcnt lgkmcnt(1)
    v_mfma_f32_32x32x16_bf16 a[16:31], v[192:195], v[84:87], a[16:31]
    ds_read_b128 v[76:79], v26 offset:4096
    v_mfma_f32_32x32x16_bf16 a[0:15], v[192:195], v[80:83], a[0:15]
    v_mfma_f32_32x32x16_bf16 a[48:63], v[192:195], v[84:87], a[48:63]
    s_waitcnt vmcnt(4) lgkmcnt(1)
    v_mfma_f32_32x32x16_bf16 v[224:239], v[124:127], v[72:75], v[224:239]
    ds_read_b128 v[80:83], v27 offset:0
    s_waitcnt lgkmcnt(1)
    v_mfma_f32_32x32x16_bf16 a[16:31], v[124:127], v[76:79], a[16:31]
    ds_read_b128 v[84:87], v27 offset:4096
    v_mfma_f32_32x32x16_bf16 a[0:15], v[124:127], v[72:75], a[0:15]
    v_mfma_f32_32x32x16_bf16 a[48:63], v[124:127], v[76:79], a[48:63]
    s_and_b32 s70, s7, 1
    s_min_u32 s70, s70, 1
    s_lshl_b32 s71, s6, 16
    s_lshl_b32 s81, s3, 14
    s_add_u32 s71, s71, s81
    s_lshl_b32 s81, s70, 13
    s_add_u32 s71, s71, s81
    s_add_u32 s71, s71, 6291456
    s_mul_i32 s92, s70, 16384
    s_sub_u32 s92, 4096, s92
    s_mul_i32 s93, s70, 22528
    s_sub_u32 s93, 3072, s93
    s_mul_i32 s94, s70, 90112
    s_sub_u32 s94, 45056, s94
    s_mul_i32 s95, s70, 65536
    s_sub_u32 s95, 32768, s95
    s_waitcnt vmcnt(0)
    v_cmp_eq_u32_e64 vcc, s83, v44
    s_nop 3
    s_lshr_b32 s81, vcc_lo, 8
    s_or_b32 s81, s81, vcc_lo
    s_and_b32 s81, s81, 0xff
    s_cmp_eq_u32 s81, 0xff
    s_cbranch_scc0 L_slow_f5_21
L_back_f5_22:
    s_waitcnt lgkmcnt(1)
    v_mfma_f32_32x32x16_bf16 v[224:239], v[128:131], v[80:83], v[224:239]
    ds_read_b128 v[72:75], v28 offset:0
    buffer_load_dwordx4 a[128:131], v42, s[24:27], s71 offen offset:0 sc1
    s_waitcnt lgkmcnt(1)
    v_mfma_f32_32x32x16_bf16 a[16:31], v[128:131], v[84:87], a[16:31]
    ds_read_b128 v[76:79], v28 offset:4096
    buffer_load_dwordx4 a[132:135], v42, s[24:27], s71 offen offset:1024 sc1
    v_mfma_f32_32x32x16_bf16 a[0:15], v[128:131], v[80:83], a[0:15]
    buffer_load_dwordx4 a[136:139], v42, s[24:27], s71 offen offset:2048 sc1
    v_mfma_f32_32x32x16_bf16 a[48:63], v[128:131], v[84:87], a[48:63]
    buffer_load_dwordx4 a[140:143], v42, s[24:27], s71 offen offset:3072 sc1
    s_waitcnt lgkmcnt(1)
    v_mfma_f32_32x32x16_bf16 v[224:239], v[132:135], v[72:75], v[224:239]
    s_add_u32 s71, s71, 4096
    ds_read_b128 v[80:83], v29 offset:0
    buffer_load_dwordx4 a[144:147], v42, s[24:27], s71 offen offset:0 sc1
    s_waitcnt lgkmcnt(1)
    v_mfma_f32_32x32x16_bf16 a[16:31], v[132:135], v[76:79], a[16:31]
    ds_read_b128 v[84:87], v29 offset:4096
    buffer_load_dwordx4 a[148:151], v42, s[24:27], s71 offen offset:1024 sc1
    v_mfma_f32_32x32x16_bf16 a[0:15], v[132:135], v[72:75], a[0:15]
    buffer_load_dwordx4 a[152:155], v42, s[24:27], s71 offen offset:2048 sc1
    v_mfma_f32_32x32x16_bf16 a[48:63], v[132:135], v[76:79], a[48:63]
    buffer_load_dwordx4 a[156:159], v42, s[24:27], s71 offen offset:3072 sc1
    s_waitcnt lgkmcnt(1)
    v_mfma_f32_32x32x16_bf16 v[224:239], v[112:115], v[80:83], v[224:239]
    s_add_u32 s71, s71, s92
    buffer_load_dwordx4 a[160:163], v42, s[24:27], s71 offen offset:0 sc1
    s_waitcnt lgkmcnt(0)
    v_mfma_f32_32x32x16_bf16 a[16:31], v[112:115], v[84:87], a[16:31]
    buffer_load_dwordx4 a[164:167], v42, s[24:27], s71 offen offset:1024 sc1
    v_mfma_f32_32x32x16_bf16 a[0:15], v[112:115], v[80:83], a[0:15]
    buffer_load_dwordx4 a[168:171], v42, s[24:27], s71 offen offset:2048 sc1
    v_mfma_f32_32x32x16_bf16 a[48:63], v[112:115], v[84:87], a[48:63]
    buffer_load_dwordx4 a[172:175], v42, s[24:27], s71 offen offset:3072 sc1
    s_add_u32 s71, s71, 4096
    buffer_load_dwordx4 a[176:179], v42, s[24:27], s71 offen offset:0 sc1
    buffer_load_dwordx4 a[180:183], v42, s[24:27], s71 offen offset:1024 sc1
    buffer_load_dwordx4 a[184:187], v42, s[24:27], s71 offen offset:2048 sc1
    buffer_load_dwordx4 a[188:191], v42, s[24:27], s71 offen offset:3072 sc1
    s_waitcnt vmcnt(16) lgkmcnt(0)
    s_nop 15
    s_branch L_s2_join_13
L_slow_kvf_27:
    s_mov_b32 s85, 32768
L_loop_29:
    buffer_load_dwordx4 v[56:59], v42, s[24:27], s68 offen offset:0 sc1
    buffer_load_dwordx4 v[60:63], v42, s[24:27], s68 offen offset:1024 sc1
    buffer_load_dwordx4 v[64:67], v42, s[24:27], s68 offen offset:2048 sc1
    buffer_load_dwordx4 v[68:71], v42, s[24:27], s68 offen offset:3072 sc1
    buffer_load_dwordx4 v[196:199], v42, s[24:27], s69 offen offset:0 sc1
    buffer_load_dwordx4 v[200:203], v42, s[24:27], s69 offen offset:1024 sc1
    buffer_load_dwordx4 v[204:207], v42, s[24:27], s69 offen offset:2048 sc1
    buffer_load_dwordx4 v[208:211], v42, s[24:27], s69 offen offset:3072 sc1
    s_waitcnt vmcnt(0)
    v_min3_u32 v5, v57, v59, v61
    v_max3_u32 v6, v57, v59, v61
    v_min3_u32 v5, v5, v63, v65
    v_max3_u32 v6, v6, v63, v65
    v_min3_u32 v5, v5, v67, v69
    v_max3_u32 v6, v6, v67, v69
    v_min3_u32 v5, v5, v71, v197
    v_max3_u32 v6, v6, v71, v197
    v_min3_u32 v5, v5, v199, v201
    v_max3_u32 v6, v6, v199, v201
    v_min3_u32 v5, v5, v203, v205
    v_max3_u32 v6, v6, v203, v205
    v_min3_u32 v5, v5, v207, v209
    v_max3_u32 v6, v6, v207, v209
    v_min_u32 v5, v5, v211
    v_max_u32 v6, v6, v211
    v_xor_b32 v5, s83, v5
    v_xor_b32 v6, s83, v6
    v_or_b32_e64 v5, v5, v6
    v_cmp_ne_u32 vcc, 0, v5
    s_sub_u32 s85, s85, 1
    s_cbranch_vccz L_back_kvf_28
    s_cmp_lg_u32 s85, 0
    s_cbranch_scc1 L_loop_29
    s_branch L_back_kvf_28
L_slow_f5_31:
    s_mov_b32 s85, 32768
L_loop_33:
    buffer_load_dword v44, v43, s[24:27], 0 offen sc1
    s_sub_u32 s85, s85, 1
    s_waitcnt vmcnt(0)
    v_cmp_eq_u32 vcc, s83, v44
    s_nop 3
    s_lshr_b32 s81, vcc_lo, 8
    s_or_b32 s81, s81, vcc_lo
    s_and_b32 s81, s81, 0xff
    s_cmp_eq_u32 s81, 0xff
    s_cbranch_scc1 L_back_f5_32
    s_cmp_lg_u32 s85, 0
    s_cbranch_scc1 L_loop_33
    s_branch L_back_f5_32
L_slow_f4_35:
    s_mov_b32 s85, 32768
L_loop_37:
    buffer_load_dword v44, v43, s[24:27], 0 offen sc1
    s_sub_u32 s85, s85, 1
    s_waitcnt vmcnt(0)
    v_cmp_eq_u32 vcc, s83, v44
    s_nop 3
    s_lshr_b32 s81, vcc_lo, 8
    s_or_b32 s81, s81, vcc_lo
    s_and_b32 s81, s81, 0xff
    s_cmp_eq_u32 s81, 0xff
    s_cbranch_scc1 L_back_f4_36
    s_cmp_lg_u32 s85, 0
    s_cbranch_scc1 L_loop_37
    s_branch L_back_f4_36
L_code_end:
.set CODE_BYTES, L_code_end-recurrent_scan__linear_kernel_hedgehog__mixer_gmlp__prompt_kernel
.section .rodata,"a"
.p2align 6
.amdhsa_kernel recurrent_scan__linear_kernel_hedgehog__mixer_gmlp__prompt_kernel
  .amdhsa_next_free_vgpr 512
  .amdhsa_next_free_sgpr 102
  .amdhsa_accum_offset 256
  .amdhsa_group_segment_fixed_size 0
  .amdhsa_kernarg_size 96
  .amdhsa_user_sgpr_count 2
  .amdhsa_user_sgpr_kernarg_segment_ptr 1
  .amdhsa_system_sgpr_workgroup_id_x 1
.end_amdhsa_kernel
```
